```python
import torch

def _softmax(x, axis=-1):
    return torch.softmax(x, dim=axis)
def _gelu(x):
    return torch.nn.functional.gelu(x, approximate="tanh")
def _silu(x):
    return torch.nn.functional.silu(x)
def _sigmoid(x):
    return torch.sigmoid(x)
def _layernorm(x, axis=-1, eps=1e-5):
    m = x.mean(dim=axis, keepdim=True)
    v = x.var(dim=axis, keepdim=True, unbiased=False)
    return (x - m) / torch.sqrt(v + eps)
def _scatter_add(tgt, idx, src, axis=0):
    return tgt.clone().index_add_(axis, idx, src)
def _segment_sum(src, seg, n):
    out = torch.zeros((n,) + src.shape[1:], dtype=src.dtype)
    return out.index_add_(0, seg, src)
def _pad(x, pw):
    flat = tuple(v for pair in reversed(pw) for v in pair)
    return torch.nn.functional.pad(x, flat)

kernel_name = 'sequential_preLN__mha_block_cached__swiglu_ffn__decode'

def setup_inputs():

    _w = (lambda a: (lambda t: t.to(torch.bfloat16) if t.is_floating_point() else t)(torch.as_tensor(a)))
    def _A_setup():
        B, Sq, D = 1, 1, 640
        H, Sk, Dh = 32, 16384, 128
        return {
            "x": _w((lambda *s: torch.randn(*s, dtype=torch.bfloat16) * 0.05)(B, Sq, D)),
            "k_cache": _w((lambda *s: torch.randn(*s, dtype=torch.bfloat16) * 3.2)(B, H, Sk, Dh)),
            "v_cache": _w((lambda *s: torch.randn(*s, dtype=torch.bfloat16) * 0.4)(B, H, Sk, Dh)),
            "wq": _w((lambda *s: torch.randn(*s, dtype=torch.bfloat16) * 3.2)(D, H * Dh) * (D ** -0.5)),
            "wo": _w((lambda *s: torch.randn(*s, dtype=torch.bfloat16) * 0.4)(H * Dh, D) * ((H * Dh) ** -0.5)),
        }
    _A_in = _A_setup()

    def _B_setup():
        B, S, D, F = 1, 1, 640, 1728
        return {
            "x": _w((lambda *s: torch.randn(*s, dtype=torch.bfloat16) * 0.05)(B, S, D)),
            "w_gate": _w((lambda *s: torch.randn(*s, dtype=torch.bfloat16) * 0.05)(D, F)),
            "w_up": _w((lambda *s: torch.randn(*s, dtype=torch.bfloat16) * 0.05)(D, F)),
            "w_down": _w((lambda *s: torch.randn(*s, dtype=torch.bfloat16) * 0.05)(F, D)),
        }
    _B_in = _B_setup()

    return {
        "A_x": _A_in["x"],
        "A_k_cache": _A_in["k_cache"],
        "A_v_cache": _A_in["v_cache"],
        "A_wq": _A_in["wq"],
        "A_wo": _A_in["wo"],
        "B_x": _B_in["x"],
        "B_w_gate": _B_in["w_gate"],
        "B_w_up": _B_in["w_up"],
        "B_w_down": _B_in["w_down"],
    }

def reference(A_x, A_k_cache, A_v_cache, A_wq, A_wo, B_x, B_w_gate, B_w_up, B_w_down):
    def _A_ref(x, k_cache, v_cache, wq, wo):
        B, Sq, D = x.shape
        H, Dh = 32, 128
        q = (lambda x, *d: x.permute(*d))((x @ wq).reshape(B, Sq, H, Dh), 0, 2, 1, 3)
        scores = torch.einsum("bhqd,bhkd->bhqk", q, k_cache) * (Dh ** -0.5)
        p = _softmax(scores, axis=-1)
        o = torch.einsum("bhqk,bhkd->bhqd", p, v_cache)
        return (lambda x, *d: x.permute(*d))(o, 0, 2, 1, 3).reshape(B, Sq, H * Dh) @ wo

    def _B_ref(x, w_gate, w_up, w_down):
        g = _silu(x @ w_gate)
        u = x @ w_up
        return (g * u) @ w_down

    x = A_x
    h = x + _A_ref(_layernorm(x, axis=-1), A_k_cache, A_v_cache, A_wq, A_wo)
    h2 = h + _B_ref(_layernorm(h, axis=-1), B_w_gate, B_w_up, B_w_down)
    return h2
```

```asm
; @launch grid=(256,1,1) block=(512,1,1) lds=61440
.amdgcn_target "amdgcn-amd-amdhsa--gfx950"
.text
.globl sequential_preLN__mha_block_cached__swiglu_ffn__decode_kernel
.p2align 8
.type sequential_preLN__mha_block_cached__swiglu_ffn__decode_kernel,@function
sequential_preLN__mha_block_cached__swiglu_ffn__decode_kernel:
    s_load_dwordx8 s[16:23], s[0:1], 0
    s_memrealtime s[98:99]
    v_lshrrev_b32 v6, 6, v0
    v_and_b32 v1, 63, v0
    s_cmp_ge_u32 s2, 256
    v_readfirstlane_b32 s3, v6
    s_cbranch_scc1 L_end
    s_and_b32 s7, s2, 7
    s_lshr_b32 s4, s2, 3
    v_lshlrev_b32 v4, 4, v1
    s_lshr_b32 s82, s4, 0
    s_lshl_b32 s80, s82, 22
    s_cmp_lt_u32 s3, 4
    s_cbranch_scc1 L_pro_h
    s_and_b32 s6, s2, 1
    s_and_b32 s5, s2, 6
    s_lshl_b32 s5, s5, 1
    s_add_u32 s5, s5, s3
    s_mul_i32 s72, s82, 352
    s_add_u32 s5, s5, s72
    s_sub_u32 s5, s5, 4
    s_lshl_b32 s77, s6, 4
    s_add_u32 s77, s77, s5
    s_lshl_b32 s77, s77, 12
    s_and_b32 s77, s77, 0x3fffff
    s_lshr_b32 s79, s4, 2
    s_lshl_b32 s79, s79, 17
    s_mov_b32 s10, 0x400000
    s_mov_b32 s11, 0x20000
    s_mov_b32 s76, s77
    s_bfe_u32 s6, s76, 0x10011
    s_lshl_b32 s6, s6, 21
    s_xor_b32 s6, s6, s79
    s_and_b32 s5, s76, 0x1ffff
    s_xor_b32 s6, s6, s5
    s_lshr_b32 s5, s76, 18
    s_lshl_b32 s5, s5, 17
    s_xor_b32 s78, s6, s5
    s_waitcnt lgkmcnt(0)
    s_add_u32 s8, s18, s80
    s_addc_u32 s9, s19, 0
    buffer_load_dwordx4 v[84:87], v4, s[8:11], s78 offen offset:0 nt
    buffer_load_dwordx4 v[88:91], v4, s[8:11], s78 offen offset:1024 nt
    buffer_load_dwordx4 v[92:95], v4, s[8:11], s78 offen offset:2048 nt
    buffer_load_dwordx4 v[96:99], v4, s[8:11], s78 offen offset:3072 nt
    s_add_u32 s76, s76, 131072
    s_and_b32 s76, s76, 0x3fffff
    s_bfe_u32 s6, s76, 0x10011
    s_lshl_b32 s6, s6, 21
    s_xor_b32 s6, s6, s79
    s_and_b32 s5, s76, 0x1ffff
    s_xor_b32 s6, s6, s5
    s_lshr_b32 s5, s76, 18
    s_lshl_b32 s5, s5, 17
    s_xor_b32 s78, s6, s5
    buffer_load_dwordx4 v[100:103], v4, s[8:11], s78 offen offset:0 nt
    s_setprio 2
    s_load_dwordx16 s[24:39], s[0:1], 32
    s_getpc_b64 s[96:97]
L_pcs:
    s_add_u32 s96, s96, L_tab-L_pcs
    s_addc_u32 s97, s97, 0
    s_and_b32 s81, s2, 0xfc
    s_load_dword s101, s[96:97], s81
    v_lshrrev_b32 v2, 4, v1
    v_and_b32 v3, 15, v1
    v_mov_b32 v20, 0
    s_mov_b32 s73, s4
    s_mul_i32 s73, s73, 4352
    s_add_u32 s73, s73, 4096
    s_mov_b32 s94, 0x3fb8aa3b
    s_mov_b32 s95, 0xffff0000
    s_mov_b32 s90, 0xffffff00
    s_mov_b32 s84, s2
    v_add_u32 v5, 4096, v4
    v_and_b32 v11, 1, v3
    v_lshlrev_b32 v11, 4, v11
    v_mov_b32 v12, 0xffff
    v_lshlrev_b32 v11, v11, v12
    v_bfe_u32 v12, v3, 1, 2
    v_cmp_eq_u32 vcc, 0, v12
    s_nop 1
    v_cndmask_b32 v24, 0, v11, vcc
    v_cmp_eq_u32 vcc, 1, v12
    s_nop 1
    v_cndmask_b32 v25, 0, v11, vcc
    v_cmp_eq_u32 vcc, 2, v12
    s_nop 1
    v_cndmask_b32 v26, 0, v11, vcc
    v_cmp_eq_u32 vcc, 3, v12
    s_nop 1
    v_cndmask_b32 v27, 0, v11, vcc
    v_lshlrev_b32 v14, 5, v3
    v_lshl_add_u32 v14, v2, 4, v14
    s_waitcnt vmcnt(4)
    buffer_load_dwordx4 v[104:107], v4, s[8:11], s78 offen offset:1024 nt
    s_waitcnt vmcnt(4)
    buffer_load_dwordx4 v[108:111], v4, s[8:11], s78 offen offset:2048 nt
    s_waitcnt vmcnt(4)
    buffer_load_dwordx4 v[112:115], v4, s[8:11], s78 offen offset:3072 nt
    s_add_u32 s76, s76, 131072
    s_and_b32 s76, s76, 0x3fffff
    s_bfe_u32 s6, s76, 0x10011
    s_lshl_b32 s6, s6, 21
    s_xor_b32 s6, s6, s79
    s_and_b32 s5, s76, 0x1ffff
    s_xor_b32 s6, s6, s5
    s_lshr_b32 s5, s76, 18
    s_lshl_b32 s5, s5, 17
    s_xor_b32 s78, s6, s5
    s_waitcnt vmcnt(4)
    buffer_load_dwordx4 v[116:119], v4, s[8:11], s78 offen offset:0 nt
    s_waitcnt vmcnt(4)
    buffer_load_dwordx4 v[120:123], v4, s[8:11], s78 offen offset:1024 nt
    s_waitcnt lgkmcnt(0)
    s_load_dword s92, s[38:39], 0
    s_add_u32 s12, s20, s80
    s_addc_u32 s13, s21, 0
    s_mov_b32 s14, 0x400000
    s_mov_b32 s15, 0x20000
    s_mov_b32 s75, 0
    s_and_b32 s87, s2, 7
    s_and_b32 s81, s2, 3
    s_lshl_b32 s81, s81, 3
    s_lshr_b32 s89, s101, s81
    s_and_b32 s89, s89, 0xff
    s_cmp_lt_u32 s89, 54
    s_cselect_b32 s85, 2, 0
    s_cselect_b32 s75, 0, s75
    s_sub_u32 s88, s89, 64
    s_cmp_lt_u32 s88, 10
    s_cselect_b32 s85, 1, s85
    s_cselect_b32 s75, 0, s75
    s_mov_b32 s44, s38
    s_mov_b32 s45, s39
    s_mov_b32 s46, 1966080
    s_mov_b32 s47, 0x20000
    s_mov_b32 s48, s16
    s_mov_b32 s49, s17
    s_mov_b32 s50, 1280
    s_mov_b32 s51, 0x20000
    s_mov_b32 s52, s24
    s_mov_b32 s53, s25
    s_mov_b32 s54, 5242880
    s_mov_b32 s55, 0x20000
    s_mov_b32 s56, s28
    s_mov_b32 s57, s29
    s_mov_b32 s58, 2211840
    s_mov_b32 s59, 0x20000
    s_mov_b32 s60, s30
    s_mov_b32 s61, s31
    s_mov_b32 s62, 2211840
    s_mov_b32 s63, 0x20000
    s_mov_b32 s64, s32
    s_mov_b32 s65, s33
    s_mov_b32 s66, 2211840
    s_mov_b32 s67, 0x20000
    s_mov_b32 s68, s34
    s_mov_b32 s69, s35
    s_mov_b32 s70, 1280
    s_mov_b32 s71, 0x20000
    s_lshl_b32 s31, s4, 14
    s_lshl_b32 s81, s7, 10
    s_add_u32 s31, s31, s81
    s_add_u32 s31, s31, 0x80000
    s_mov_b32 s16, 0xcccccccc
    s_mov_b32 s17, 0xcccccccc
    s_mov_b32 s18, 0xaaaaaaaa
    s_mov_b32 s19, 0xaaaaaaaa
    s_mov_b32 s26, 0xf000f
    s_mov_b32 s27, 0xf000f
    s_waitcnt vmcnt(4)
    buffer_load_dwordx4 v[124:127], v4, s[8:11], s78 offen offset:2048 nt
    s_waitcnt vmcnt(4)
    buffer_load_dwordx4 v[128:131], v4, s[8:11], s78 offen offset:3072 nt
    s_add_u32 s76, s76, 131072
    s_and_b32 s76, s76, 0x3fffff
    s_bfe_u32 s6, s76, 0x10011
    s_lshl_b32 s6, s6, 21
    s_xor_b32 s6, s6, s79
    s_and_b32 s5, s76, 0x1ffff
    s_xor_b32 s6, s6, s5
    s_lshr_b32 s5, s76, 18
    s_lshl_b32 s5, s5, 17
    s_xor_b32 s78, s6, s5
    s_waitcnt vmcnt(4)
    buffer_load_dwordx4 v[132:135], v4, s[8:11], s78 offen offset:0 nt
    s_waitcnt vmcnt(4)
    buffer_load_dwordx4 v[136:139], v4, s[8:11], s78 offen offset:1024 nt
    s_waitcnt vmcnt(4)
    buffer_load_dwordx4 v[140:143], v4, s[8:11], s78 offen offset:2048 nt
    s_waitcnt lgkmcnt(0)
    s_add_u32 s92, s92, 1
    s_and_b32 s93, s92, 0xff
    v_mov_b32 v16, s93
    s_waitcnt vmcnt(4)
    buffer_load_dwordx4 v[144:147], v4, s[8:11], s78 offen offset:3072 nt
    s_add_u32 s76, s76, 131072
    s_and_b32 s76, s76, 0x3fffff
    s_bfe_u32 s6, s76, 0x10011
    s_lshl_b32 s6, s6, 21
    s_xor_b32 s6, s6, s79
    s_and_b32 s5, s76, 0x1ffff
    s_xor_b32 s6, s6, s5
    s_lshr_b32 s5, s76, 18
    s_lshl_b32 s5, s5, 17
    s_xor_b32 s78, s6, s5
    s_waitcnt vmcnt(4)
    buffer_load_dwordx4 v[148:151], v4, s[8:11], s78 offen offset:0 nt
    s_waitcnt vmcnt(4)
    buffer_load_dwordx4 v[152:155], v4, s[8:11], s78 offen offset:1024 nt
    s_waitcnt vmcnt(4)
    buffer_load_dwordx4 v[156:159], v4, s[8:11], s78 offen offset:2048 nt
    s_waitcnt vmcnt(4)
    buffer_load_dwordx4 v[160:163], v4, s[8:11], s78 offen offset:3072 nt
    s_add_u32 s76, s76, 131072
    s_and_b32 s76, s76, 0x3fffff
    s_bfe_u32 s6, s76, 0x10011
    s_lshl_b32 s6, s6, 21
    s_xor_b32 s6, s6, s79
    s_and_b32 s5, s76, 0x1ffff
    s_xor_b32 s6, s6, s5
    s_lshr_b32 s5, s76, 18
    s_lshl_b32 s5, s5, 17
    s_xor_b32 s78, s6, s5
    s_waitcnt vmcnt(4)
    buffer_load_dwordx4 v[164:167], v4, s[8:11], s78 offen offset:0 nt
    s_waitcnt vmcnt(4)
    buffer_load_dwordx4 v[168:171], v4, s[8:11], s78 offen offset:1024 nt
    s_waitcnt vmcnt(4)
    buffer_load_dwordx4 v[172:175], v4, s[8:11], s78 offen offset:2048 nt
    s_waitcnt vmcnt(4)
    buffer_load_dwordx4 v[176:179], v4, s[8:11], s78 offen offset:3072 nt
    s_add_u32 s76, s76, 131072
    s_and_b32 s76, s76, 0x3fffff
    s_bfe_u32 s6, s76, 0x10011
    s_lshl_b32 s6, s6, 21
    s_xor_b32 s6, s6, s79
    s_and_b32 s5, s76, 0x1ffff
    s_xor_b32 s6, s6, s5
    s_lshr_b32 s5, s76, 18
    s_lshl_b32 s5, s5, 17
    s_xor_b32 s78, s6, s5
    s_waitcnt vmcnt(4)
    buffer_load_dwordx4 v[180:183], v4, s[8:11], s78 offen offset:0 nt
    s_waitcnt vmcnt(4)
    buffer_load_dwordx4 v[184:187], v4, s[8:11], s78 offen offset:1024 nt
    s_waitcnt vmcnt(4)
    buffer_load_dwordx4 v[188:191], v4, s[8:11], s78 offen offset:2048 nt
    s_waitcnt vmcnt(4)
    buffer_load_dwordx4 v[192:195], v4, s[8:11], s78 offen offset:3072 nt
    s_add_u32 s76, s76, 131072
    s_and_b32 s76, s76, 0x3fffff
    s_bfe_u32 s6, s76, 0x10011
    s_lshl_b32 s6, s6, 21
    s_xor_b32 s6, s6, s79
    s_and_b32 s5, s76, 0x1ffff
    s_xor_b32 s6, s6, s5
    s_lshr_b32 s5, s76, 18
    s_lshl_b32 s5, s5, 17
    s_xor_b32 s78, s6, s5
    s_waitcnt vmcnt(4)
    buffer_load_dwordx4 v[196:199], v4, s[8:11], s78 offen offset:0 nt
    s_waitcnt vmcnt(4)
    buffer_load_dwordx4 v[200:203], v4, s[8:11], s78 offen offset:1024 nt
    s_waitcnt vmcnt(4)
    buffer_load_dwordx4 v[204:207], v4, s[8:11], s78 offen offset:2048 nt
    s_waitcnt vmcnt(4)
    buffer_load_dwordx4 v[208:211], v4, s[8:11], s78 offen offset:3072 nt
    s_barrier
    s_branch L_qread
L_pro_h:
    v_lshrrev_b32 v2, 4, v1
    v_and_b32 v3, 15, v1
    s_cmp_lg_u32 s3, 2
    s_cbranch_scc1 L_nocp
    s_getpc_b64 s[96:97]
L_pcc:
    s_add_u32 s96, s96, L_qread-L_pcc
    s_addc_u32 s97, s97, 0
    s_and_b32 s81, s4, 3
    s_lshl_b32 s81, s81, 7
    v_lshlrev_b32 v7, 9, v1
    v_add_u32 v7, s81, v7
    v_min_u32 v7, L_end-L_qread, v7
    global_load_dword v8, v7, s[96:97]
L_nocp:
    s_cmp_lg_u32 s3, 0
    s_cbranch_scc1 L_q
    s_lshl_b32 s81, s4, 8
    s_mul_i32 s82, s7, 655360
    s_add_u32 s81, s81, s82
    s_mov_b32 s42, 655360
    s_mov_b32 s43, 0x20000
    s_mov_b32 s50, 1280
    s_mov_b32 s51, 0x20000
    v_lshlrev_b32 v7, 13, v2
    v_lshl_add_u32 v7, v3, 4, v7
    v_lshlrev_b32 v8, 2, v1
    v_lshl_add_u32 v9, v3, 2, v2
    v_lshlrev_b32 v9, 1, v9
    s_mul_i32 s83, s7, 160
    s_waitcnt lgkmcnt(0)
    s_mov_b32 s48, s16
    s_mov_b32 s49, s17
    s_add_u32 s40, s22, s81
    s_addc_u32 s41, s23, 0
    buffer_load_dword v68, v8, s[48:51], 0 offen offset:0
    buffer_load_dword v69, v8, s[48:51], 0 offen offset:256
    buffer_load_dword v70, v8, s[48:51], 0 offen offset:512
    buffer_load_dword v71, v8, s[48:51], 0 offen offset:768
    buffer_load_dword v72, v8, s[48:51], 0 offen offset:1024
    buffer_load_ushort v73, v9, s[48:51], s83 offen
    buffer_load_ushort v74, v9, s[48:51], s83 offen offset:128
    buffer_load_dwordx4 v[84:87], v7, s[40:43], 0 offen nt
    s_mov_b32 s81, 32768
    buffer_load_dwordx4 v[88:91], v7, s[40:43], s81 offen nt
    s_mov_b32 s81, 65536
    buffer_load_dwordx4 v[92:95], v7, s[40:43], s81 offen nt
    s_mov_b32 s81, 98304
    buffer_load_dwordx4 v[96:99], v7, s[40:43], s81 offen nt
    s_mov_b32 s81, 131072
    buffer_load_dwordx4 v[100:103], v7, s[40:43], s81 offen nt
    s_mov_b32 s81, 163840
    buffer_load_dwordx4 v[104:107], v7, s[40:43], s81 offen nt
    s_mov_b32 s81, 196608
    buffer_load_dwordx4 v[108:111], v7, s[40:43], s81 offen nt
    s_mov_b32 s81, 229376
    buffer_load_dwordx4 v[112:115], v7, s[40:43], s81 offen nt
    s_mov_b32 s81, 262144
    buffer_load_dwordx4 v[116:119], v7, s[40:43], s81 offen nt
    s_mov_b32 s81, 294912
    buffer_load_dwordx4 v[120:123], v7, s[40:43], s81 offen nt
    s_mov_b32 s81, 327680
    buffer_load_dwordx4 v[124:127], v7, s[40:43], s81 offen nt
    s_mov_b32 s81, 360448
    buffer_load_dwordx4 v[128:131], v7, s[40:43], s81 offen nt
    s_mov_b32 s81, 393216
    buffer_load_dwordx4 v[132:135], v7, s[40:43], s81 offen nt
    s_mov_b32 s81, 425984
    buffer_load_dwordx4 v[136:139], v7, s[40:43], s81 offen nt
    s_mov_b32 s81, 458752
    buffer_load_dwordx4 v[140:143], v7, s[40:43], s81 offen nt
    s_mov_b32 s81, 491520
    buffer_load_dwordx4 v[144:147], v7, s[40:43], s81 offen nt
    s_mov_b32 s81, 524288
    buffer_load_dwordx4 v[148:151], v7, s[40:43], s81 offen nt
    s_mov_b32 s81, 557056
    buffer_load_dwordx4 v[152:155], v7, s[40:43], s81 offen nt
    s_mov_b32 s81, 589824
    buffer_load_dwordx4 v[156:159], v7, s[40:43], s81 offen nt
    s_mov_b32 s81, 622592
    buffer_load_dwordx4 v[160:163], v7, s[40:43], s81 offen nt
L_q:
    s_load_dwordx16 s[24:39], s[0:1], 32
    s_getpc_b64 s[96:97]
L_pch:
    s_add_u32 s96, s96, L_tab-L_pch
    s_addc_u32 s97, s97, 0
    s_and_b32 s81, s2, 0xfc
    s_load_dword s101, s[96:97], s81
    v_lshrrev_b32 v2, 4, v1
    v_and_b32 v3, 15, v1
    v_mov_b32 v20, 0
    s_mov_b32 s73, s4
    s_mul_i32 s73, s73, 4352
    s_add_u32 s73, s73, 4096
    s_mov_b32 s94, 0x3fb8aa3b
    s_mov_b32 s95, 0xffff0000
    s_mov_b32 s90, 0xffffff00
    s_mov_b32 s84, s2
    v_add_u32 v5, 4096, v4
    v_and_b32 v11, 1, v3
    v_lshlrev_b32 v11, 4, v11
    v_mov_b32 v12, 0xffff
    v_lshlrev_b32 v11, v11, v12
    v_bfe_u32 v12, v3, 1, 2
    v_cmp_eq_u32 vcc, 0, v12
    s_nop 1
    v_cndmask_b32 v24, 0, v11, vcc
    v_cmp_eq_u32 vcc, 1, v12
    s_nop 1
    v_cndmask_b32 v25, 0, v11, vcc
    v_cmp_eq_u32 vcc, 2, v12
    s_nop 1
    v_cndmask_b32 v26, 0, v11, vcc
    v_cmp_eq_u32 vcc, 3, v12
    s_nop 1
    v_cndmask_b32 v27, 0, v11, vcc
    v_lshlrev_b32 v14, 5, v3
    v_lshl_add_u32 v14, v2, 4, v14
    s_waitcnt lgkmcnt(0)
    s_load_dword s92, s[38:39], 0
    s_add_u32 s12, s20, s80
    s_addc_u32 s13, s21, 0
    s_mov_b32 s14, 0x400000
    s_mov_b32 s15, 0x20000
    s_mov_b32 s75, 0
    s_and_b32 s87, s2, 7
    s_and_b32 s81, s2, 3
    s_lshl_b32 s81, s81, 3
    s_lshr_b32 s89, s101, s81
    s_and_b32 s89, s89, 0xff
    s_cmp_lt_u32 s89, 54
    s_cselect_b32 s85, 2, 0
    s_cselect_b32 s75, 0, s75
    s_sub_u32 s88, s89, 64
    s_cmp_lt_u32 s88, 10
    s_cselect_b32 s85, 1, s85
    s_cselect_b32 s75, 0, s75
    s_mov_b32 s44, s38
    s_mov_b32 s45, s39
    s_mov_b32 s46, 1966080
    s_mov_b32 s47, 0x20000
    s_mov_b32 s48, s16
    s_mov_b32 s49, s17
    s_mov_b32 s50, 1280
    s_mov_b32 s51, 0x20000
    s_mov_b32 s52, s24
    s_mov_b32 s53, s25
    s_mov_b32 s54, 5242880
    s_mov_b32 s55, 0x20000
    s_mov_b32 s56, s28
    s_mov_b32 s57, s29
    s_mov_b32 s58, 2211840
    s_mov_b32 s59, 0x20000
    s_mov_b32 s60, s30
    s_mov_b32 s61, s31
    s_mov_b32 s62, 2211840
    s_mov_b32 s63, 0x20000
    s_mov_b32 s64, s32
    s_mov_b32 s65, s33
    s_mov_b32 s66, 2211840
    s_mov_b32 s67, 0x20000
    s_mov_b32 s68, s34
    s_mov_b32 s69, s35
    s_mov_b32 s70, 1280
    s_mov_b32 s71, 0x20000
    s_lshl_b32 s31, s4, 14
    s_lshl_b32 s81, s7, 10
    s_add_u32 s31, s31, s81
    s_add_u32 s31, s31, 0x80000
    s_mov_b32 s16, 0xcccccccc
    s_mov_b32 s17, 0xcccccccc
    s_mov_b32 s18, 0xaaaaaaaa
    s_mov_b32 s19, 0xaaaaaaaa
    s_mov_b32 s26, 0xf000f
    s_mov_b32 s27, 0xf000f
    s_waitcnt lgkmcnt(0)
    s_add_u32 s92, s92, 1
    s_and_b32 s93, s92, 0xff
    v_mov_b32 v16, s93
    s_cmp_eq_u32 s3, 0
    s_cbranch_scc1 L_q2
    s_barrier
    s_branch L_hdma
L_q2:
    ds_write_b32 v20, v20 offset:256
    ds_write_b32 v20, v20 offset:260
    ds_write_b32 v20, v20 offset:264
    ds_write_b32 v20, v20 offset:268
    ds_write_b32 v20, v20 offset:276
    ds_write_b32 v20, v20 offset:280
    ds_write_b32 v20, v20 offset:284
    ds_write_b32 v20, v20 offset:288
    s_mov_b32 s81, s7
    s_lshl_b32 s81, s81, 2
    s_add_u32 s81, s81, s73
    v_mov_b32 v11, s98
    s_mov_b64 exec, 1
    buffer_store_dword v11, v20, s[44:47], s81 offen offset:512 sc1
    s_mov_b64 exec, -1
    s_waitcnt vmcnt(21)
    v_lshlrev_b32 v52, 16, v68
    v_and_b32 v53, s95, v68
    v_lshlrev_b32 v54, 16, v69
    v_and_b32 v55, s95, v69
    v_lshlrev_b32 v56, 16, v70
    v_and_b32 v57, s95, v70
    v_lshlrev_b32 v58, 16, v71
    v_and_b32 v59, s95, v71
    v_lshlrev_b32 v60, 16, v72
    v_and_b32 v61, s95, v72
    v_add_f32 v6, v52, v53
    v_add_f32 v6, v6, v54
    v_add_f32 v6, v6, v55
    v_add_f32 v6, v6, v56
    v_add_f32 v6, v6, v57
    v_add_f32 v6, v6, v58
    v_add_f32 v6, v6, v59
    v_add_f32 v6, v6, v60
    v_add_f32 v6, v6, v61
    s_nop 1
    v_add_f32_dpp v6, v6, v6 row_ror:8 row_mask:0xf bank_mask:0xf
    s_nop 1
    v_add_f32_dpp v6, v6, v6 row_ror:4 row_mask:0xf bank_mask:0xf
    s_nop 1
    v_add_f32_dpp v6, v6, v6 row_ror:2 row_mask:0xf bank_mask:0xf
    s_nop 1
    v_add_f32_dpp v6, v6, v6 row_ror:1 row_mask:0xf bank_mask:0xf
    v_mov_b32 v8, v6
    s_nop 1
    v_permlane16_swap_b32 v6, v8
    v_add_f32 v6, v6, v8
    v_mov_b32 v8, v6
    s_nop 1
    v_permlane32_swap_b32 v6, v8
    v_add_f32 v6, v6, v8
    v_mul_f32 v6, 0x3acccccd, v6
    v_sub_f32 v52, v52, v6
    v_sub_f32 v53, v53, v6
    v_sub_f32 v54, v54, v6
    v_sub_f32 v55, v55, v6
    v_sub_f32 v56, v56, v6
    v_sub_f32 v57, v57, v6
    v_sub_f32 v58, v58, v6
    v_sub_f32 v59, v59, v6
    v_sub_f32 v60, v60, v6
    v_sub_f32 v61, v61, v6
    v_mul_f32 v9, v52, v52
    v_fmac_f32 v9, v53, v53
    v_fmac_f32 v9, v54, v54
    v_fmac_f32 v9, v55, v55
    v_fmac_f32 v9, v56, v56
    v_fmac_f32 v9, v57, v57
    v_fmac_f32 v9, v58, v58
    v_fmac_f32 v9, v59, v59
    v_fmac_f32 v9, v60, v60
    v_fmac_f32 v9, v61, v61
    s_nop 1
    v_add_f32_dpp v9, v9, v9 row_ror:8 row_mask:0xf bank_mask:0xf
    s_nop 1
    v_add_f32_dpp v9, v9, v9 row_ror:4 row_mask:0xf bank_mask:0xf
    s_nop 1
    v_add_f32_dpp v9, v9, v9 row_ror:2 row_mask:0xf bank_mask:0xf
    s_nop 1
    v_add_f32_dpp v9, v9, v9 row_ror:1 row_mask:0xf bank_mask:0xf
    v_mov_b32 v8, v9
    s_nop 1
    v_permlane16_swap_b32 v9, v8
    v_add_f32 v9, v9, v8
    v_mov_b32 v8, v9
    s_nop 1
    v_permlane32_swap_b32 v9, v8
    v_add_f32 v9, v9, v8
    v_mul_f32 v9, 0x3acccccd, v9
    v_cvt_pk_bf16_f32 v11, v9, v9
    v_lshlrev_b32 v11, 16, v11
    v_cvt_pk_bf16_f32 v10, v6, v6
    v_lshlrev_b32 v10, 16, v10
    v_add_f32 v11, 0x3727c5ac, v11
    v_cvt_pk_bf16_f32 v11, v11, v11
    v_lshlrev_b32 v11, 16, v11
    v_sqrt_f32 v11, v11
    s_nop 0
    v_cvt_pk_bf16_f32 v11, v11, v11
    v_lshlrev_b32 v11, 16, v11
    v_rcp_f32 v12, v11
    v_lshlrev_b32 v73, 16, v73
    v_lshlrev_b32 v74, 16, v74
    v_sub_f32 v73, v73, v10
    v_sub_f32 v74, v74, v10
    v_cvt_pk_bf16_f32 v73, v73, v73
    v_cvt_pk_bf16_f32 v74, v74, v74
    v_lshlrev_b32 v73, 16, v73
    v_lshlrev_b32 v74, 16, v74
    v_mul_f32 v7, v73, v12
    v_mul_f32 v8, v74, v12
    v_fma_f32 v73, -v7, v11, v73
    v_fma_f32 v74, -v8, v11, v74
    v_fma_f32 v73, v73, v12, v7
    v_fma_f32 v74, v74, v12, v8
    v_cvt_pk_bf16_f32 v73, v73, v73
    v_cvt_pk_bf16_f32 v74, v74, v74
    s_nop 0
    v_and_b32_dpp v28, v73, v24 row_newbcast:0 row_mask:0xf bank_mask:0xf
    v_and_b32_dpp v29, v73, v25 row_newbcast:0 row_mask:0xf bank_mask:0xf
    v_and_b32_dpp v30, v73, v26 row_newbcast:0 row_mask:0xf bank_mask:0xf
    v_and_b32_dpp v31, v73, v27 row_newbcast:0 row_mask:0xf bank_mask:0xf
    v_and_b32_dpp v32, v73, v24 row_newbcast:1 row_mask:0xf bank_mask:0xf
    v_and_b32_dpp v33, v73, v25 row_newbcast:1 row_mask:0xf bank_mask:0xf
    v_and_b32_dpp v34, v73, v26 row_newbcast:1 row_mask:0xf bank_mask:0xf
    v_and_b32_dpp v35, v73, v27 row_newbcast:1 row_mask:0xf bank_mask:0xf
    s_waitcnt vmcnt(19)
    v_mfma_f32_16x16x32_bf16 v[36:39], v[28:31], v[84:87], 0
    v_and_b32_dpp v28, v73, v24 row_newbcast:2 row_mask:0xf bank_mask:0xf
    v_and_b32_dpp v29, v73, v25 row_newbcast:2 row_mask:0xf bank_mask:0xf
    v_and_b32_dpp v30, v73, v26 row_newbcast:2 row_mask:0xf bank_mask:0xf
    v_and_b32_dpp v31, v73, v27 row_newbcast:2 row_mask:0xf bank_mask:0xf
    v_mfma_f32_16x16x32_bf16 v[36:39], v[32:35], v[88:91], v[36:39]
    v_and_b32_dpp v32, v73, v24 row_newbcast:3 row_mask:0xf bank_mask:0xf
    v_and_b32_dpp v33, v73, v25 row_newbcast:3 row_mask:0xf bank_mask:0xf
    v_and_b32_dpp v34, v73, v26 row_newbcast:3 row_mask:0xf bank_mask:0xf
    v_and_b32_dpp v35, v73, v27 row_newbcast:3 row_mask:0xf bank_mask:0xf
    s_waitcnt vmcnt(17)
    v_mfma_f32_16x16x32_bf16 v[36:39], v[28:31], v[92:95], v[36:39]
    v_and_b32_dpp v28, v73, v24 row_newbcast:4 row_mask:0xf bank_mask:0xf
    v_and_b32_dpp v29, v73, v25 row_newbcast:4 row_mask:0xf bank_mask:0xf
    v_and_b32_dpp v30, v73, v26 row_newbcast:4 row_mask:0xf bank_mask:0xf
    v_and_b32_dpp v31, v73, v27 row_newbcast:4 row_mask:0xf bank_mask:0xf
    v_mfma_f32_16x16x32_bf16 v[36:39], v[32:35], v[96:99], v[36:39]
    v_and_b32_dpp v32, v73, v24 row_newbcast:5 row_mask:0xf bank_mask:0xf
    v_and_b32_dpp v33, v73, v25 row_newbcast:5 row_mask:0xf bank_mask:0xf
    v_and_b32_dpp v34, v73, v26 row_newbcast:5 row_mask:0xf bank_mask:0xf
    v_and_b32_dpp v35, v73, v27 row_newbcast:5 row_mask:0xf bank_mask:0xf
    s_waitcnt vmcnt(15)
    v_mfma_f32_16x16x32_bf16 v[36:39], v[28:31], v[100:103], v[36:39]
    v_and_b32_dpp v28, v73, v24 row_newbcast:6 row_mask:0xf bank_mask:0xf
    v_and_b32_dpp v29, v73, v25 row_newbcast:6 row_mask:0xf bank_mask:0xf
    v_and_b32_dpp v30, v73, v26 row_newbcast:6 row_mask:0xf bank_mask:0xf
    v_and_b32_dpp v31, v73, v27 row_newbcast:6 row_mask:0xf bank_mask:0xf
    v_mfma_f32_16x16x32_bf16 v[36:39], v[32:35], v[104:107], v[36:39]
    v_and_b32_dpp v32, v73, v24 row_newbcast:7 row_mask:0xf bank_mask:0xf
    v_and_b32_dpp v33, v73, v25 row_newbcast:7 row_mask:0xf bank_mask:0xf
    v_and_b32_dpp v34, v73, v26 row_newbcast:7 row_mask:0xf bank_mask:0xf
    v_and_b32_dpp v35, v73, v27 row_newbcast:7 row_mask:0xf bank_mask:0xf
    s_waitcnt vmcnt(13)
    v_mfma_f32_16x16x32_bf16 v[36:39], v[28:31], v[108:111], v[36:39]
    v_and_b32_dpp v28, v73, v24 row_newbcast:8 row_mask:0xf bank_mask:0xf
    v_and_b32_dpp v29, v73, v25 row_newbcast:8 row_mask:0xf bank_mask:0xf
    v_and_b32_dpp v30, v73, v26 row_newbcast:8 row_mask:0xf bank_mask:0xf
    v_and_b32_dpp v31, v73, v27 row_newbcast:8 row_mask:0xf bank_mask:0xf
    v_mfma_f32_16x16x32_bf16 v[36:39], v[32:35], v[112:115], v[36:39]
    v_and_b32_dpp v32, v73, v24 row_newbcast:9 row_mask:0xf bank_mask:0xf
    v_and_b32_dpp v33, v73, v25 row_newbcast:9 row_mask:0xf bank_mask:0xf
    v_and_b32_dpp v34, v73, v26 row_newbcast:9 row_mask:0xf bank_mask:0xf
    v_and_b32_dpp v35, v73, v27 row_newbcast:9 row_mask:0xf bank_mask:0xf
    s_waitcnt vmcnt(11)
    v_mfma_f32_16x16x32_bf16 v[36:39], v[28:31], v[116:119], v[36:39]
    v_and_b32_dpp v28, v73, v24 row_newbcast:10 row_mask:0xf bank_mask:0xf
    v_and_b32_dpp v29, v73, v25 row_newbcast:10 row_mask:0xf bank_mask:0xf
    v_and_b32_dpp v30, v73, v26 row_newbcast:10 row_mask:0xf bank_mask:0xf
    v_and_b32_dpp v31, v73, v27 row_newbcast:10 row_mask:0xf bank_mask:0xf
    v_mfma_f32_16x16x32_bf16 v[36:39], v[32:35], v[120:123], v[36:39]
    v_and_b32_dpp v32, v73, v24 row_newbcast:11 row_mask:0xf bank_mask:0xf
    v_and_b32_dpp v33, v73, v25 row_newbcast:11 row_mask:0xf bank_mask:0xf
    v_and_b32_dpp v34, v73, v26 row_newbcast:11 row_mask:0xf bank_mask:0xf
    v_and_b32_dpp v35, v73, v27 row_newbcast:11 row_mask:0xf bank_mask:0xf
    s_waitcnt vmcnt(9)
    v_mfma_f32_16x16x32_bf16 v[36:39], v[28:31], v[124:127], v[36:39]
    v_and_b32_dpp v28, v73, v24 row_newbcast:12 row_mask:0xf bank_mask:0xf
    v_and_b32_dpp v29, v73, v25 row_newbcast:12 row_mask:0xf bank_mask:0xf
    v_and_b32_dpp v30, v73, v26 row_newbcast:12 row_mask:0xf bank_mask:0xf
    v_and_b32_dpp v31, v73, v27 row_newbcast:12 row_mask:0xf bank_mask:0xf
    v_mfma_f32_16x16x32_bf16 v[36:39], v[32:35], v[128:131], v[36:39]
    v_and_b32_dpp v32, v73, v24 row_newbcast:13 row_mask:0xf bank_mask:0xf
    v_and_b32_dpp v33, v73, v25 row_newbcast:13 row_mask:0xf bank_mask:0xf
    v_and_b32_dpp v34, v73, v26 row_newbcast:13 row_mask:0xf bank_mask:0xf
    v_and_b32_dpp v35, v73, v27 row_newbcast:13 row_mask:0xf bank_mask:0xf
    s_waitcnt vmcnt(7)
    v_mfma_f32_16x16x32_bf16 v[36:39], v[28:31], v[132:135], v[36:39]
    v_and_b32_dpp v28, v73, v24 row_newbcast:14 row_mask:0xf bank_mask:0xf
    v_and_b32_dpp v29, v73, v25 row_newbcast:14 row_mask:0xf bank_mask:0xf
    v_and_b32_dpp v30, v73, v26 row_newbcast:14 row_mask:0xf bank_mask:0xf
    v_and_b32_dpp v31, v73, v27 row_newbcast:14 row_mask:0xf bank_mask:0xf
    v_mfma_f32_16x16x32_bf16 v[36:39], v[32:35], v[136:139], v[36:39]
    v_and_b32_dpp v32, v73, v24 row_newbcast:15 row_mask:0xf bank_mask:0xf
    v_and_b32_dpp v33, v73, v25 row_newbcast:15 row_mask:0xf bank_mask:0xf
    v_and_b32_dpp v34, v73, v26 row_newbcast:15 row_mask:0xf bank_mask:0xf
    v_and_b32_dpp v35, v73, v27 row_newbcast:15 row_mask:0xf bank_mask:0xf
    s_waitcnt vmcnt(5)
    v_mfma_f32_16x16x32_bf16 v[36:39], v[28:31], v[140:143], v[36:39]
    v_and_b32_dpp v28, v74, v24 row_newbcast:0 row_mask:0xf bank_mask:0xf
    v_and_b32_dpp v29, v74, v25 row_newbcast:0 row_mask:0xf bank_mask:0xf
    v_and_b32_dpp v30, v74, v26 row_newbcast:0 row_mask:0xf bank_mask:0xf
    v_and_b32_dpp v31, v74, v27 row_newbcast:0 row_mask:0xf bank_mask:0xf
    v_mfma_f32_16x16x32_bf16 v[36:39], v[32:35], v[144:147], v[36:39]
    v_and_b32_dpp v32, v74, v24 row_newbcast:1 row_mask:0xf bank_mask:0xf
    v_and_b32_dpp v33, v74, v25 row_newbcast:1 row_mask:0xf bank_mask:0xf
    v_and_b32_dpp v34, v74, v26 row_newbcast:1 row_mask:0xf bank_mask:0xf
    v_and_b32_dpp v35, v74, v27 row_newbcast:1 row_mask:0xf bank_mask:0xf
    s_waitcnt vmcnt(3)
    v_mfma_f32_16x16x32_bf16 v[36:39], v[28:31], v[148:151], v[36:39]
    v_and_b32_dpp v28, v74, v24 row_newbcast:2 row_mask:0xf bank_mask:0xf
    v_and_b32_dpp v29, v74, v25 row_newbcast:2 row_mask:0xf bank_mask:0xf
    v_and_b32_dpp v30, v74, v26 row_newbcast:2 row_mask:0xf bank_mask:0xf
    v_and_b32_dpp v31, v74, v27 row_newbcast:2 row_mask:0xf bank_mask:0xf
    v_mfma_f32_16x16x32_bf16 v[36:39], v[32:35], v[152:155], v[36:39]
    v_and_b32_dpp v32, v74, v24 row_newbcast:3 row_mask:0xf bank_mask:0xf
    v_and_b32_dpp v33, v74, v25 row_newbcast:3 row_mask:0xf bank_mask:0xf
    v_and_b32_dpp v34, v74, v26 row_newbcast:3 row_mask:0xf bank_mask:0xf
    v_and_b32_dpp v35, v74, v27 row_newbcast:3 row_mask:0xf bank_mask:0xf
    s_waitcnt vmcnt(1)
    v_mfma_f32_16x16x32_bf16 v[36:39], v[28:31], v[156:159], v[36:39]
    v_mfma_f32_16x16x32_bf16 v[36:39], v[32:35], v[160:163], v[36:39]
    s_lshl_b32 s80, s84, 9
    s_add_u32 s80, s80, 0x40000
    s_nop 5
    v_add_u32 v36, 0x80, v36
    v_add_u32 v37, 0x80, v37
    v_add_u32 v38, 0x80, v38
    v_add_u32 v39, 0x80, v39
    v_and_or_b32 v36, v36, s90, v16
    v_and_or_b32 v37, v37, s90, v16
    v_and_or_b32 v38, v38, s90, v16
    v_and_or_b32 v39, v39, s90, v16
    s_waitcnt vmcnt(0)
    s_mov_b32 exec_hi, 0
    buffer_store_dwordx4 v[36:39], v14, s[44:47], s80 offen sc1
    s_mov_b64 exec, -1
    s_lshl_b32 s80, s4, 12
    s_add_u32 s80, s80, 0x40000
    s_mov_b32 s91, 3000000
    v_and_b32 v8, 7, v1
    v_lshlrev_b32 v8, 2, v8
L_qpoll:
    buffer_load_dwordx4 v[180:183], v4, s[44:47], s80 offen offset:0 sc1
    buffer_load_dwordx4 v[184:187], v4, s[44:47], s80 offen offset:1024 sc1
    buffer_load_dwordx4 v[188:191], v4, s[44:47], s80 offen offset:2048 sc1
    buffer_load_dwordx4 v[192:195], v4, s[44:47], s80 offen offset:3072 sc1
    buffer_load_dword v9, v8, s[44:47], s73 offen offset:512 sc1
    s_waitcnt vmcnt(0)
    v_xor_b32 v68, v16, v180
    v_xor_b32 v69, v16, v181
    v_xor_b32 v70, v16, v182
    v_xor_b32 v71, v16, v183
    v_xor_b32 v72, v16, v184
    v_xor_b32 v73, v16, v185
    v_xor_b32 v74, v16, v186
    v_xor_b32 v75, v16, v187
    v_xor_b32 v76, v16, v188
    v_xor_b32 v77, v16, v189
    v_xor_b32 v78, v16, v190
    v_xor_b32 v79, v16, v191
    v_xor_b32 v80, v16, v192
    v_xor_b32 v81, v16, v193
    v_xor_b32 v82, v16, v194
    v_xor_b32 v83, v16, v195
    v_or3_b32 v13, v68, v69, v70
    v_or3_b32 v13, v13, v71, v72
    v_or3_b32 v13, v13, v73, v74
    v_or3_b32 v13, v13, v75, v76
    v_or3_b32 v13, v13, v77, v78
    v_or3_b32 v13, v13, v79, v80
    v_or3_b32 v13, v13, v81, v82
    v_or_b32 v13, v13, v83
    v_and_b32 v13, 0xff, v13
    v_cmp_ne_u32 vcc, 0, v13
    s_cbranch_vccz L_qpoll_done
    s_sleep 4
    s_sub_u32 s91, s91, 1
    s_cbranch_scc0 L_qpoll
L_qpoll_done:
    v_add_f32 v68, v68, v72
    v_add_f32 v76, v76, v80
    v_add_f32 v69, v69, v73
    v_add_f32 v77, v77, v81
    v_add_f32 v70, v70, v74
    v_add_f32 v78, v78, v82
    v_add_f32 v71, v71, v75
    v_add_f32 v79, v79, v83
    v_add_f32 v68, v68, v76
    v_add_f32 v69, v69, v77
    v_add_f32 v70, v70, v78
    v_add_f32 v71, v71, v79
    v_and_b32 v6, 31, v1
    v_lshrrev_b32 v7, 5, v1
    v_permlane32_swap_b32 v68, v70
    v_permlane32_swap_b32 v69, v71
    v_lshl_add_u32 v6, v6, 1, v7
    v_add_f32 v68, v68, v70
    v_add_f32 v69, v69, v71
    v_lshlrev_b32 v6, 2, v6
    v_cvt_pk_bf16_f32 v68, v68, v69
    ds_write_b32 v6, v68 offset:0
    v_subrev_u32 v9, s98, v9
    v_mov_b32 v10, -200
    v_mov_b32 v11, 200
    v_med3_i32 v10, v9, v10, v11
    v_cmp_eq_u32 vcc, v9, v10
    s_nop 1
    v_cndmask_b32 v9, 0, v9, vcc
    s_nop 1
    v_add_u32_dpp v9, v9, v9 quad_perm:[1,0,3,2] row_mask:0xf bank_mask:0xf
    s_nop 1
    v_add_u32_dpp v9, v9, v9 quad_perm:[2,3,0,1] row_mask:0xf bank_mask:0xf
    s_nop 1
    v_add_u32_dpp v9, v9, v9 row_half_mirror row_mask:0xf bank_mask:0xf
    v_ashrrev_i32 v9, 3, v9
    v_add_u32 v9, s98, v9
    ds_write_b32 v20, v9 offset:292
    s_waitcnt lgkmcnt(0)
    s_barrier
L_hdma:
    s_cmp_lg_u32 s85, 0
    s_cbranch_scc1 L_noprobe
    s_cmp_gt_u32 s2, 15
    s_cbranch_scc1 L_fin
    s_lshl_b32 s80, s2, 2
    s_add_u32 s80, s80, s3
    s_lshr_b32 s81, s80, 3
    s_lshl_b32 s81, s81, 14
    s_and_b32 s80, s80, 7
    s_lshl_b32 s80, s80, 10
    s_add_u32 s80, s80, s81
    s_add_u32 s80, s80, 0x1a0000
    s_mov_b32 s83, 0
    s_mov_b32 s91, 5
L_probe:
    s_add_u32 s81, s80, 0x2000
    s_memtime s[96:97]
    s_waitcnt lgkmcnt(0)
    s_load_dword s101, s[38:39], s80
    s_waitcnt lgkmcnt(0)
    s_memtime s[98:99]
    s_waitcnt lgkmcnt(0)
    s_load_dword s101, s[38:39], s81
    s_sub_u32 s82, s98, s96
    s_min_u32 s82, s82, 1400
    s_add_u32 s83, s83, s82
    s_waitcnt lgkmcnt(0)
    s_memtime s[96:97]
    s_waitcnt lgkmcnt(0)
    s_sub_u32 s82, s96, s98
    s_min_u32 s82, s82, 1400
    s_sub_u32 s83, s83, s82
    s_add_u32 s80, s80, 128
    s_sub_u32 s91, s91, 1
    s_cmp_lg_u32 s91, 0
    s_cbranch_scc1 L_probe
    s_getreg_b32 s81, hwreg(HW_REG_XCC_ID)
    s_sub_u32 s82, 0, s83
    s_bitcmp1_b32 s81, 2
    s_cselect_b32 s83, s82, s83
    s_lshl_b32 s83, s83, 16
    s_and_b32 s81, s92, 0xffff
    s_or_b32 s83, s83, s81
    v_mov_b32 v6, s83
    s_lshl_b32 s80, s2, 7
    s_lshl_b32 s81, s3, 2
    s_add_u32 s80, s80, s81
    s_add_u32 s80, s80, 0x30000
    s_mov_b64 exec, 1
    buffer_store_dword v6, v20, s[44:47], s80 offen sc1
    s_mov_b64 exec, -1
    s_branch L_fin
L_noprobe:
    s_cmp_eq_u32 s85, 2
    s_cbranch_scc1 L_dma_g
    s_cmp_eq_u32 s85, 1
    s_cbranch_scc0 L_dma_done
    v_lshrrev_b32 v10, 3, v1
    v_mul_u32_u24 v10, 10240, v10
    v_and_b32 v7, 7, v1
    v_lshl_add_u32 v10, v7, 4, v10
    s_lshl_b32 s80, s87, 9
    s_lshl_b32 s81, s3, 6
    s_add_u32 s80, s80, s81
    s_mul_i32 s80, s80, 1280
    s_lshl_b32 s81, s88, 7
    s_add_u32 s80, s80, s81
    s_mul_i32 s83, s3, 10240
    s_add_u32 s83, s83, 20480
    s_add_u32 s81, s80, 327680
    s_add_u32 m0, s83, 0
    s_waitcnt vmcnt(7)
    buffer_load_dwordx4 v10, s[52:55], s81 offen nt lds
    s_add_u32 s81, s80, 328960
    s_add_u32 m0, s83, 4096
    s_waitcnt vmcnt(7)
    buffer_load_dwordx4 v10, s[52:55], s81 offen nt lds
    s_add_u32 s81, s80, 330240
    s_add_u32 m0, s83, 1024
    s_waitcnt vmcnt(7)
    buffer_load_dwordx4 v10, s[52:55], s81 offen nt lds
    s_add_u32 s81, s80, 331520
    s_add_u32 m0, s83, 5120
    s_waitcnt vmcnt(7)
    buffer_load_dwordx4 v10, s[52:55], s81 offen nt lds
    s_add_u32 s81, s80, 332800
    s_add_u32 m0, s83, 2048
    s_waitcnt vmcnt(7)
    buffer_load_dwordx4 v10, s[52:55], s81 offen nt lds
    s_add_u32 s81, s80, 334080
    s_add_u32 m0, s83, 6144
    s_waitcnt vmcnt(7)
    buffer_load_dwordx4 v10, s[52:55], s81 offen nt lds
    s_add_u32 s81, s80, 335360
    s_add_u32 m0, s83, 3072
    s_waitcnt vmcnt(7)
    buffer_load_dwordx4 v10, s[52:55], s81 offen nt lds
    s_add_u32 s81, s80, 336640
    s_add_u32 m0, s83, 7168
    s_waitcnt vmcnt(7)
    buffer_load_dwordx4 v10, s[52:55], s81 offen nt lds
    s_waitcnt vmcnt(0)
    s_mov_b64 exec, 1
    v_mov_b32 v12, 1
    ds_add_u32 v20, v12 offset:268
    s_mov_b64 exec, -1
    s_cmp_lg_u32 s3, 0
    s_cbranch_scc1 L_vote0
    s_mov_b32 s91, 90000000
L_gate0:
    ds_read_b32 v12, v20 offset:264
    s_waitcnt lgkmcnt(0)
    v_cmp_gt_u32 vcc, 4, v12
    s_cbranch_vccz L_gate0_done
    s_sleep 2
    s_sub_u32 s91, s91, 1
    s_cbranch_scc0 L_gate0
L_gate0_done:
    v_lshrrev_b32 v68, 2, v1
    v_and_b32 v69, 3, v1
    v_lshlrev_b32 v68, 7, v68
    v_lshl_add_u32 v68, v69, 2, v68
    s_mov_b32 s81, 0x30000
    buffer_load_dword v69, v68, s[44:47], s81 offen sc1
    s_and_b32 s81, s92, 0xffff
    s_waitcnt vmcnt(0)
    v_and_b32 v68, 0xffff, v69
    v_ashrrev_i32 v69, 16, v69
    v_cmp_eq_u32 vcc, s81, v68
    s_nop 1
    v_cndmask_b32 v69, 0, v69, vcc
    s_nop 1
    v_add_u32_dpp v69, v69, v69 row_ror:8 row_mask:0xf bank_mask:0xf
    s_nop 1
    v_add_u32_dpp v69, v69, v69 row_ror:4 row_mask:0xf bank_mask:0xf
    s_nop 1
    v_add_u32_dpp v69, v69, v69 row_ror:2 row_mask:0xf bank_mask:0xf
    s_nop 1
    v_add_u32_dpp v69, v69, v69 row_ror:1 row_mask:0xf bank_mask:0xf
    v_mov_b32 v70, v69
    s_nop 1
    v_permlane16_swap_b32 v69, v70
    v_add_u32 v69, v69, v70
    v_mov_b32 v70, v69
    s_nop 1
    v_permlane32_swap_b32 v69, v70
    v_add_u32 v69, v69, v70
    s_getreg_b32 s81, hwreg(HW_REG_XCC_ID)
    v_sub_u32 v68, 0, v69
    s_bitcmp1_b32 s81, 2
    s_cselect_b64 vcc, -1, 0
    v_cndmask_b32 v69, v69, v68, vcc
    ds_write_b32 v20, v69 offset:284
L_vote0:
    s_mov_b32 s91, 90000000
L_gate1:
    ds_read_b32 v12, v20 offset:256
    s_waitcnt lgkmcnt(0)
    v_cmp_gt_u32 vcc, 4, v12
    s_cbranch_vccz L_gate1_done
    s_sleep 2
    s_sub_u32 s91, s91, 1
    s_cbranch_scc0 L_gate1
L_gate1_done:
    s_add_u32 s81, s80, 0
    s_waitcnt vmcnt(7)
    buffer_load_dwordx4 v[84:87], v10, s[52:55], s81 offen nt
    s_add_u32 s81, s80, 1280
    s_waitcnt vmcnt(7)
    buffer_load_dwordx4 v[100:103], v10, s[52:55], s81 offen nt
    s_add_u32 s81, s80, 2560
    s_waitcnt vmcnt(7)
    buffer_load_dwordx4 v[88:91], v10, s[52:55], s81 offen nt
    s_add_u32 s81, s80, 3840
    s_waitcnt vmcnt(7)
    buffer_load_dwordx4 v[104:107], v10, s[52:55], s81 offen nt
    s_add_u32 s81, s80, 5120
    s_waitcnt vmcnt(7)
    buffer_load_dwordx4 v[92:95], v10, s[52:55], s81 offen nt
    s_add_u32 s81, s80, 6400
    s_waitcnt vmcnt(7)
    buffer_load_dwordx4 v[108:111], v10, s[52:55], s81 offen nt
    s_add_u32 s81, s80, 7680
    s_waitcnt vmcnt(7)
    buffer_load_dwordx4 v[96:99], v10, s[52:55], s81 offen nt
    s_add_u32 s81, s80, 8960
    s_waitcnt vmcnt(7)
    buffer_load_dwordx4 v[112:115], v10, s[52:55], s81 offen nt
    s_branch L_dma_done
L_dma_g:
    v_lshrrev_b32 v6, 3, v1
    v_mul_u32_u24 v6, 41472, v6
    v_and_b32 v11, 3, v1
    v_lshl_add_u32 v6, v11, 4, v6
    v_lshrrev_b32 v7, 3, v1
    v_mul_u32_u24 v7, 27648, v7
    v_and_b32 v11, 3, v1
    v_lshl_add_u32 v7, v11, 4, v7
    s_lshl_b32 s81, s89, 6
    s_mul_i32 s80, s3, 331776
    s_add_u32 s80, s80, s81
    s_mul_i32 s82, s3, 221184
    s_add_u32 s82, s82, s81
    s_mul_i32 s83, s3, 10240
    s_add_u32 s83, s83, 20480
    s_add_u32 s81, s82, 1327104
    s_add_u32 m0, s83, 0
    s_mov_b32 exec_lo, 0x0f0f0f0f
    s_mov_b32 exec_hi, 0x0f0f0f0f
    s_waitcnt vmcnt(7)
    buffer_load_dwordx4 v7, s[56:59], s81 offen  lds
    s_mov_b32 exec_lo, 0xf0f0f0f0
    s_mov_b32 exec_hi, 0xf0f0f0f0
    s_waitcnt vmcnt(7)
    buffer_load_dwordx4 v7, s[60:63], s81 offen  lds
    s_add_u32 s81, s82, 1334016
    s_add_u32 m0, s83, 1024
    s_mov_b32 exec_lo, 0x0f0f0f0f
    s_mov_b32 exec_hi, 0x0f0f0f0f
    s_waitcnt vmcnt(7)
    buffer_load_dwordx4 v7, s[56:59], s81 offen  lds
    s_mov_b32 exec_lo, 0xf0f0f0f0
    s_mov_b32 exec_hi, 0xf0f0f0f0
    s_waitcnt vmcnt(7)
    buffer_load_dwordx4 v7, s[60:63], s81 offen  lds
    s_add_u32 s81, s82, 1340928
    s_add_u32 m0, s83, 2048
    s_mov_b32 exec_lo, 0x0f0f0f0f
    s_mov_b32 exec_hi, 0x0f0f0f0f
    s_waitcnt vmcnt(7)
    buffer_load_dwordx4 v7, s[56:59], s81 offen  lds
    s_mov_b32 exec_lo, 0xf0f0f0f0
    s_mov_b32 exec_hi, 0xf0f0f0f0
    s_waitcnt vmcnt(7)
    buffer_load_dwordx4 v7, s[60:63], s81 offen  lds
    s_add_u32 s81, s82, 1347840
    s_add_u32 m0, s83, 3072
    s_mov_b32 exec_lo, 0x0f0f0f0f
    s_mov_b32 exec_hi, 0x0f0f0f0f
    s_waitcnt vmcnt(7)
    buffer_load_dwordx4 v7, s[56:59], s81 offen  lds
    s_mov_b32 exec_lo, 0xf0f0f0f0
    s_mov_b32 exec_hi, 0xf0f0f0f0
    s_waitcnt vmcnt(7)
    buffer_load_dwordx4 v7, s[60:63], s81 offen  lds
    s_add_u32 s81, s82, 1330560
    s_add_u32 m0, s83, 4096
    s_mov_b32 exec_lo, 0x0f0f0f0f
    s_mov_b32 exec_hi, 0x0f0f0f0f
    s_waitcnt vmcnt(7)
    buffer_load_dwordx4 v7, s[56:59], s81 offen  lds
    s_mov_b32 exec_lo, 0xf0f0f0f0
    s_mov_b32 exec_hi, 0xf0f0f0f0
    s_waitcnt vmcnt(7)
    buffer_load_dwordx4 v7, s[60:63], s81 offen  lds
    s_add_u32 s81, s82, 1337472
    s_add_u32 m0, s83, 5120
    s_mov_b32 exec_lo, 0x0f0f0f0f
    s_mov_b32 exec_hi, 0x0f0f0f0f
    s_waitcnt vmcnt(7)
    buffer_load_dwordx4 v7, s[56:59], s81 offen  lds
    s_mov_b32 exec_lo, 0xf0f0f0f0
    s_mov_b32 exec_hi, 0xf0f0f0f0
    s_waitcnt vmcnt(7)
    buffer_load_dwordx4 v7, s[60:63], s81 offen  lds
    s_add_u32 s81, s82, 1344384
    s_add_u32 m0, s83, 6144
    s_mov_b32 exec_lo, 0x0f0f0f0f
    s_mov_b32 exec_hi, 0x0f0f0f0f
    s_waitcnt vmcnt(7)
    buffer_load_dwordx4 v7, s[56:59], s81 offen  lds
    s_mov_b32 exec_lo, 0xf0f0f0f0
    s_mov_b32 exec_hi, 0xf0f0f0f0
    s_waitcnt vmcnt(7)
    buffer_load_dwordx4 v7, s[60:63], s81 offen  lds
    s_add_u32 s81, s82, 1351296
    s_add_u32 m0, s83, 7168
    s_mov_b32 exec_lo, 0x0f0f0f0f
    s_mov_b32 exec_hi, 0x0f0f0f0f
    s_waitcnt vmcnt(7)
    buffer_load_dwordx4 v7, s[56:59], s81 offen  lds
    s_mov_b32 exec_lo, 0xf0f0f0f0
    s_mov_b32 exec_hi, 0xf0f0f0f0
    s_waitcnt vmcnt(7)
    buffer_load_dwordx4 v7, s[60:63], s81 offen  lds
    s_waitcnt vmcnt(0)
    s_mov_b64 exec, 1
    v_mov_b32 v12, 1
    ds_add_u32 v20, v12 offset:268
    s_mov_b64 exec, -1
    s_add_u32 s81, s80, 0
    s_mov_b32 exec_lo, 0x0f0f0f0f
    s_mov_b32 exec_hi, 0x0f0f0f0f
    s_waitcnt vmcnt(7)
    buffer_load_dwordx4 v[84:87], v6, s[56:59], s81 offen
    s_mov_b32 exec_lo, 0xf0f0f0f0
    s_mov_b32 exec_hi, 0xf0f0f0f0
    s_waitcnt vmcnt(7)
    buffer_load_dwordx4 v[84:87], v6, s[60:63], s81 offen
    s_add_u32 s81, s80, 10368
    s_mov_b32 exec_lo, 0x0f0f0f0f
    s_mov_b32 exec_hi, 0x0f0f0f0f
    s_waitcnt vmcnt(7)
    buffer_load_dwordx4 v[88:91], v6, s[56:59], s81 offen
    s_mov_b32 exec_lo, 0xf0f0f0f0
    s_mov_b32 exec_hi, 0xf0f0f0f0
    s_waitcnt vmcnt(7)
    buffer_load_dwordx4 v[88:91], v6, s[60:63], s81 offen
    s_mov_b64 exec, -1
    s_cmp_lg_u32 s3, 0
    s_cbranch_scc1 L_vote1
    s_mov_b32 s91, 90000000
L_gate2:
    ds_read_b32 v12, v20 offset:264
    s_waitcnt lgkmcnt(0)
    v_cmp_gt_u32 vcc, 4, v12
    s_cbranch_vccz L_gate2_done
    s_sleep 2
    s_sub_u32 s91, s91, 1
    s_cbranch_scc0 L_gate2
L_gate2_done:
    v_lshrrev_b32 v68, 2, v1
    v_and_b32 v69, 3, v1
    v_lshlrev_b32 v68, 7, v68
    v_lshl_add_u32 v68, v69, 2, v68
    s_mov_b32 s81, 0x30000
    buffer_load_dword v69, v68, s[44:47], s81 offen sc1
    s_and_b32 s81, s92, 0xffff
    s_waitcnt vmcnt(0)
    v_and_b32 v68, 0xffff, v69
    v_ashrrev_i32 v69, 16, v69
    v_cmp_eq_u32 vcc, s81, v68
    s_nop 1
    v_cndmask_b32 v69, 0, v69, vcc
    s_nop 1
    v_add_u32_dpp v69, v69, v69 row_ror:8 row_mask:0xf bank_mask:0xf
    s_nop 1
    v_add_u32_dpp v69, v69, v69 row_ror:4 row_mask:0xf bank_mask:0xf
    s_nop 1
    v_add_u32_dpp v69, v69, v69 row_ror:2 row_mask:0xf bank_mask:0xf
    s_nop 1
    v_add_u32_dpp v69, v69, v69 row_ror:1 row_mask:0xf bank_mask:0xf
    v_mov_b32 v70, v69
    s_nop 1
    v_permlane16_swap_b32 v69, v70
    v_add_u32 v69, v69, v70
    v_mov_b32 v70, v69
    s_nop 1
    v_permlane32_swap_b32 v69, v70
    v_add_u32 v69, v69, v70
    s_getreg_b32 s81, hwreg(HW_REG_XCC_ID)
    v_sub_u32 v68, 0, v69
    s_bitcmp1_b32 s81, 2
    s_cselect_b64 vcc, -1, 0
    v_cndmask_b32 v69, v69, v68, vcc
    ds_write_b32 v20, v69 offset:284
L_vote1:
    s_mov_b32 s91, 90000000
L_gate3:
    ds_read_b32 v12, v20 offset:256
    s_waitcnt lgkmcnt(0)
    v_cmp_gt_u32 vcc, 4, v12
    s_cbranch_vccz L_gate3_done
    s_sleep 2
    s_sub_u32 s91, s91, 1
    s_cbranch_scc0 L_gate3
L_gate3_done:
    s_add_u32 s81, s80, 20736
    s_mov_b32 exec_lo, 0x0f0f0f0f
    s_mov_b32 exec_hi, 0x0f0f0f0f
    s_waitcnt vmcnt(7)
    buffer_load_dwordx4 v[92:95], v6, s[56:59], s81 offen
    s_mov_b32 exec_lo, 0xf0f0f0f0
    s_mov_b32 exec_hi, 0xf0f0f0f0
    s_waitcnt vmcnt(7)
    buffer_load_dwordx4 v[92:95], v6, s[60:63], s81 offen
    s_add_u32 s81, s80, 31104
    s_mov_b32 exec_lo, 0x0f0f0f0f
    s_mov_b32 exec_hi, 0x0f0f0f0f
    s_waitcnt vmcnt(7)
    buffer_load_dwordx4 v[96:99], v6, s[56:59], s81 offen
    s_mov_b32 exec_lo, 0xf0f0f0f0
    s_mov_b32 exec_hi, 0xf0f0f0f0
    s_waitcnt vmcnt(7)
    buffer_load_dwordx4 v[96:99], v6, s[60:63], s81 offen
    s_add_u32 s81, s80, 3456
    s_mov_b32 exec_lo, 0x0f0f0f0f
    s_mov_b32 exec_hi, 0x0f0f0f0f
    s_waitcnt vmcnt(7)
    buffer_load_dwordx4 v[100:103], v6, s[56:59], s81 offen
    s_mov_b32 exec_lo, 0xf0f0f0f0
    s_mov_b32 exec_hi, 0xf0f0f0f0
    s_waitcnt vmcnt(7)
    buffer_load_dwordx4 v[100:103], v6, s[60:63], s81 offen
    s_add_u32 s81, s80, 13824
    s_mov_b32 exec_lo, 0x0f0f0f0f
    s_mov_b32 exec_hi, 0x0f0f0f0f
    s_waitcnt vmcnt(7)
    buffer_load_dwordx4 v[104:107], v6, s[56:59], s81 offen
    s_mov_b32 exec_lo, 0xf0f0f0f0
    s_mov_b32 exec_hi, 0xf0f0f0f0
    s_waitcnt vmcnt(7)
    buffer_load_dwordx4 v[104:107], v6, s[60:63], s81 offen
    s_add_u32 s81, s80, 24192
    s_mov_b32 exec_lo, 0x0f0f0f0f
    s_mov_b32 exec_hi, 0x0f0f0f0f
    s_waitcnt vmcnt(7)
    buffer_load_dwordx4 v[108:111], v6, s[56:59], s81 offen
    s_mov_b32 exec_lo, 0xf0f0f0f0
    s_mov_b32 exec_hi, 0xf0f0f0f0
    s_waitcnt vmcnt(7)
    buffer_load_dwordx4 v[108:111], v6, s[60:63], s81 offen
    s_add_u32 s81, s80, 34560
    s_mov_b32 exec_lo, 0x0f0f0f0f
    s_mov_b32 exec_hi, 0x0f0f0f0f
    s_waitcnt vmcnt(7)
    buffer_load_dwordx4 v[112:115], v6, s[56:59], s81 offen
    s_mov_b32 exec_lo, 0xf0f0f0f0
    s_mov_b32 exec_hi, 0xf0f0f0f0
    s_waitcnt vmcnt(7)
    buffer_load_dwordx4 v[112:115], v6, s[60:63], s81 offen
    s_add_u32 s81, s80, 6912
    s_mov_b32 exec_lo, 0x0f0f0f0f
    s_mov_b32 exec_hi, 0x0f0f0f0f
    s_waitcnt vmcnt(7)
    buffer_load_dwordx4 v[116:119], v6, s[56:59], s81 offen
    s_mov_b32 exec_lo, 0xf0f0f0f0
    s_mov_b32 exec_hi, 0xf0f0f0f0
    s_waitcnt vmcnt(7)
    buffer_load_dwordx4 v[116:119], v6, s[60:63], s81 offen
    s_add_u32 s81, s80, 17280
    s_mov_b32 exec_lo, 0x0f0f0f0f
    s_mov_b32 exec_hi, 0x0f0f0f0f
    s_waitcnt vmcnt(7)
    buffer_load_dwordx4 v[120:123], v6, s[56:59], s81 offen
    s_mov_b32 exec_lo, 0xf0f0f0f0
    s_mov_b32 exec_hi, 0xf0f0f0f0
    s_waitcnt vmcnt(7)
    buffer_load_dwordx4 v[120:123], v6, s[60:63], s81 offen
    s_add_u32 s81, s80, 27648
    s_mov_b32 exec_lo, 0x0f0f0f0f
    s_mov_b32 exec_hi, 0x0f0f0f0f
    s_waitcnt vmcnt(7)
    buffer_load_dwordx4 v[124:127], v6, s[56:59], s81 offen
    s_mov_b32 exec_lo, 0xf0f0f0f0
    s_mov_b32 exec_hi, 0xf0f0f0f0
    s_waitcnt vmcnt(7)
    buffer_load_dwordx4 v[124:127], v6, s[60:63], s81 offen
    s_add_u32 s81, s80, 38016
    s_mov_b32 exec_lo, 0x0f0f0f0f
    s_mov_b32 exec_hi, 0x0f0f0f0f
    s_waitcnt vmcnt(7)
    buffer_load_dwordx4 v[128:131], v6, s[56:59], s81 offen
    s_mov_b32 exec_lo, 0xf0f0f0f0
    s_mov_b32 exec_hi, 0xf0f0f0f0
    s_waitcnt vmcnt(7)
    buffer_load_dwordx4 v[128:131], v6, s[60:63], s81 offen
    s_mov_b64 exec, -1
L_dma_done:
    s_branch L_hsel
L_qread:
    v_lshlrev_b32 v6, 4, v3
    ds_read_b128 v[40:43], v6 offset:0
    s_and_b32 s80, s3, 3
    s_lshl_b32 s80, s80, 9
    v_add_u32 v14, s80, v14
    ds_read_b32 v7, v20 offset:292
    s_waitcnt lgkmcnt(0)
    v_readfirstlane_b32 s98, v7
    s_mov_b64 vcc, 0
    s_mov_b32 s34, s98
    s_cmp_eq_u32 s85, 1
    s_cselect_b32 s80, 70, 0
    s_sub_u32 s34, s34, s80
    s_cmp_eq_u32 s85, 2
    s_cselect_b32 s80, 95, 0
    s_sub_u32 s34, s34, s80
    s_mov_b32 s35, 0
    v_dot2_f32_bf16 v52, v84, v40, 0
    v_dot2_f32_bf16 v53, v88, v40, 0
    v_dot2_f32_bf16 v52, v85, v41, v52
    v_dot2_f32_bf16 v53, v89, v41, v53
    v_dot2_f32_bf16 v52, v86, v42, v52
    v_dot2_f32_bf16 v53, v90, v42, v53
    v_dot2_f32_bf16 v52, v87, v43, v52
    v_dot2_f32_bf16 v53, v91, v43, v53
    v_dot2_f32_bf16 v54, v92, v40, 0
    v_dot2_f32_bf16 v55, v96, v40, 0
    v_dot2_f32_bf16 v54, v93, v41, v54
    v_dot2_f32_bf16 v55, v97, v41, v55
    v_dot2_f32_bf16 v54, v94, v42, v54
    v_dot2_f32_bf16 v55, v98, v42, v55
    v_dot2_f32_bf16 v54, v95, v43, v54
    v_dot2_f32_bf16 v55, v99, v43, v55
    s_add_u32 s76, s76, 131072
    s_and_b32 s76, s76, 0x3fffff
    s_bfe_u32 s6, s76, 0x10011
    s_lshl_b32 s6, s6, 21
    s_xor_b32 s6, s6, s79
    s_and_b32 s5, s76, 0x1ffff
    s_xor_b32 s6, s6, s5
    s_lshr_b32 s5, s76, 18
    s_lshl_b32 s5, s5, 17
    s_xor_b32 s78, s6, s5
    s_cmp_eq_u32 s35, 1
    s_cbranch_scc1 L_fq1
    s_cbranch_vccnz L_fr1
    s_waitcnt vmcnt(4)
L_fr1:
    s_waitcnt vmcnt(5)
L_fq1:
    buffer_load_dwordx4 v[84:87], v4, s[8:11], s78 offen offset:0 nt
    v_dot2_f32_bf16 v56, v100, v40, 0
    v_dot2_f32_bf16 v57, v104, v40, 0
    v_dot2_f32_bf16 v56, v101, v41, v56
    v_dot2_f32_bf16 v57, v105, v41, v57
    v_dot2_f32_bf16 v56, v102, v42, v56
    v_dot2_f32_bf16 v57, v106, v42, v57
    v_dot2_f32_bf16 v56, v103, v43, v56
    v_dot2_f32_bf16 v57, v107, v43, v57
    v_dot2_f32_bf16 v58, v108, v40, 0
    v_dot2_f32_bf16 v59, v112, v40, 0
    v_dot2_f32_bf16 v58, v109, v41, v58
    v_dot2_f32_bf16 v59, v113, v41, v59
    v_dot2_f32_bf16 v58, v110, v42, v58
    v_dot2_f32_bf16 v59, v114, v42, v59
    v_dot2_f32_bf16 v58, v111, v43, v58
    v_dot2_f32_bf16 v59, v115, v43, v59
    s_cmp_eq_u32 s35, 1
    s_cbranch_scc1 L_fq2
    s_cbranch_vccnz L_fr2
    s_waitcnt vmcnt(4)
L_fr2:
    s_waitcnt vmcnt(5)
L_fq2:
    buffer_load_dwordx4 v[88:91], v4, s[8:11], s78 offen offset:1024 nt
    v_dot2_f32_bf16 v60, v116, v40, 0
    v_dot2_f32_bf16 v61, v120, v40, 0
    v_dot2_f32_bf16 v60, v117, v41, v60
    v_dot2_f32_bf16 v61, v121, v41, v61
    v_dot2_f32_bf16 v60, v118, v42, v60
    v_dot2_f32_bf16 v61, v122, v42, v61
    v_dot2_f32_bf16 v60, v119, v43, v60
    v_dot2_f32_bf16 v61, v123, v43, v61
    v_dot2_f32_bf16 v62, v124, v40, 0
    v_dot2_f32_bf16 v63, v128, v40, 0
    v_dot2_f32_bf16 v62, v125, v41, v62
    v_dot2_f32_bf16 v63, v129, v41, v63
    v_dot2_f32_bf16 v62, v126, v42, v62
    v_dot2_f32_bf16 v63, v130, v42, v63
    v_dot2_f32_bf16 v62, v127, v43, v62
    v_dot2_f32_bf16 v63, v131, v43, v63
    s_cmp_eq_u32 s35, 1
    s_cbranch_scc1 L_fq3
    s_cbranch_vccnz L_fr3
    s_waitcnt vmcnt(4)
L_fr3:
    s_waitcnt vmcnt(5)
L_fq3:
    buffer_load_dwordx4 v[92:95], v4, s[8:11], s78 offen offset:2048 nt
    v_dot2_f32_bf16 v64, v132, v40, 0
    v_dot2_f32_bf16 v65, v136, v40, 0
    v_dot2_f32_bf16 v64, v133, v41, v64
    v_dot2_f32_bf16 v65, v137, v41, v65
    v_dot2_f32_bf16 v64, v134, v42, v64
    v_dot2_f32_bf16 v65, v138, v42, v65
    v_dot2_f32_bf16 v64, v135, v43, v64
    v_dot2_f32_bf16 v65, v139, v43, v65
    v_dot2_f32_bf16 v66, v140, v40, 0
    v_dot2_f32_bf16 v67, v144, v40, 0
    v_dot2_f32_bf16 v66, v141, v41, v66
    v_dot2_f32_bf16 v67, v145, v41, v67
    v_dot2_f32_bf16 v66, v142, v42, v66
    v_dot2_f32_bf16 v67, v146, v42, v67
    v_dot2_f32_bf16 v66, v143, v43, v66
    v_dot2_f32_bf16 v67, v147, v43, v67
    v_add_f32_dpp v52, v52, v52 row_ror:8 row_mask:0xf bank_mask:0x3
    v_add_f32_dpp v53, v53, v53 row_ror:8 row_mask:0xf bank_mask:0x3
    v_add_f32_dpp v54, v54, v54 row_ror:8 row_mask:0xf bank_mask:0x3
    v_add_f32_dpp v55, v55, v55 row_ror:8 row_mask:0xf bank_mask:0x3
    v_add_f32_dpp v56, v56, v56 row_ror:8 row_mask:0xf bank_mask:0x3
    v_add_f32_dpp v57, v57, v57 row_ror:8 row_mask:0xf bank_mask:0x3
    v_add_f32_dpp v58, v58, v58 row_ror:8 row_mask:0xf bank_mask:0x3
    v_add_f32_dpp v59, v59, v59 row_ror:8 row_mask:0xf bank_mask:0x3
    v_add_f32_dpp v52, v60, v60 row_ror:8 row_mask:0xf bank_mask:0xc
    v_add_f32_dpp v53, v61, v61 row_ror:8 row_mask:0xf bank_mask:0xc
    v_add_f32_dpp v54, v62, v62 row_ror:8 row_mask:0xf bank_mask:0xc
    v_add_f32_dpp v55, v63, v63 row_ror:8 row_mask:0xf bank_mask:0xc
    v_add_f32_dpp v56, v64, v64 row_ror:8 row_mask:0xf bank_mask:0xc
    v_add_f32_dpp v57, v65, v65 row_ror:8 row_mask:0xf bank_mask:0xc
    v_add_f32_dpp v58, v66, v66 row_ror:8 row_mask:0xf bank_mask:0xc
    v_add_f32_dpp v59, v67, v67 row_ror:8 row_mask:0xf bank_mask:0xc
    v_add_f32_dpp v60, v52, v52 row_shl:4 row_mask:0xf bank_mask:0x5
    v_add_f32_dpp v61, v53, v53 row_shl:4 row_mask:0xf bank_mask:0x5
    v_add_f32_dpp v62, v54, v54 row_shl:4 row_mask:0xf bank_mask:0x5
    v_add_f32_dpp v63, v55, v55 row_shl:4 row_mask:0xf bank_mask:0x5
    v_add_f32_dpp v60, v56, v56 row_shr:4 row_mask:0xf bank_mask:0xa
    v_add_f32_dpp v61, v57, v57 row_shr:4 row_mask:0xf bank_mask:0xa
    v_add_f32_dpp v62, v58, v58 row_shr:4 row_mask:0xf bank_mask:0xa
    v_add_f32_dpp v63, v59, v59 row_shr:4 row_mask:0xf bank_mask:0xa
    v_add_f32_dpp v60, v60, v60 quad_perm:[2,3,0,1] row_mask:0xf bank_mask:0xf
    v_add_f32_dpp v61, v61, v61 quad_perm:[2,3,0,1] row_mask:0xf bank_mask:0xf
    v_add_f32_dpp v62, v62, v62 quad_perm:[2,3,0,1] row_mask:0xf bank_mask:0xf
    v_add_f32_dpp v63, v63, v63 quad_perm:[2,3,0,1] row_mask:0xf bank_mask:0xf
    v_cndmask_b32 v60, v60, v62, s[16:17]
    v_cndmask_b32 v61, v61, v63, s[16:17]
    s_nop 0
    v_add_f32_dpp v60, v60, v60 quad_perm:[1,0,3,2] row_mask:0xf bank_mask:0xf
    v_add_f32_dpp v61, v61, v61 quad_perm:[1,0,3,2] row_mask:0xf bank_mask:0xf
    v_cndmask_b32 v44, v60, v61, s[18:19]
    v_cvt_pk_bf16_f32 v44, v44, v44
    v_lshlrev_b32 v44, 16, v44
    v_mul_f32 v44, 0x3db504f3, v44
    v_cvt_pk_bf16_f32 v44, v44, v44
    v_lshlrev_b32 v44, 16, v44
    s_cmp_eq_u32 s35, 1
    s_cbranch_scc1 L_fq4
    s_cbranch_vccnz L_fr4
    s_waitcnt vmcnt(4)
L_fr4:
    s_waitcnt vmcnt(5)
L_fq4:
    s_waitcnt vmcnt(7)
    buffer_load_dwordx4 v[96:99], v4, s[8:11], s78 offen offset:3072 nt
    v_dot2_f32_bf16 v52, v148, v40, 0
    v_dot2_f32_bf16 v53, v152, v40, 0
    v_dot2_f32_bf16 v52, v149, v41, v52
    v_dot2_f32_bf16 v53, v153, v41, v53
    v_dot2_f32_bf16 v52, v150, v42, v52
    v_dot2_f32_bf16 v53, v154, v42, v53
    v_dot2_f32_bf16 v52, v151, v43, v52
    v_dot2_f32_bf16 v53, v155, v43, v53
    v_dot2_f32_bf16 v54, v156, v40, 0
    v_dot2_f32_bf16 v55, v160, v40, 0
    v_dot2_f32_bf16 v54, v157, v41, v54
    v_dot2_f32_bf16 v55, v161, v41, v55
    v_dot2_f32_bf16 v54, v158, v42, v54
    v_dot2_f32_bf16 v55, v162, v42, v55
    v_dot2_f32_bf16 v54, v159, v43, v54
    v_dot2_f32_bf16 v55, v163, v43, v55
    s_memrealtime s[96:97]
    s_waitcnt lgkmcnt(0)
    s_sub_u32 s96, s96, s34
    s_cmp_gt_i32 s96, 704
    s_cselect_b64 vcc, -1, 0
    s_cmp_gt_i32 s96, 744
    s_cselect_b32 s35, 1, 0
    s_add_u32 s76, s76, 131072
    s_and_b32 s76, s76, 0x3fffff
    s_bfe_u32 s6, s76, 0x10011
    s_lshl_b32 s6, s6, 21
    s_xor_b32 s6, s6, s79
    s_and_b32 s5, s76, 0x1ffff
    s_xor_b32 s6, s6, s5
    s_lshr_b32 s5, s76, 18
    s_lshl_b32 s5, s5, 17
    s_xor_b32 s78, s6, s5
    s_cmp_eq_u32 s35, 1
    s_cbranch_scc1 L_fq5
    s_cbranch_vccnz L_fr5
    s_waitcnt vmcnt(4)
L_fr5:
    s_waitcnt vmcnt(5)
L_fq5:
    s_waitcnt vmcnt(7)
    buffer_load_dwordx4 v[100:103], v4, s[8:11], s78 offen offset:0 nt
    v_dot2_f32_bf16 v56, v164, v40, 0
    v_dot2_f32_bf16 v57, v168, v40, 0
    v_dot2_f32_bf16 v56, v165, v41, v56
    v_dot2_f32_bf16 v57, v169, v41, v57
    v_dot2_f32_bf16 v56, v166, v42, v56
    v_dot2_f32_bf16 v57, v170, v42, v57
    v_dot2_f32_bf16 v56, v167, v43, v56
    v_dot2_f32_bf16 v57, v171, v43, v57
    v_dot2_f32_bf16 v58, v172, v40, 0
    v_dot2_f32_bf16 v59, v176, v40, 0
    v_dot2_f32_bf16 v58, v173, v41, v58
    v_dot2_f32_bf16 v59, v177, v41, v59
    v_dot2_f32_bf16 v58, v174, v42, v58
    v_dot2_f32_bf16 v59, v178, v42, v59
    v_dot2_f32_bf16 v58, v175, v43, v58
    v_dot2_f32_bf16 v59, v179, v43, v59
    s_memrealtime s[96:97]
    s_waitcnt lgkmcnt(0)
    s_sub_u32 s96, s96, s34
    s_cmp_gt_i32 s96, 718
    s_cselect_b64 vcc, -1, 0
    s_cmp_gt_i32 s96, 758
    s_cselect_b32 s35, 1, 0
    s_cmp_eq_u32 s35, 1
    s_cbranch_scc1 L_fq6
    s_cbranch_vccnz L_fr6
    s_waitcnt vmcnt(4)
L_fr6:
    s_waitcnt vmcnt(5)
L_fq6:
    s_waitcnt vmcnt(7)
    buffer_load_dwordx4 v[104:107], v4, s[8:11], s78 offen offset:1024 nt
    v_dot2_f32_bf16 v60, v180, v40, 0
    v_dot2_f32_bf16 v61, v184, v40, 0
    v_dot2_f32_bf16 v60, v181, v41, v60
    v_dot2_f32_bf16 v61, v185, v41, v61
    v_dot2_f32_bf16 v60, v182, v42, v60
    v_dot2_f32_bf16 v61, v186, v42, v61
    v_dot2_f32_bf16 v60, v183, v43, v60
    v_dot2_f32_bf16 v61, v187, v43, v61
    v_dot2_f32_bf16 v62, v188, v40, 0
    v_dot2_f32_bf16 v63, v192, v40, 0
    v_dot2_f32_bf16 v62, v189, v41, v62
    v_dot2_f32_bf16 v63, v193, v41, v63
    v_dot2_f32_bf16 v62, v190, v42, v62
    v_dot2_f32_bf16 v63, v194, v42, v63
    v_dot2_f32_bf16 v62, v191, v43, v62
    v_dot2_f32_bf16 v63, v195, v43, v63
    s_memrealtime s[96:97]
    s_waitcnt lgkmcnt(0)
    s_sub_u32 s96, s96, s34
    s_cmp_gt_i32 s96, 732
    s_cselect_b64 vcc, -1, 0
    s_cmp_gt_i32 s96, 772
    s_cselect_b32 s35, 1, 0
    s_cmp_eq_u32 s35, 1
    s_cbranch_scc1 L_fq7
    s_cbranch_vccnz L_fr7
    s_waitcnt vmcnt(4)
L_fr7:
    s_waitcnt vmcnt(5)
L_fq7:
    s_waitcnt vmcnt(7)
    buffer_load_dwordx4 v[108:111], v4, s[8:11], s78 offen offset:2048 nt
    v_dot2_f32_bf16 v64, v196, v40, 0
    v_dot2_f32_bf16 v65, v200, v40, 0
    v_dot2_f32_bf16 v64, v197, v41, v64
    v_dot2_f32_bf16 v65, v201, v41, v65
    v_dot2_f32_bf16 v64, v198, v42, v64
    v_dot2_f32_bf16 v65, v202, v42, v65
    v_dot2_f32_bf16 v64, v199, v43, v64
    v_dot2_f32_bf16 v65, v203, v43, v65
    s_cmp_eq_u32 s35, 1
    s_cbranch_scc1 L_fq8
    s_cbranch_vccnz L_fr8
    s_waitcnt vmcnt(4)
L_fr8:
    s_waitcnt vmcnt(5)
L_fq8:
    s_waitcnt vmcnt(7)
    buffer_load_dwordx4 v[112:115], v4, s[8:11], s78 offen offset:3072 nt
    v_dot2_f32_bf16 v66, v204, v40, 0
    v_dot2_f32_bf16 v67, v208, v40, 0
    v_dot2_f32_bf16 v66, v205, v41, v66
    v_dot2_f32_bf16 v67, v209, v41, v67
    v_dot2_f32_bf16 v66, v206, v42, v66
    v_dot2_f32_bf16 v67, v210, v42, v67
    v_dot2_f32_bf16 v66, v207, v43, v66
    v_dot2_f32_bf16 v67, v211, v43, v67
    v_add_f32_dpp v52, v52, v52 row_ror:8 row_mask:0xf bank_mask:0x3
    v_add_f32_dpp v53, v53, v53 row_ror:8 row_mask:0xf bank_mask:0x3
    v_add_f32_dpp v54, v54, v54 row_ror:8 row_mask:0xf bank_mask:0x3
    v_add_f32_dpp v55, v55, v55 row_ror:8 row_mask:0xf bank_mask:0x3
    v_add_f32_dpp v56, v56, v56 row_ror:8 row_mask:0xf bank_mask:0x3
    v_add_f32_dpp v57, v57, v57 row_ror:8 row_mask:0xf bank_mask:0x3
    v_add_f32_dpp v58, v58, v58 row_ror:8 row_mask:0xf bank_mask:0x3
    v_add_f32_dpp v59, v59, v59 row_ror:8 row_mask:0xf bank_mask:0x3
    v_add_f32_dpp v52, v60, v60 row_ror:8 row_mask:0xf bank_mask:0xc
    v_add_f32_dpp v53, v61, v61 row_ror:8 row_mask:0xf bank_mask:0xc
    v_add_f32_dpp v54, v62, v62 row_ror:8 row_mask:0xf bank_mask:0xc
    v_add_f32_dpp v55, v63, v63 row_ror:8 row_mask:0xf bank_mask:0xc
    v_add_f32_dpp v56, v64, v64 row_ror:8 row_mask:0xf bank_mask:0xc
    v_add_f32_dpp v57, v65, v65 row_ror:8 row_mask:0xf bank_mask:0xc
    v_add_f32_dpp v58, v66, v66 row_ror:8 row_mask:0xf bank_mask:0xc
    v_add_f32_dpp v59, v67, v67 row_ror:8 row_mask:0xf bank_mask:0xc
    v_add_f32_dpp v60, v52, v52 row_shl:4 row_mask:0xf bank_mask:0x5
    v_add_f32_dpp v61, v53, v53 row_shl:4 row_mask:0xf bank_mask:0x5
    v_add_f32_dpp v62, v54, v54 row_shl:4 row_mask:0xf bank_mask:0x5
    v_add_f32_dpp v63, v55, v55 row_shl:4 row_mask:0xf bank_mask:0x5
    v_add_f32_dpp v60, v56, v56 row_shr:4 row_mask:0xf bank_mask:0xa
    v_add_f32_dpp v61, v57, v57 row_shr:4 row_mask:0xf bank_mask:0xa
    v_add_f32_dpp v62, v58, v58 row_shr:4 row_mask:0xf bank_mask:0xa
    v_add_f32_dpp v63, v59, v59 row_shr:4 row_mask:0xf bank_mask:0xa
    v_add_f32_dpp v60, v60, v60 quad_perm:[2,3,0,1] row_mask:0xf bank_mask:0xf
    v_add_f32_dpp v61, v61, v61 quad_perm:[2,3,0,1] row_mask:0xf bank_mask:0xf
    v_add_f32_dpp v62, v62, v62 quad_perm:[2,3,0,1] row_mask:0xf bank_mask:0xf
    v_add_f32_dpp v63, v63, v63 quad_perm:[2,3,0,1] row_mask:0xf bank_mask:0xf
    v_cndmask_b32 v60, v60, v62, s[16:17]
    v_cndmask_b32 v61, v61, v63, s[16:17]
    s_nop 0
    v_add_f32_dpp v60, v60, v60 quad_perm:[1,0,3,2] row_mask:0xf bank_mask:0xf
    v_add_f32_dpp v61, v61, v61 quad_perm:[1,0,3,2] row_mask:0xf bank_mask:0xf
    v_cndmask_b32 v45, v60, v61, s[18:19]
    v_cvt_pk_bf16_f32 v45, v45, v45
    v_lshlrev_b32 v45, 16, v45
    v_mul_f32 v45, 0x3db504f3, v45
    v_cvt_pk_bf16_f32 v45, v45, v45
    v_lshlrev_b32 v45, 16, v45
    s_memrealtime s[96:97]
    s_waitcnt lgkmcnt(0)
    s_sub_u32 s96, s96, s34
    s_cmp_gt_i32 s96, 760
    s_cselect_b64 vcc, -1, 0
    s_cmp_gt_i32 s96, 800
    s_cselect_b32 s35, 1, 0
    s_add_u32 s76, s76, 131072
    s_and_b32 s76, s76, 0x3fffff
    s_bfe_u32 s6, s76, 0x10011
    s_lshl_b32 s6, s6, 21
    s_xor_b32 s6, s6, s79
    s_and_b32 s5, s76, 0x1ffff
    s_xor_b32 s6, s6, s5
    s_lshr_b32 s5, s76, 18
    s_lshl_b32 s5, s5, 17
    s_xor_b32 s78, s6, s5
    s_cmp_eq_u32 s35, 1
    s_cbranch_scc1 L_fq9
    s_cbranch_vccnz L_fr9
    s_waitcnt vmcnt(4)
L_fr9:
    s_waitcnt vmcnt(5)
L_fq9:
    s_waitcnt vmcnt(7)
    buffer_load_dwordx4 v[116:119], v4, s[8:11], s78 offen offset:0 nt
    s_cmp_eq_u32 s35, 1
    s_cbranch_scc1 L_fq10
    s_cbranch_vccnz L_fr10
    s_waitcnt vmcnt(4)
L_fr10:
    s_waitcnt vmcnt(5)
L_fq10:
    s_waitcnt vmcnt(7)
    buffer_load_dwordx4 v[120:123], v4, s[8:11], s78 offen offset:1024 nt
    v_dot2_f32_bf16 v52, v84, v40, 0
    v_dot2_f32_bf16 v53, v88, v40, 0
    v_dot2_f32_bf16 v52, v85, v41, v52
    v_dot2_f32_bf16 v53, v89, v41, v53
    v_dot2_f32_bf16 v52, v86, v42, v52
    v_dot2_f32_bf16 v53, v90, v42, v53
    v_dot2_f32_bf16 v52, v87, v43, v52
    v_dot2_f32_bf16 v53, v91, v43, v53
    s_cmp_eq_u32 s35, 1
    s_cbranch_scc1 L_fq11
    s_cbranch_vccnz L_fr11
    s_waitcnt vmcnt(4)
L_fr11:
    s_waitcnt vmcnt(5)
L_fq11:
    s_waitcnt vmcnt(7)
    buffer_load_dwordx4 v[124:127], v4, s[8:11], s78 offen offset:2048 nt
    s_cmp_eq_u32 s35, 1
    s_cbranch_scc1 L_fq12
    s_cbranch_vccnz L_fr12
    s_waitcnt vmcnt(4)
L_fr12:
    s_waitcnt vmcnt(5)
L_fq12:
    s_waitcnt vmcnt(7)
    buffer_load_dwordx4 v[128:131], v4, s[8:11], s78 offen offset:3072 nt
    v_dot2_f32_bf16 v54, v92, v40, 0
    v_dot2_f32_bf16 v55, v96, v40, 0
    v_dot2_f32_bf16 v54, v93, v41, v54
    v_dot2_f32_bf16 v55, v97, v41, v55
    v_dot2_f32_bf16 v54, v94, v42, v54
    v_dot2_f32_bf16 v55, v98, v42, v55
    v_dot2_f32_bf16 v54, v95, v43, v54
    v_dot2_f32_bf16 v55, v99, v43, v55
    s_memrealtime s[96:97]
    s_waitcnt lgkmcnt(0)
    s_sub_u32 s96, s96, s34
    s_cmp_gt_i32 s96, 816
    s_cselect_b64 vcc, -1, 0
    s_cmp_gt_i32 s96, 856
    s_cselect_b32 s35, 1, 0
    s_add_u32 s76, s76, 131072
    s_and_b32 s76, s76, 0x3fffff
    s_bfe_u32 s6, s76, 0x10011
    s_lshl_b32 s6, s6, 21
    s_xor_b32 s6, s6, s79
    s_and_b32 s5, s76, 0x1ffff
    s_xor_b32 s6, s6, s5
    s_lshr_b32 s5, s76, 18
    s_lshl_b32 s5, s5, 17
    s_xor_b32 s78, s6, s5
    s_cmp_eq_u32 s35, 1
    s_cbranch_scc1 L_fq13
    s_cbranch_vccnz L_fr13
    s_waitcnt vmcnt(4)
L_fr13:
    s_waitcnt vmcnt(5)
L_fq13:
    s_waitcnt vmcnt(7)
    buffer_load_dwordx4 v[132:135], v4, s[8:11], s78 offen offset:0 nt
    s_cmp_eq_u32 s35, 1
    s_cbranch_scc1 L_fq14
    s_cbranch_vccnz L_fr14
    s_waitcnt vmcnt(4)
L_fr14:
    s_waitcnt vmcnt(5)
L_fq14:
    s_waitcnt vmcnt(7)
    buffer_load_dwordx4 v[136:139], v4, s[8:11], s78 offen offset:1024 nt
    v_dot2_f32_bf16 v56, v100, v40, 0
    v_dot2_f32_bf16 v57, v104, v40, 0
    v_dot2_f32_bf16 v56, v101, v41, v56
    v_dot2_f32_bf16 v57, v105, v41, v57
    v_dot2_f32_bf16 v56, v102, v42, v56
    v_dot2_f32_bf16 v57, v106, v42, v57
    v_dot2_f32_bf16 v56, v103, v43, v56
    v_dot2_f32_bf16 v57, v107, v43, v57
    s_cmp_eq_u32 s35, 1
    s_cbranch_scc1 L_fq15
    s_cbranch_vccnz L_fr15
    s_waitcnt vmcnt(4)
L_fr15:
    s_waitcnt vmcnt(5)
L_fq15:
    s_waitcnt vmcnt(7)
    buffer_load_dwordx4 v[140:143], v4, s[8:11], s78 offen offset:2048 nt
    s_cmp_eq_u32 s35, 1
    s_cbranch_scc1 L_fq16
    s_cbranch_vccnz L_fr16
    s_waitcnt vmcnt(4)
L_fr16:
    s_waitcnt vmcnt(5)
L_fq16:
    s_waitcnt vmcnt(7)
    buffer_load_dwordx4 v[144:147], v4, s[8:11], s78 offen offset:3072 nt
    v_dot2_f32_bf16 v58, v108, v40, 0
    v_dot2_f32_bf16 v59, v112, v40, 0
    v_dot2_f32_bf16 v58, v109, v41, v58
    v_dot2_f32_bf16 v59, v113, v41, v59
    v_dot2_f32_bf16 v58, v110, v42, v58
    v_dot2_f32_bf16 v59, v114, v42, v59
    v_dot2_f32_bf16 v58, v111, v43, v58
    v_dot2_f32_bf16 v59, v115, v43, v59
    s_memrealtime s[96:97]
    s_waitcnt lgkmcnt(0)
    s_sub_u32 s96, s96, s34
    s_cmp_gt_i32 s96, 872
    s_cselect_b64 vcc, -1, 0
    s_cmp_gt_i32 s96, 912
    s_cselect_b32 s35, 1, 0
    s_add_u32 s76, s76, 131072
    s_and_b32 s76, s76, 0x3fffff
    s_bfe_u32 s6, s76, 0x10011
    s_lshl_b32 s6, s6, 21
    s_xor_b32 s6, s6, s79
    s_and_b32 s5, s76, 0x1ffff
    s_xor_b32 s6, s6, s5
    s_lshr_b32 s5, s76, 18
    s_lshl_b32 s5, s5, 17
    s_xor_b32 s78, s6, s5
    s_cmp_eq_u32 s35, 1
    s_cbranch_scc1 L_fq17
    s_cbranch_vccnz L_fr17
    s_waitcnt vmcnt(4)
L_fr17:
    s_waitcnt vmcnt(5)
L_fq17:
    s_waitcnt vmcnt(7)
    buffer_load_dwordx4 v[148:151], v4, s[8:11], s78 offen offset:0 nt
    s_cmp_eq_u32 s35, 1
    s_cbranch_scc1 L_fq18
    s_cbranch_vccnz L_fr18
    s_waitcnt vmcnt(4)
L_fr18:
    s_waitcnt vmcnt(5)
L_fq18:
    s_waitcnt vmcnt(7)
    buffer_load_dwordx4 v[152:155], v4, s[8:11], s78 offen offset:1024 nt
    v_dot2_f32_bf16 v60, v116, v40, 0
    v_dot2_f32_bf16 v61, v120, v40, 0
    v_dot2_f32_bf16 v60, v117, v41, v60
    v_dot2_f32_bf16 v61, v121, v41, v61
    v_dot2_f32_bf16 v60, v118, v42, v60
    v_dot2_f32_bf16 v61, v122, v42, v61
    v_dot2_f32_bf16 v60, v119, v43, v60
    v_dot2_f32_bf16 v61, v123, v43, v61
    s_cmp_eq_u32 s35, 1
    s_cbranch_scc1 L_fq19
    s_cbranch_vccnz L_fr19
    s_waitcnt vmcnt(4)
L_fr19:
    s_waitcnt vmcnt(5)
L_fq19:
    s_waitcnt vmcnt(7)
    buffer_load_dwordx4 v[156:159], v4, s[8:11], s78 offen offset:2048 nt
    s_cmp_eq_u32 s35, 1
    s_cbranch_scc1 L_fq20
    s_cbranch_vccnz L_fr20
    s_waitcnt vmcnt(4)
L_fr20:
    s_waitcnt vmcnt(5)
L_fq20:
    s_waitcnt vmcnt(7)
    buffer_load_dwordx4 v[160:163], v4, s[8:11], s78 offen offset:3072 nt
    v_dot2_f32_bf16 v62, v124, v40, 0
    v_dot2_f32_bf16 v63, v128, v40, 0
    v_dot2_f32_bf16 v62, v125, v41, v62
    v_dot2_f32_bf16 v63, v129, v41, v63
    v_dot2_f32_bf16 v62, v126, v42, v62
    v_dot2_f32_bf16 v63, v130, v42, v63
    v_dot2_f32_bf16 v62, v127, v43, v62
    v_dot2_f32_bf16 v63, v131, v43, v63
    s_memrealtime s[96:97]
    s_waitcnt lgkmcnt(0)
    s_sub_u32 s96, s96, s34
    s_cmp_gt_i32 s96, 928
    s_cselect_b64 vcc, -1, 0
    s_cmp_gt_i32 s96, 968
    s_cselect_b32 s35, 1, 0
    s_add_u32 s76, s76, 131072
    s_and_b32 s76, s76, 0x3fffff
    s_bfe_u32 s6, s76, 0x10011
    s_lshl_b32 s6, s6, 21
    s_xor_b32 s6, s6, s79
    s_and_b32 s5, s76, 0x1ffff
    s_xor_b32 s6, s6, s5
    s_lshr_b32 s5, s76, 18
    s_lshl_b32 s5, s5, 17
    s_xor_b32 s78, s6, s5
    s_cmp_eq_u32 s35, 1
    s_cbranch_scc1 L_fq21
    s_cbranch_vccnz L_fr21
    s_waitcnt vmcnt(4)
L_fr21:
    s_waitcnt vmcnt(5)
L_fq21:
    s_waitcnt vmcnt(7)
    buffer_load_dwordx4 v[164:167], v4, s[8:11], s78 offen offset:0 nt
    s_cmp_eq_u32 s35, 1
    s_cbranch_scc1 L_fq22
    s_cbranch_vccnz L_fr22
    s_waitcnt vmcnt(4)
L_fr22:
    s_waitcnt vmcnt(5)
L_fq22:
    s_waitcnt vmcnt(7)
    buffer_load_dwordx4 v[168:171], v4, s[8:11], s78 offen offset:1024 nt
    v_dot2_f32_bf16 v64, v132, v40, 0
    v_dot2_f32_bf16 v65, v136, v40, 0
    v_dot2_f32_bf16 v64, v133, v41, v64
    v_dot2_f32_bf16 v65, v137, v41, v65
    v_dot2_f32_bf16 v64, v134, v42, v64
    v_dot2_f32_bf16 v65, v138, v42, v65
    v_dot2_f32_bf16 v64, v135, v43, v64
    v_dot2_f32_bf16 v65, v139, v43, v65
    s_cmp_eq_u32 s35, 1
    s_cbranch_scc1 L_fq23
    s_cbranch_vccnz L_fr23
    s_waitcnt vmcnt(4)
L_fr23:
    s_waitcnt vmcnt(5)
L_fq23:
    s_waitcnt vmcnt(7)
    buffer_load_dwordx4 v[172:175], v4, s[8:11], s78 offen offset:2048 nt
    s_cmp_eq_u32 s35, 1
    s_cbranch_scc1 L_fq24
    s_cbranch_vccnz L_fr24
    s_waitcnt vmcnt(4)
L_fr24:
    s_waitcnt vmcnt(5)
L_fq24:
    s_waitcnt vmcnt(7)
    buffer_load_dwordx4 v[176:179], v4, s[8:11], s78 offen offset:3072 nt
    v_dot2_f32_bf16 v66, v140, v40, 0
    v_dot2_f32_bf16 v67, v144, v40, 0
    v_dot2_f32_bf16 v66, v141, v41, v66
    v_dot2_f32_bf16 v67, v145, v41, v67
    v_dot2_f32_bf16 v66, v142, v42, v66
    v_dot2_f32_bf16 v67, v146, v42, v67
    v_dot2_f32_bf16 v66, v143, v43, v66
    v_dot2_f32_bf16 v67, v147, v43, v67
    v_add_f32_dpp v52, v52, v52 row_ror:8 row_mask:0xf bank_mask:0x3
    v_add_f32_dpp v53, v53, v53 row_ror:8 row_mask:0xf bank_mask:0x3
    v_add_f32_dpp v54, v54, v54 row_ror:8 row_mask:0xf bank_mask:0x3
    v_add_f32_dpp v55, v55, v55 row_ror:8 row_mask:0xf bank_mask:0x3
    v_add_f32_dpp v56, v56, v56 row_ror:8 row_mask:0xf bank_mask:0x3
    v_add_f32_dpp v57, v57, v57 row_ror:8 row_mask:0xf bank_mask:0x3
    v_add_f32_dpp v58, v58, v58 row_ror:8 row_mask:0xf bank_mask:0x3
    v_add_f32_dpp v59, v59, v59 row_ror:8 row_mask:0xf bank_mask:0x3
    v_add_f32_dpp v52, v60, v60 row_ror:8 row_mask:0xf bank_mask:0xc
    v_add_f32_dpp v53, v61, v61 row_ror:8 row_mask:0xf bank_mask:0xc
    v_add_f32_dpp v54, v62, v62 row_ror:8 row_mask:0xf bank_mask:0xc
    v_add_f32_dpp v55, v63, v63 row_ror:8 row_mask:0xf bank_mask:0xc
    v_add_f32_dpp v56, v64, v64 row_ror:8 row_mask:0xf bank_mask:0xc
    v_add_f32_dpp v57, v65, v65 row_ror:8 row_mask:0xf bank_mask:0xc
    v_add_f32_dpp v58, v66, v66 row_ror:8 row_mask:0xf bank_mask:0xc
    v_add_f32_dpp v59, v67, v67 row_ror:8 row_mask:0xf bank_mask:0xc
    v_add_f32_dpp v60, v52, v52 row_shl:4 row_mask:0xf bank_mask:0x5
    v_add_f32_dpp v61, v53, v53 row_shl:4 row_mask:0xf bank_mask:0x5
    v_add_f32_dpp v62, v54, v54 row_shl:4 row_mask:0xf bank_mask:0x5
    v_add_f32_dpp v63, v55, v55 row_shl:4 row_mask:0xf bank_mask:0x5
    v_add_f32_dpp v60, v56, v56 row_shr:4 row_mask:0xf bank_mask:0xa
    v_add_f32_dpp v61, v57, v57 row_shr:4 row_mask:0xf bank_mask:0xa
    v_add_f32_dpp v62, v58, v58 row_shr:4 row_mask:0xf bank_mask:0xa
    v_add_f32_dpp v63, v59, v59 row_shr:4 row_mask:0xf bank_mask:0xa
    v_add_f32_dpp v60, v60, v60 quad_perm:[2,3,0,1] row_mask:0xf bank_mask:0xf
    v_add_f32_dpp v61, v61, v61 quad_perm:[2,3,0,1] row_mask:0xf bank_mask:0xf
    v_add_f32_dpp v62, v62, v62 quad_perm:[2,3,0,1] row_mask:0xf bank_mask:0xf
    v_add_f32_dpp v63, v63, v63 quad_perm:[2,3,0,1] row_mask:0xf bank_mask:0xf
    v_cndmask_b32 v60, v60, v62, s[16:17]
    v_cndmask_b32 v61, v61, v63, s[16:17]
    s_nop 0
    v_add_f32_dpp v60, v60, v60 quad_perm:[1,0,3,2] row_mask:0xf bank_mask:0xf
    v_add_f32_dpp v61, v61, v61 quad_perm:[1,0,3,2] row_mask:0xf bank_mask:0xf
    v_cndmask_b32 v46, v60, v61, s[18:19]
    v_cvt_pk_bf16_f32 v46, v46, v46
    v_lshlrev_b32 v46, 16, v46
    v_mul_f32 v46, 0x3db504f3, v46
    v_cvt_pk_bf16_f32 v46, v46, v46
    v_lshlrev_b32 v46, 16, v46
    s_memrealtime s[96:97]
    s_waitcnt lgkmcnt(0)
    s_sub_u32 s96, s96, s34
    s_cmp_gt_i32 s96, 984
    s_cselect_b64 vcc, -1, 0
    s_cmp_gt_i32 s96, 1024
    s_cselect_b32 s35, 1, 0
    s_add_u32 s76, s76, 131072
    s_and_b32 s76, s76, 0x3fffff
    s_bfe_u32 s6, s76, 0x10011
    s_lshl_b32 s6, s6, 21
    s_xor_b32 s6, s6, s79
    s_and_b32 s5, s76, 0x1ffff
    s_xor_b32 s6, s6, s5
    s_lshr_b32 s5, s76, 18
    s_lshl_b32 s5, s5, 17
    s_xor_b32 s78, s6, s5
    s_cmp_eq_u32 s35, 1
    s_cbranch_scc1 L_fq25
    s_cbranch_vccnz L_fr25
    s_waitcnt vmcnt(4)
L_fr25:
    s_waitcnt vmcnt(5)
L_fq25:
    s_waitcnt vmcnt(7)
    buffer_load_dwordx4 v[180:183], v4, s[8:11], s78 offen offset:0 nt
    s_cmp_eq_u32 s35, 1
    s_cbranch_scc1 L_fq26
    s_cbranch_vccnz L_fr26
    s_waitcnt vmcnt(4)
L_fr26:
    s_waitcnt vmcnt(5)
L_fq26:
    s_waitcnt vmcnt(7)
    buffer_load_dwordx4 v[184:187], v4, s[8:11], s78 offen offset:1024 nt
    v_dot2_f32_bf16 v52, v148, v40, 0
    v_dot2_f32_bf16 v53, v152, v40, 0
    v_dot2_f32_bf16 v52, v149, v41, v52
    v_dot2_f32_bf16 v53, v153, v41, v53
    v_dot2_f32_bf16 v52, v150, v42, v52
    v_dot2_f32_bf16 v53, v154, v42, v53
    v_dot2_f32_bf16 v52, v151, v43, v52
    v_dot2_f32_bf16 v53, v155, v43, v53
    s_cmp_eq_u32 s35, 1
    s_cbranch_scc1 L_fq27
    s_cbranch_vccnz L_fr27
    s_waitcnt vmcnt(4)
L_fr27:
    s_waitcnt vmcnt(5)
L_fq27:
    s_waitcnt vmcnt(7)
    buffer_load_dwordx4 v[188:191], v4, s[8:11], s78 offen offset:2048 nt
    s_cmp_eq_u32 s35, 1
    s_cbranch_scc1 L_fq28
    s_cbranch_vccnz L_fr28
    s_waitcnt vmcnt(4)
L_fr28:
    s_waitcnt vmcnt(5)
L_fq28:
    s_waitcnt vmcnt(7)
    buffer_load_dwordx4 v[192:195], v4, s[8:11], s78 offen offset:3072 nt
    v_dot2_f32_bf16 v54, v156, v40, 0
    v_dot2_f32_bf16 v55, v160, v40, 0
    v_dot2_f32_bf16 v54, v157, v41, v54
    v_dot2_f32_bf16 v55, v161, v41, v55
    v_dot2_f32_bf16 v54, v158, v42, v54
    v_dot2_f32_bf16 v55, v162, v42, v55
    v_dot2_f32_bf16 v54, v159, v43, v54
    v_dot2_f32_bf16 v55, v163, v43, v55
    s_memrealtime s[96:97]
    s_waitcnt lgkmcnt(0)
    s_sub_u32 s96, s96, s34
    s_cmp_gt_i32 s96, 1040
    s_cselect_b64 vcc, -1, 0
    s_cmp_gt_i32 s96, 1080
    s_cselect_b32 s35, 1, 0
    s_add_u32 s76, s76, 131072
    s_and_b32 s76, s76, 0x3fffff
    s_bfe_u32 s6, s76, 0x10011
    s_lshl_b32 s6, s6, 21
    s_xor_b32 s6, s6, s79
    s_and_b32 s5, s76, 0x1ffff
    s_xor_b32 s6, s6, s5
    s_lshr_b32 s5, s76, 18
    s_lshl_b32 s5, s5, 17
    s_xor_b32 s78, s6, s5
    s_cmp_eq_u32 s35, 1
    s_cbranch_scc1 L_fq29
    s_cbranch_vccnz L_fr29
    s_waitcnt vmcnt(4)
L_fr29:
    s_waitcnt vmcnt(5)
L_fq29:
    s_waitcnt vmcnt(7)
    buffer_load_dwordx4 v[196:199], v4, s[8:11], s78 offen offset:0 nt
    s_cmp_eq_u32 s35, 1
    s_cbranch_scc1 L_fq30
    s_cbranch_vccnz L_fr30
    s_waitcnt vmcnt(4)
L_fr30:
    s_waitcnt vmcnt(5)
L_fq30:
    s_waitcnt vmcnt(7)
    buffer_load_dwordx4 v[200:203], v4, s[8:11], s78 offen offset:1024 nt
    v_dot2_f32_bf16 v56, v164, v40, 0
    v_dot2_f32_bf16 v57, v168, v40, 0
    v_dot2_f32_bf16 v56, v165, v41, v56
    v_dot2_f32_bf16 v57, v169, v41, v57
    v_dot2_f32_bf16 v56, v166, v42, v56
    v_dot2_f32_bf16 v57, v170, v42, v57
    v_dot2_f32_bf16 v56, v167, v43, v56
    v_dot2_f32_bf16 v57, v171, v43, v57
    s_cmp_eq_u32 s35, 1
    s_cbranch_scc1 L_fq31
    s_cbranch_vccnz L_fr31
    s_waitcnt vmcnt(4)
L_fr31:
    s_waitcnt vmcnt(5)
L_fq31:
    s_waitcnt vmcnt(7)
    buffer_load_dwordx4 v[204:207], v4, s[8:11], s78 offen offset:2048 nt
    s_cmp_eq_u32 s35, 1
    s_cbranch_scc1 L_fq32
    s_cbranch_vccnz L_fr32
    s_waitcnt vmcnt(4)
L_fr32:
    s_waitcnt vmcnt(5)
L_fq32:
    s_waitcnt vmcnt(7)
    buffer_load_dwordx4 v[208:211], v4, s[8:11], s78 offen offset:3072 nt
    v_dot2_f32_bf16 v58, v172, v40, 0
    v_dot2_f32_bf16 v59, v176, v40, 0
    v_dot2_f32_bf16 v58, v173, v41, v58
    v_dot2_f32_bf16 v59, v177, v41, v59
    v_dot2_f32_bf16 v58, v174, v42, v58
    v_dot2_f32_bf16 v59, v178, v42, v59
    v_dot2_f32_bf16 v58, v175, v43, v58
    v_dot2_f32_bf16 v59, v179, v43, v59
    s_memrealtime s[96:97]
    s_waitcnt lgkmcnt(0)
    s_sub_u32 s96, s96, s34
    s_cmp_gt_i32 s96, 1096
    s_cselect_b64 vcc, -1, 0
    s_cmp_gt_i32 s96, 1136
    s_cselect_b32 s35, 1, 0
    s_add_u32 s76, s76, 131072
    s_and_b32 s76, s76, 0x3fffff
    s_bfe_u32 s6, s76, 0x10011
    s_lshl_b32 s6, s6, 21
    s_xor_b32 s6, s6, s79
    s_and_b32 s5, s76, 0x1ffff
    s_xor_b32 s6, s6, s5
    s_lshr_b32 s5, s76, 18
    s_lshl_b32 s5, s5, 17
    s_xor_b32 s78, s6, s5
    s_cmp_eq_u32 s35, 1
    s_cbranch_scc1 L_fq33
    s_cbranch_vccnz L_fr33
    s_waitcnt vmcnt(4)
L_fr33:
    s_waitcnt vmcnt(5)
L_fq33:
    s_waitcnt vmcnt(7)
    buffer_load_dwordx4 v[84:87], v4, s[8:11], s78 offen offset:0 nt
    s_cmp_eq_u32 s35, 1
    s_cbranch_scc1 L_fq34
    s_cbranch_vccnz L_fr34
    s_waitcnt vmcnt(4)
L_fr34:
    s_waitcnt vmcnt(5)
L_fq34:
    s_waitcnt vmcnt(7)
    buffer_load_dwordx4 v[88:91], v4, s[8:11], s78 offen offset:1024 nt
    v_dot2_f32_bf16 v60, v180, v40, 0
    v_dot2_f32_bf16 v61, v184, v40, 0
    v_dot2_f32_bf16 v60, v181, v41, v60
    v_dot2_f32_bf16 v61, v185, v41, v61
    v_dot2_f32_bf16 v60, v182, v42, v60
    v_dot2_f32_bf16 v61, v186, v42, v61
    v_dot2_f32_bf16 v60, v183, v43, v60
    v_dot2_f32_bf16 v61, v187, v43, v61
    s_cmp_eq_u32 s35, 1
    s_cbranch_scc1 L_fq35
    s_cbranch_vccnz L_fr35
    s_waitcnt vmcnt(4)
L_fr35:
    s_waitcnt vmcnt(5)
L_fq35:
    s_waitcnt vmcnt(7)
    buffer_load_dwordx4 v[92:95], v4, s[8:11], s78 offen offset:2048 nt
    s_cmp_eq_u32 s35, 1
    s_cbranch_scc1 L_fq36
    s_cbranch_vccnz L_fr36
    s_waitcnt vmcnt(4)
L_fr36:
    s_waitcnt vmcnt(5)
L_fq36:
    s_waitcnt vmcnt(7)
    buffer_load_dwordx4 v[96:99], v4, s[8:11], s78 offen offset:3072 nt
    v_dot2_f32_bf16 v62, v188, v40, 0
    v_dot2_f32_bf16 v63, v192, v40, 0
    v_dot2_f32_bf16 v62, v189, v41, v62
    v_dot2_f32_bf16 v63, v193, v41, v63
    v_dot2_f32_bf16 v62, v190, v42, v62
    v_dot2_f32_bf16 v63, v194, v42, v63
    v_dot2_f32_bf16 v62, v191, v43, v62
    v_dot2_f32_bf16 v63, v195, v43, v63
    s_memrealtime s[96:97]
    s_waitcnt lgkmcnt(0)
    s_sub_u32 s96, s96, s34
    s_cmp_gt_i32 s96, 1152
    s_cselect_b64 vcc, -1, 0
    s_cmp_gt_i32 s96, 1192
    s_cselect_b32 s35, 1, 0
    s_add_u32 s76, s76, 131072
    s_and_b32 s76, s76, 0x3fffff
    s_bfe_u32 s6, s76, 0x10011
    s_lshl_b32 s6, s6, 21
    s_xor_b32 s6, s6, s79
    s_and_b32 s5, s76, 0x1ffff
    s_xor_b32 s6, s6, s5
    s_lshr_b32 s5, s76, 18
    s_lshl_b32 s5, s5, 17
    s_xor_b32 s78, s6, s5
    s_cmp_eq_u32 s35, 1
    s_cbranch_scc1 L_fq37
    s_cbranch_vccnz L_fr37
    s_waitcnt vmcnt(4)
L_fr37:
    s_waitcnt vmcnt(5)
L_fq37:
    s_waitcnt vmcnt(7)
    buffer_load_dwordx4 v[100:103], v4, s[8:11], s78 offen offset:0 nt
    s_cmp_eq_u32 s35, 1
    s_cbranch_scc1 L_fq38
    s_cbranch_vccnz L_fr38
    s_waitcnt vmcnt(4)
L_fr38:
    s_waitcnt vmcnt(5)
L_fq38:
    s_waitcnt vmcnt(7)
    buffer_load_dwordx4 v[104:107], v4, s[8:11], s78 offen offset:1024 nt
    v_dot2_f32_bf16 v64, v196, v40, 0
    v_dot2_f32_bf16 v65, v200, v40, 0
    v_dot2_f32_bf16 v64, v197, v41, v64
    v_dot2_f32_bf16 v65, v201, v41, v65
    v_dot2_f32_bf16 v64, v198, v42, v64
    v_dot2_f32_bf16 v65, v202, v42, v65
    v_dot2_f32_bf16 v64, v199, v43, v64
    v_dot2_f32_bf16 v65, v203, v43, v65
    s_cmp_eq_u32 s35, 1
    s_cbranch_scc1 L_fq39
    s_cbranch_vccnz L_fr39
    s_waitcnt vmcnt(4)
L_fr39:
    s_waitcnt vmcnt(5)
L_fq39:
    s_waitcnt vmcnt(7)
    buffer_load_dwordx4 v[108:111], v4, s[8:11], s78 offen offset:2048 nt
    s_cmp_eq_u32 s35, 1
    s_cbranch_scc1 L_fq40
    s_cbranch_vccnz L_fr40
    s_waitcnt vmcnt(4)
L_fr40:
    s_waitcnt vmcnt(5)
L_fq40:
    s_waitcnt vmcnt(7)
    buffer_load_dwordx4 v[112:115], v4, s[8:11], s78 offen offset:3072 nt
    v_dot2_f32_bf16 v66, v204, v40, 0
    v_dot2_f32_bf16 v67, v208, v40, 0
    v_dot2_f32_bf16 v66, v205, v41, v66
    v_dot2_f32_bf16 v67, v209, v41, v67
    v_dot2_f32_bf16 v66, v206, v42, v66
    v_dot2_f32_bf16 v67, v210, v42, v67
    v_dot2_f32_bf16 v66, v207, v43, v66
    v_dot2_f32_bf16 v67, v211, v43, v67
    v_add_f32_dpp v52, v52, v52 row_ror:8 row_mask:0xf bank_mask:0x3
    v_add_f32_dpp v53, v53, v53 row_ror:8 row_mask:0xf bank_mask:0x3
    v_add_f32_dpp v54, v54, v54 row_ror:8 row_mask:0xf bank_mask:0x3
    v_add_f32_dpp v55, v55, v55 row_ror:8 row_mask:0xf bank_mask:0x3
    v_add_f32_dpp v56, v56, v56 row_ror:8 row_mask:0xf bank_mask:0x3
    v_add_f32_dpp v57, v57, v57 row_ror:8 row_mask:0xf bank_mask:0x3
    v_add_f32_dpp v58, v58, v58 row_ror:8 row_mask:0xf bank_mask:0x3
    v_add_f32_dpp v59, v59, v59 row_ror:8 row_mask:0xf bank_mask:0x3
    v_add_f32_dpp v52, v60, v60 row_ror:8 row_mask:0xf bank_mask:0xc
    v_add_f32_dpp v53, v61, v61 row_ror:8 row_mask:0xf bank_mask:0xc
    v_add_f32_dpp v54, v62, v62 row_ror:8 row_mask:0xf bank_mask:0xc
    v_add_f32_dpp v55, v63, v63 row_ror:8 row_mask:0xf bank_mask:0xc
    v_add_f32_dpp v56, v64, v64 row_ror:8 row_mask:0xf bank_mask:0xc
    v_add_f32_dpp v57, v65, v65 row_ror:8 row_mask:0xf bank_mask:0xc
    v_add_f32_dpp v58, v66, v66 row_ror:8 row_mask:0xf bank_mask:0xc
    v_add_f32_dpp v59, v67, v67 row_ror:8 row_mask:0xf bank_mask:0xc
    v_add_f32_dpp v60, v52, v52 row_shl:4 row_mask:0xf bank_mask:0x5
    v_add_f32_dpp v61, v53, v53 row_shl:4 row_mask:0xf bank_mask:0x5
    v_add_f32_dpp v62, v54, v54 row_shl:4 row_mask:0xf bank_mask:0x5
    v_add_f32_dpp v63, v55, v55 row_shl:4 row_mask:0xf bank_mask:0x5
    v_add_f32_dpp v60, v56, v56 row_shr:4 row_mask:0xf bank_mask:0xa
    v_add_f32_dpp v61, v57, v57 row_shr:4 row_mask:0xf bank_mask:0xa
    v_add_f32_dpp v62, v58, v58 row_shr:4 row_mask:0xf bank_mask:0xa
    v_add_f32_dpp v63, v59, v59 row_shr:4 row_mask:0xf bank_mask:0xa
    v_add_f32_dpp v60, v60, v60 quad_perm:[2,3,0,1] row_mask:0xf bank_mask:0xf
    v_add_f32_dpp v61, v61, v61 quad_perm:[2,3,0,1] row_mask:0xf bank_mask:0xf
    v_add_f32_dpp v62, v62, v62 quad_perm:[2,3,0,1] row_mask:0xf bank_mask:0xf
    v_add_f32_dpp v63, v63, v63 quad_perm:[2,3,0,1] row_mask:0xf bank_mask:0xf
    v_cndmask_b32 v60, v60, v62, s[16:17]
    v_cndmask_b32 v61, v61, v63, s[16:17]
    s_nop 0
    v_add_f32_dpp v60, v60, v60 quad_perm:[1,0,3,2] row_mask:0xf bank_mask:0xf
    v_add_f32_dpp v61, v61, v61 quad_perm:[1,0,3,2] row_mask:0xf bank_mask:0xf
    v_cndmask_b32 v47, v60, v61, s[18:19]
    v_cvt_pk_bf16_f32 v47, v47, v47
    v_lshlrev_b32 v47, 16, v47
    v_mul_f32 v47, 0x3db504f3, v47
    v_cvt_pk_bf16_f32 v47, v47, v47
    v_lshlrev_b32 v47, 16, v47
    s_mov_b64 exec, 1
    v_mov_b32 v12, 1
    ds_add_u32 v20, v12 offset:276
    s_mov_b64 exec, -1
    s_memrealtime s[96:97]
    s_waitcnt lgkmcnt(0)
    s_sub_u32 s96, s96, s34
    s_cmp_gt_i32 s96, 1208
    s_cselect_b64 vcc, -1, 0
    s_cmp_gt_i32 s96, 1248
    s_cselect_b32 s35, 1, 0
    s_add_u32 s76, s76, 131072
    s_and_b32 s76, s76, 0x3fffff
    s_bfe_u32 s6, s76, 0x10011
    s_lshl_b32 s6, s6, 21
    s_xor_b32 s6, s6, s79
    s_and_b32 s5, s76, 0x1ffff
    s_xor_b32 s6, s6, s5
    s_lshr_b32 s5, s76, 18
    s_lshl_b32 s5, s5, 17
    s_xor_b32 s78, s6, s5
    s_cmp_eq_u32 s35, 1
    s_cbranch_scc1 L_fq41
    s_cbranch_vccnz L_fr41
    s_waitcnt vmcnt(4)
L_fr41:
    s_waitcnt vmcnt(5)
L_fq41:
    s_waitcnt vmcnt(7)
    buffer_load_dwordx4 v[116:119], v4, s[8:11], s78 offen offset:0 nt
    s_cmp_eq_u32 s35, 1
    s_cbranch_scc1 L_fq42
    s_cbranch_vccnz L_fr42
    s_waitcnt vmcnt(4)
L_fr42:
    s_waitcnt vmcnt(5)
L_fq42:
    s_waitcnt vmcnt(7)
    buffer_load_dwordx4 v[120:123], v4, s[8:11], s78 offen offset:1024 nt
    v_dot2_f32_bf16 v52, v84, v40, 0
    v_dot2_f32_bf16 v53, v88, v40, 0
    v_dot2_f32_bf16 v52, v85, v41, v52
    v_dot2_f32_bf16 v53, v89, v41, v53
    v_dot2_f32_bf16 v52, v86, v42, v52
    v_dot2_f32_bf16 v53, v90, v42, v53
    v_dot2_f32_bf16 v52, v87, v43, v52
    v_dot2_f32_bf16 v53, v91, v43, v53
    s_cmp_eq_u32 s35, 1
    s_cbranch_scc1 L_fq43
    s_cbranch_vccnz L_fr43
    s_waitcnt vmcnt(4)
L_fr43:
    s_waitcnt vmcnt(5)
L_fq43:
    s_waitcnt vmcnt(7)
    buffer_load_dwordx4 v[124:127], v4, s[8:11], s78 offen offset:2048 nt
    s_cmp_eq_u32 s35, 1
    s_cbranch_scc1 L_fq44
    s_cbranch_vccnz L_fr44
    s_waitcnt vmcnt(4)
L_fr44:
    s_waitcnt vmcnt(5)
L_fq44:
    s_waitcnt vmcnt(7)
    buffer_load_dwordx4 v[128:131], v4, s[8:11], s78 offen offset:3072 nt
    v_dot2_f32_bf16 v54, v92, v40, 0
    v_dot2_f32_bf16 v55, v96, v40, 0
    v_dot2_f32_bf16 v54, v93, v41, v54
    v_dot2_f32_bf16 v55, v97, v41, v55
    v_dot2_f32_bf16 v54, v94, v42, v54
    v_dot2_f32_bf16 v55, v98, v42, v55
    v_dot2_f32_bf16 v54, v95, v43, v54
    v_dot2_f32_bf16 v55, v99, v43, v55
    s_memrealtime s[96:97]
    s_waitcnt lgkmcnt(0)
    s_sub_u32 s96, s96, s34
    s_cmp_gt_i32 s96, 1264
    s_cselect_b64 vcc, -1, 0
    s_cmp_gt_i32 s96, 1304
    s_cselect_b32 s35, 1, 0
    s_add_u32 s76, s76, 131072
    s_and_b32 s76, s76, 0x3fffff
    s_bfe_u32 s6, s76, 0x10011
    s_lshl_b32 s6, s6, 21
    s_xor_b32 s6, s6, s79
    s_and_b32 s5, s76, 0x1ffff
    s_xor_b32 s6, s6, s5
    s_lshr_b32 s5, s76, 18
    s_lshl_b32 s5, s5, 17
    s_xor_b32 s78, s6, s5
    s_cmp_eq_u32 s35, 1
    s_cbranch_scc1 L_fq45
    s_cbranch_vccnz L_fr45
    s_waitcnt vmcnt(4)
L_fr45:
    s_waitcnt vmcnt(5)
L_fq45:
    s_waitcnt vmcnt(7)
    buffer_load_dwordx4 v[132:135], v4, s[8:11], s78 offen offset:0 nt
    s_cmp_eq_u32 s35, 1
    s_cbranch_scc1 L_fq46
    s_cbranch_vccnz L_fr46
    s_waitcnt vmcnt(4)
L_fr46:
    s_waitcnt vmcnt(5)
L_fq46:
    s_waitcnt vmcnt(7)
    buffer_load_dwordx4 v[136:139], v4, s[8:11], s78 offen offset:1024 nt
    v_dot2_f32_bf16 v56, v100, v40, 0
    v_dot2_f32_bf16 v57, v104, v40, 0
    v_dot2_f32_bf16 v56, v101, v41, v56
    v_dot2_f32_bf16 v57, v105, v41, v57
    v_dot2_f32_bf16 v56, v102, v42, v56
    v_dot2_f32_bf16 v57, v106, v42, v57
    v_dot2_f32_bf16 v56, v103, v43, v56
    v_dot2_f32_bf16 v57, v107, v43, v57
    s_cmp_eq_u32 s35, 1
    s_cbranch_scc1 L_fq47
    s_cbranch_vccnz L_fr47
    s_waitcnt vmcnt(4)
L_fr47:
    s_waitcnt vmcnt(5)
L_fq47:
    s_waitcnt vmcnt(7)
    buffer_load_dwordx4 v[140:143], v4, s[8:11], s78 offen offset:2048 nt
    s_cmp_eq_u32 s35, 1
    s_cbranch_scc1 L_fq48
    s_cbranch_vccnz L_fr48
    s_waitcnt vmcnt(4)
L_fr48:
    s_waitcnt vmcnt(5)
L_fq48:
    s_waitcnt vmcnt(7)
    buffer_load_dwordx4 v[144:147], v4, s[8:11], s78 offen offset:3072 nt
    v_dot2_f32_bf16 v58, v108, v40, 0
    v_dot2_f32_bf16 v59, v112, v40, 0
    v_dot2_f32_bf16 v58, v109, v41, v58
    v_dot2_f32_bf16 v59, v113, v41, v59
    v_dot2_f32_bf16 v58, v110, v42, v58
    v_dot2_f32_bf16 v59, v114, v42, v59
    v_dot2_f32_bf16 v58, v111, v43, v58
    v_dot2_f32_bf16 v59, v115, v43, v59
    s_memrealtime s[96:97]
    s_waitcnt lgkmcnt(0)
    s_sub_u32 s96, s96, s34
    s_cmp_gt_i32 s96, 1320
    s_cselect_b64 vcc, -1, 0
    s_cmp_gt_i32 s96, 1360
    s_cselect_b32 s35, 1, 0
    s_add_u32 s76, s76, 131072
    s_and_b32 s76, s76, 0x3fffff
    s_bfe_u32 s6, s76, 0x10011
    s_lshl_b32 s6, s6, 21
    s_xor_b32 s6, s6, s79
    s_and_b32 s5, s76, 0x1ffff
    s_xor_b32 s6, s6, s5
    s_lshr_b32 s5, s76, 18
    s_lshl_b32 s5, s5, 17
    s_xor_b32 s78, s6, s5
    s_cmp_eq_u32 s35, 1
    s_cbranch_scc1 L_fq49
    s_cbranch_vccnz L_fr49
    s_waitcnt vmcnt(4)
L_fr49:
    s_waitcnt vmcnt(5)
L_fq49:
    s_waitcnt vmcnt(7)
    buffer_load_dwordx4 v[148:151], v4, s[8:11], s78 offen offset:0 nt
    s_cmp_eq_u32 s35, 1
    s_cbranch_scc1 L_fq50
    s_cbranch_vccnz L_fr50
    s_waitcnt vmcnt(4)
L_fr50:
    s_waitcnt vmcnt(5)
L_fq50:
    s_waitcnt vmcnt(7)
    buffer_load_dwordx4 v[152:155], v4, s[8:11], s78 offen offset:1024 nt
    v_dot2_f32_bf16 v60, v116, v40, 0
    v_dot2_f32_bf16 v61, v120, v40, 0
    v_dot2_f32_bf16 v60, v117, v41, v60
    v_dot2_f32_bf16 v61, v121, v41, v61
    v_dot2_f32_bf16 v60, v118, v42, v60
    v_dot2_f32_bf16 v61, v122, v42, v61
    v_dot2_f32_bf16 v60, v119, v43, v60
    v_dot2_f32_bf16 v61, v123, v43, v61
    s_cmp_eq_u32 s35, 1
    s_cbranch_scc1 L_fq51
    s_cbranch_vccnz L_fr51
    s_waitcnt vmcnt(4)
L_fr51:
    s_waitcnt vmcnt(5)
L_fq51:
    s_waitcnt vmcnt(7)
    buffer_load_dwordx4 v[156:159], v4, s[8:11], s78 offen offset:2048 nt
    s_cmp_eq_u32 s35, 1
    s_cbranch_scc1 L_fq52
    s_cbranch_vccnz L_fr52
    s_waitcnt vmcnt(4)
L_fr52:
    s_waitcnt vmcnt(5)
L_fq52:
    s_waitcnt vmcnt(7)
    buffer_load_dwordx4 v[160:163], v4, s[8:11], s78 offen offset:3072 nt
    v_dot2_f32_bf16 v62, v124, v40, 0
    v_dot2_f32_bf16 v63, v128, v40, 0
    v_dot2_f32_bf16 v62, v125, v41, v62
    v_dot2_f32_bf16 v63, v129, v41, v63
    v_dot2_f32_bf16 v62, v126, v42, v62
    v_dot2_f32_bf16 v63, v130, v42, v63
    v_dot2_f32_bf16 v62, v127, v43, v62
    v_dot2_f32_bf16 v63, v131, v43, v63
    s_memrealtime s[96:97]
    s_waitcnt lgkmcnt(0)
    s_sub_u32 s96, s96, s34
    s_cmp_gt_i32 s96, 1376
    s_cselect_b64 vcc, -1, 0
    s_cmp_gt_i32 s96, 1416
    s_cselect_b32 s35, 1, 0
    s_add_u32 s76, s76, 131072
    s_and_b32 s76, s76, 0x3fffff
    s_bfe_u32 s6, s76, 0x10011
    s_lshl_b32 s6, s6, 21
    s_xor_b32 s6, s6, s79
    s_and_b32 s5, s76, 0x1ffff
    s_xor_b32 s6, s6, s5
    s_lshr_b32 s5, s76, 18
    s_lshl_b32 s5, s5, 17
    s_xor_b32 s78, s6, s5
    s_cmp_eq_u32 s35, 1
    s_cbranch_scc1 L_fq53
    s_cbranch_vccnz L_fr53
    s_waitcnt vmcnt(4)
L_fr53:
    s_waitcnt vmcnt(5)
L_fq53:
    s_waitcnt vmcnt(7)
    buffer_load_dwordx4 v[164:167], v4, s[8:11], s78 offen offset:0 nt
    s_cmp_eq_u32 s35, 1
    s_cbranch_scc1 L_fq54
    s_cbranch_vccnz L_fr54
    s_waitcnt vmcnt(4)
L_fr54:
    s_waitcnt vmcnt(5)
L_fq54:
    s_waitcnt vmcnt(7)
    buffer_load_dwordx4 v[168:171], v4, s[8:11], s78 offen offset:1024 nt
    v_dot2_f32_bf16 v64, v132, v40, 0
    v_dot2_f32_bf16 v65, v136, v40, 0
    v_dot2_f32_bf16 v64, v133, v41, v64
    v_dot2_f32_bf16 v65, v137, v41, v65
    v_dot2_f32_bf16 v64, v134, v42, v64
    v_dot2_f32_bf16 v65, v138, v42, v65
    v_dot2_f32_bf16 v64, v135, v43, v64
    v_dot2_f32_bf16 v65, v139, v43, v65
    s_cmp_eq_u32 s35, 1
    s_cbranch_scc1 L_fq55
    s_cbranch_vccnz L_fr55
    s_waitcnt vmcnt(4)
L_fr55:
    s_waitcnt vmcnt(5)
L_fq55:
    s_waitcnt vmcnt(7)
    buffer_load_dwordx4 v[172:175], v4, s[8:11], s78 offen offset:2048 nt
    s_cmp_eq_u32 s35, 1
    s_cbranch_scc1 L_fq56
    s_cbranch_vccnz L_fr56
    s_waitcnt vmcnt(4)
L_fr56:
    s_waitcnt vmcnt(5)
L_fq56:
    s_waitcnt vmcnt(7)
    buffer_load_dwordx4 v[176:179], v4, s[8:11], s78 offen offset:3072 nt
    v_dot2_f32_bf16 v66, v140, v40, 0
    v_dot2_f32_bf16 v67, v144, v40, 0
    v_dot2_f32_bf16 v66, v141, v41, v66
    v_dot2_f32_bf16 v67, v145, v41, v67
    v_dot2_f32_bf16 v66, v142, v42, v66
    v_dot2_f32_bf16 v67, v146, v42, v67
    v_dot2_f32_bf16 v66, v143, v43, v66
    v_dot2_f32_bf16 v67, v147, v43, v67
    v_add_f32_dpp v52, v52, v52 row_ror:8 row_mask:0xf bank_mask:0x3
    v_add_f32_dpp v53, v53, v53 row_ror:8 row_mask:0xf bank_mask:0x3
    v_add_f32_dpp v54, v54, v54 row_ror:8 row_mask:0xf bank_mask:0x3
    v_add_f32_dpp v55, v55, v55 row_ror:8 row_mask:0xf bank_mask:0x3
    v_add_f32_dpp v56, v56, v56 row_ror:8 row_mask:0xf bank_mask:0x3
    v_add_f32_dpp v57, v57, v57 row_ror:8 row_mask:0xf bank_mask:0x3
    v_add_f32_dpp v58, v58, v58 row_ror:8 row_mask:0xf bank_mask:0x3
    v_add_f32_dpp v59, v59, v59 row_ror:8 row_mask:0xf bank_mask:0x3
    v_add_f32_dpp v52, v60, v60 row_ror:8 row_mask:0xf bank_mask:0xc
    v_add_f32_dpp v53, v61, v61 row_ror:8 row_mask:0xf bank_mask:0xc
    v_add_f32_dpp v54, v62, v62 row_ror:8 row_mask:0xf bank_mask:0xc
    v_add_f32_dpp v55, v63, v63 row_ror:8 row_mask:0xf bank_mask:0xc
    v_add_f32_dpp v56, v64, v64 row_ror:8 row_mask:0xf bank_mask:0xc
    v_add_f32_dpp v57, v65, v65 row_ror:8 row_mask:0xf bank_mask:0xc
    v_add_f32_dpp v58, v66, v66 row_ror:8 row_mask:0xf bank_mask:0xc
    v_add_f32_dpp v59, v67, v67 row_ror:8 row_mask:0xf bank_mask:0xc
    v_add_f32_dpp v60, v52, v52 row_shl:4 row_mask:0xf bank_mask:0x5
    v_add_f32_dpp v61, v53, v53 row_shl:4 row_mask:0xf bank_mask:0x5
    v_add_f32_dpp v62, v54, v54 row_shl:4 row_mask:0xf bank_mask:0x5
    v_add_f32_dpp v63, v55, v55 row_shl:4 row_mask:0xf bank_mask:0x5
    v_add_f32_dpp v60, v56, v56 row_shr:4 row_mask:0xf bank_mask:0xa
    v_add_f32_dpp v61, v57, v57 row_shr:4 row_mask:0xf bank_mask:0xa
    v_add_f32_dpp v62, v58, v58 row_shr:4 row_mask:0xf bank_mask:0xa
    v_add_f32_dpp v63, v59, v59 row_shr:4 row_mask:0xf bank_mask:0xa
    v_add_f32_dpp v60, v60, v60 quad_perm:[2,3,0,1] row_mask:0xf bank_mask:0xf
    v_add_f32_dpp v61, v61, v61 quad_perm:[2,3,0,1] row_mask:0xf bank_mask:0xf
    v_add_f32_dpp v62, v62, v62 quad_perm:[2,3,0,1] row_mask:0xf bank_mask:0xf
    v_add_f32_dpp v63, v63, v63 quad_perm:[2,3,0,1] row_mask:0xf bank_mask:0xf
    v_cndmask_b32 v60, v60, v62, s[16:17]
    v_cndmask_b32 v61, v61, v63, s[16:17]
    s_nop 0
    v_add_f32_dpp v60, v60, v60 quad_perm:[1,0,3,2] row_mask:0xf bank_mask:0xf
    v_add_f32_dpp v61, v61, v61 quad_perm:[1,0,3,2] row_mask:0xf bank_mask:0xf
    v_cndmask_b32 v48, v60, v61, s[18:19]
    v_cvt_pk_bf16_f32 v48, v48, v48
    v_lshlrev_b32 v48, 16, v48
    v_mul_f32 v48, 0x3db504f3, v48
    v_cvt_pk_bf16_f32 v48, v48, v48
    v_lshlrev_b32 v48, 16, v48
    s_memrealtime s[96:97]
    s_waitcnt lgkmcnt(0)
    s_sub_u32 s96, s96, s34
    s_cmp_gt_i32 s96, 1432
    s_cselect_b64 vcc, -1, 0
    s_cmp_gt_i32 s96, 1472
    s_cselect_b32 s35, 1, 0
    s_add_u32 s76, s76, 131072
    s_and_b32 s76, s76, 0x3fffff
    s_bfe_u32 s6, s76, 0x10011
    s_lshl_b32 s6, s6, 21
    s_xor_b32 s6, s6, s79
    s_and_b32 s5, s76, 0x1ffff
    s_xor_b32 s6, s6, s5
    s_lshr_b32 s5, s76, 18
    s_lshl_b32 s5, s5, 17
    s_xor_b32 s78, s6, s5
    s_cmp_eq_u32 s35, 1
    s_cbranch_scc1 L_fq57
    s_cbranch_vccnz L_fr57
    s_waitcnt vmcnt(4)
L_fr57:
    s_waitcnt vmcnt(5)
L_fq57:
    s_waitcnt vmcnt(7)
    buffer_load_dwordx4 v[180:183], v4, s[8:11], s78 offen offset:0 nt
    s_cmp_eq_u32 s35, 1
    s_cbranch_scc1 L_fq58
    s_cbranch_vccnz L_fr58
    s_waitcnt vmcnt(4)
L_fr58:
    s_waitcnt vmcnt(5)
L_fq58:
    s_waitcnt vmcnt(7)
    buffer_load_dwordx4 v[184:187], v4, s[8:11], s78 offen offset:1024 nt
    v_dot2_f32_bf16 v52, v148, v40, 0
    v_dot2_f32_bf16 v53, v152, v40, 0
    v_dot2_f32_bf16 v52, v149, v41, v52
    v_dot2_f32_bf16 v53, v153, v41, v53
    v_dot2_f32_bf16 v52, v150, v42, v52
    v_dot2_f32_bf16 v53, v154, v42, v53
    v_dot2_f32_bf16 v52, v151, v43, v52
    v_dot2_f32_bf16 v53, v155, v43, v53
    s_cmp_eq_u32 s35, 1
    s_cbranch_scc1 L_fq59
    s_cbranch_vccnz L_fr59
    s_waitcnt vmcnt(4)
L_fr59:
    s_waitcnt vmcnt(5)
L_fq59:
    s_waitcnt vmcnt(7)
    buffer_load_dwordx4 v[188:191], v4, s[8:11], s78 offen offset:2048 nt
    s_cmp_eq_u32 s35, 1
    s_cbranch_scc1 L_fq60
    s_cbranch_vccnz L_fr60
    s_waitcnt vmcnt(4)
L_fr60:
    s_waitcnt vmcnt(5)
L_fq60:
    s_waitcnt vmcnt(7)
    buffer_load_dwordx4 v[192:195], v4, s[8:11], s78 offen offset:3072 nt
    v_dot2_f32_bf16 v54, v156, v40, 0
    v_dot2_f32_bf16 v55, v160, v40, 0
    v_dot2_f32_bf16 v54, v157, v41, v54
    v_dot2_f32_bf16 v55, v161, v41, v55
    v_dot2_f32_bf16 v54, v158, v42, v54
    v_dot2_f32_bf16 v55, v162, v42, v55
    v_dot2_f32_bf16 v54, v159, v43, v54
    v_dot2_f32_bf16 v55, v163, v43, v55
    s_memrealtime s[96:97]
    s_waitcnt lgkmcnt(0)
    s_sub_u32 s96, s96, s34
    s_cmp_gt_i32 s96, 1488
    s_cselect_b64 vcc, -1, 0
    s_cmp_gt_i32 s96, 1528
    s_cselect_b32 s35, 1, 0
    s_add_u32 s76, s76, 131072
    s_and_b32 s76, s76, 0x3fffff
    s_bfe_u32 s6, s76, 0x10011
    s_lshl_b32 s6, s6, 21
    s_xor_b32 s6, s6, s79
    s_and_b32 s5, s76, 0x1ffff
    s_xor_b32 s6, s6, s5
    s_lshr_b32 s5, s76, 18
    s_lshl_b32 s5, s5, 17
    s_xor_b32 s78, s6, s5
    s_cmp_eq_u32 s35, 1
    s_cbranch_scc1 L_fq61
    s_cbranch_vccnz L_fr61
    s_waitcnt vmcnt(4)
L_fr61:
    s_waitcnt vmcnt(5)
L_fq61:
    s_waitcnt vmcnt(7)
    buffer_load_dwordx4 v[196:199], v4, s[8:11], s78 offen offset:0 nt
    s_cmp_eq_u32 s35, 1
    s_cbranch_scc1 L_fq62
    s_cbranch_vccnz L_fr62
    s_waitcnt vmcnt(4)
L_fr62:
    s_waitcnt vmcnt(5)
L_fq62:
    s_waitcnt vmcnt(7)
    buffer_load_dwordx4 v[200:203], v4, s[8:11], s78 offen offset:1024 nt
    v_dot2_f32_bf16 v56, v164, v40, 0
    v_dot2_f32_bf16 v57, v168, v40, 0
    v_dot2_f32_bf16 v56, v165, v41, v56
    v_dot2_f32_bf16 v57, v169, v41, v57
    v_dot2_f32_bf16 v56, v166, v42, v56
    v_dot2_f32_bf16 v57, v170, v42, v57
    v_dot2_f32_bf16 v56, v167, v43, v56
    v_dot2_f32_bf16 v57, v171, v43, v57
    s_cmp_eq_u32 s35, 1
    s_cbranch_scc1 L_fq63
    s_cbranch_vccnz L_fr63
    s_waitcnt vmcnt(4)
L_fr63:
    s_waitcnt vmcnt(5)
L_fq63:
    s_waitcnt vmcnt(7)
    buffer_load_dwordx4 v[204:207], v4, s[8:11], s78 offen offset:2048 nt
    s_cmp_eq_u32 s35, 1
    s_cbranch_scc1 L_fq64
    s_cbranch_vccnz L_fr64
    s_waitcnt vmcnt(4)
L_fr64:
    s_waitcnt vmcnt(5)
L_fq64:
    s_waitcnt vmcnt(7)
    buffer_load_dwordx4 v[208:211], v4, s[8:11], s78 offen offset:3072 nt
    v_dot2_f32_bf16 v58, v172, v40, 0
    v_dot2_f32_bf16 v59, v176, v40, 0
    v_dot2_f32_bf16 v58, v173, v41, v58
    v_dot2_f32_bf16 v59, v177, v41, v59
    v_dot2_f32_bf16 v58, v174, v42, v58
    v_dot2_f32_bf16 v59, v178, v42, v59
    v_dot2_f32_bf16 v58, v175, v43, v58
    v_dot2_f32_bf16 v59, v179, v43, v59
    s_memrealtime s[96:97]
    s_waitcnt lgkmcnt(0)
    s_sub_u32 s96, s96, s34
    s_cmp_gt_i32 s96, 1544
    s_cselect_b64 vcc, -1, 0
    s_cmp_gt_i32 s96, 1584
    s_cselect_b32 s35, 1, 0
    s_add_u32 s76, s76, 131072
    s_and_b32 s76, s76, 0x3fffff
    s_bfe_u32 s6, s76, 0x10011
    s_lshl_b32 s6, s6, 21
    s_xor_b32 s6, s6, s79
    s_and_b32 s5, s76, 0x1ffff
    s_xor_b32 s6, s6, s5
    s_lshr_b32 s5, s76, 18
    s_lshl_b32 s5, s5, 17
    s_xor_b32 s78, s6, s5
    s_cmp_eq_u32 s35, 1
    s_cbranch_scc1 L_fq65
    s_cbranch_vccnz L_fr65
    s_waitcnt vmcnt(4)
L_fr65:
    s_waitcnt vmcnt(5)
L_fq65:
    s_waitcnt vmcnt(7)
    buffer_load_dwordx4 v[84:87], v4, s[8:11], s78 offen offset:0 nt
    s_cmp_eq_u32 s35, 1
    s_cbranch_scc1 L_fq66
    s_cbranch_vccnz L_fr66
    s_waitcnt vmcnt(4)
L_fr66:
    s_waitcnt vmcnt(5)
L_fq66:
    s_waitcnt vmcnt(7)
    buffer_load_dwordx4 v[88:91], v4, s[8:11], s78 offen offset:1024 nt
    v_dot2_f32_bf16 v60, v180, v40, 0
    v_dot2_f32_bf16 v61, v184, v40, 0
    v_dot2_f32_bf16 v60, v181, v41, v60
    v_dot2_f32_bf16 v61, v185, v41, v61
    v_dot2_f32_bf16 v60, v182, v42, v60
    v_dot2_f32_bf16 v61, v186, v42, v61
    v_dot2_f32_bf16 v60, v183, v43, v60
    v_dot2_f32_bf16 v61, v187, v43, v61
    s_cmp_eq_u32 s35, 1
    s_cbranch_scc1 L_fq67
    s_cbranch_vccnz L_fr67
    s_waitcnt vmcnt(4)
L_fr67:
    s_waitcnt vmcnt(5)
L_fq67:
    s_waitcnt vmcnt(7)
    buffer_load_dwordx4 v[92:95], v4, s[8:11], s78 offen offset:2048 nt
    s_cmp_eq_u32 s35, 1
    s_cbranch_scc1 L_fq68
    s_cbranch_vccnz L_fr68
    s_waitcnt vmcnt(4)
L_fr68:
    s_waitcnt vmcnt(5)
L_fq68:
    s_waitcnt vmcnt(7)
    buffer_load_dwordx4 v[96:99], v4, s[8:11], s78 offen offset:3072 nt
    v_dot2_f32_bf16 v62, v188, v40, 0
    v_dot2_f32_bf16 v63, v192, v40, 0
    v_dot2_f32_bf16 v62, v189, v41, v62
    v_dot2_f32_bf16 v63, v193, v41, v63
    v_dot2_f32_bf16 v62, v190, v42, v62
    v_dot2_f32_bf16 v63, v194, v42, v63
    v_dot2_f32_bf16 v62, v191, v43, v62
    v_dot2_f32_bf16 v63, v195, v43, v63
    s_memrealtime s[96:97]
    s_waitcnt lgkmcnt(0)
    s_sub_u32 s96, s96, s34
    s_cmp_gt_i32 s96, 1600
    s_cselect_b64 vcc, -1, 0
    s_cmp_gt_i32 s96, 1640
    s_cselect_b32 s35, 1, 0
    s_add_u32 s76, s76, 131072
    s_and_b32 s76, s76, 0x3fffff
    s_bfe_u32 s6, s76, 0x10011
    s_lshl_b32 s6, s6, 21
    s_xor_b32 s6, s6, s79
    s_and_b32 s5, s76, 0x1ffff
    s_xor_b32 s6, s6, s5
    s_lshr_b32 s5, s76, 18
    s_lshl_b32 s5, s5, 17
    s_xor_b32 s78, s6, s5
    s_cmp_eq_u32 s35, 1
    s_cbranch_scc1 L_fq69
    s_cbranch_vccnz L_fr69
    s_waitcnt vmcnt(4)
L_fr69:
    s_waitcnt vmcnt(5)
L_fq69:
    s_waitcnt vmcnt(7)
    buffer_load_dwordx4 v[100:103], v4, s[8:11], s78 offen offset:0 nt
    s_cmp_eq_u32 s35, 1
    s_cbranch_scc1 L_fq70
    s_cbranch_vccnz L_fr70
    s_waitcnt vmcnt(4)
L_fr70:
    s_waitcnt vmcnt(5)
L_fq70:
    s_waitcnt vmcnt(7)
    buffer_load_dwordx4 v[104:107], v4, s[8:11], s78 offen offset:1024 nt
    v_dot2_f32_bf16 v64, v196, v40, 0
    v_dot2_f32_bf16 v65, v200, v40, 0
    v_dot2_f32_bf16 v64, v197, v41, v64
    v_dot2_f32_bf16 v65, v201, v41, v65
    v_dot2_f32_bf16 v64, v198, v42, v64
    v_dot2_f32_bf16 v65, v202, v42, v65
    v_dot2_f32_bf16 v64, v199, v43, v64
    v_dot2_f32_bf16 v65, v203, v43, v65
    s_cmp_eq_u32 s35, 1
    s_cbranch_scc1 L_fq71
    s_cbranch_vccnz L_fr71
    s_waitcnt vmcnt(4)
L_fr71:
    s_waitcnt vmcnt(5)
L_fq71:
    s_waitcnt vmcnt(7)
    buffer_load_dwordx4 v[108:111], v4, s[8:11], s78 offen offset:2048 nt
    s_cmp_eq_u32 s35, 1
    s_cbranch_scc1 L_fq72
    s_cbranch_vccnz L_fr72
    s_waitcnt vmcnt(4)
L_fr72:
    s_waitcnt vmcnt(5)
L_fq72:
    s_waitcnt vmcnt(7)
    buffer_load_dwordx4 v[112:115], v4, s[8:11], s78 offen offset:3072 nt
    v_dot2_f32_bf16 v66, v204, v40, 0
    v_dot2_f32_bf16 v67, v208, v40, 0
    v_dot2_f32_bf16 v66, v205, v41, v66
    v_dot2_f32_bf16 v67, v209, v41, v67
    v_dot2_f32_bf16 v66, v206, v42, v66
    v_dot2_f32_bf16 v67, v210, v42, v67
    v_dot2_f32_bf16 v66, v207, v43, v66
    v_dot2_f32_bf16 v67, v211, v43, v67
    v_add_f32_dpp v52, v52, v52 row_ror:8 row_mask:0xf bank_mask:0x3
    v_add_f32_dpp v53, v53, v53 row_ror:8 row_mask:0xf bank_mask:0x3
    v_add_f32_dpp v54, v54, v54 row_ror:8 row_mask:0xf bank_mask:0x3
    v_add_f32_dpp v55, v55, v55 row_ror:8 row_mask:0xf bank_mask:0x3
    v_add_f32_dpp v56, v56, v56 row_ror:8 row_mask:0xf bank_mask:0x3
    v_add_f32_dpp v57, v57, v57 row_ror:8 row_mask:0xf bank_mask:0x3
    v_add_f32_dpp v58, v58, v58 row_ror:8 row_mask:0xf bank_mask:0x3
    v_add_f32_dpp v59, v59, v59 row_ror:8 row_mask:0xf bank_mask:0x3
    v_add_f32_dpp v52, v60, v60 row_ror:8 row_mask:0xf bank_mask:0xc
    v_add_f32_dpp v53, v61, v61 row_ror:8 row_mask:0xf bank_mask:0xc
    v_add_f32_dpp v54, v62, v62 row_ror:8 row_mask:0xf bank_mask:0xc
    v_add_f32_dpp v55, v63, v63 row_ror:8 row_mask:0xf bank_mask:0xc
    v_add_f32_dpp v56, v64, v64 row_ror:8 row_mask:0xf bank_mask:0xc
    v_add_f32_dpp v57, v65, v65 row_ror:8 row_mask:0xf bank_mask:0xc
    v_add_f32_dpp v58, v66, v66 row_ror:8 row_mask:0xf bank_mask:0xc
    v_add_f32_dpp v59, v67, v67 row_ror:8 row_mask:0xf bank_mask:0xc
    v_add_f32_dpp v60, v52, v52 row_shl:4 row_mask:0xf bank_mask:0x5
    v_add_f32_dpp v61, v53, v53 row_shl:4 row_mask:0xf bank_mask:0x5
    v_add_f32_dpp v62, v54, v54 row_shl:4 row_mask:0xf bank_mask:0x5
    v_add_f32_dpp v63, v55, v55 row_shl:4 row_mask:0xf bank_mask:0x5
    v_add_f32_dpp v60, v56, v56 row_shr:4 row_mask:0xf bank_mask:0xa
    v_add_f32_dpp v61, v57, v57 row_shr:4 row_mask:0xf bank_mask:0xa
    v_add_f32_dpp v62, v58, v58 row_shr:4 row_mask:0xf bank_mask:0xa
    v_add_f32_dpp v63, v59, v59 row_shr:4 row_mask:0xf bank_mask:0xa
    v_add_f32_dpp v60, v60, v60 quad_perm:[2,3,0,1] row_mask:0xf bank_mask:0xf
    v_add_f32_dpp v61, v61, v61 quad_perm:[2,3,0,1] row_mask:0xf bank_mask:0xf
    v_add_f32_dpp v62, v62, v62 quad_perm:[2,3,0,1] row_mask:0xf bank_mask:0xf
    v_add_f32_dpp v63, v63, v63 quad_perm:[2,3,0,1] row_mask:0xf bank_mask:0xf
    v_cndmask_b32 v60, v60, v62, s[16:17]
    v_cndmask_b32 v61, v61, v63, s[16:17]
    s_nop 0
    v_add_f32_dpp v60, v60, v60 quad_perm:[1,0,3,2] row_mask:0xf bank_mask:0xf
    v_add_f32_dpp v61, v61, v61 quad_perm:[1,0,3,2] row_mask:0xf bank_mask:0xf
    v_cndmask_b32 v49, v60, v61, s[18:19]
    v_cvt_pk_bf16_f32 v49, v49, v49
    v_lshlrev_b32 v49, 16, v49
    v_mul_f32 v49, 0x3db504f3, v49
    v_cvt_pk_bf16_f32 v49, v49, v49
    v_lshlrev_b32 v49, 16, v49
    s_memrealtime s[96:97]
    s_waitcnt lgkmcnt(0)
    s_sub_u32 s96, s96, s34
    s_cmp_gt_i32 s96, 1656
    s_cselect_b64 vcc, -1, 0
    s_cmp_gt_i32 s96, 1696
    s_cselect_b32 s35, 1, 0
    s_add_u32 s76, s76, 131072
    s_and_b32 s76, s76, 0x3fffff
    s_bfe_u32 s6, s76, 0x10011
    s_lshl_b32 s6, s6, 21
    s_xor_b32 s6, s6, s79
    s_and_b32 s5, s76, 0x1ffff
    s_xor_b32 s6, s6, s5
    s_lshr_b32 s5, s76, 18
    s_lshl_b32 s5, s5, 17
    s_xor_b32 s78, s6, s5
    s_cmp_eq_u32 s35, 1
    s_cbranch_scc1 L_fq73
    s_cbranch_vccnz L_fr73
    s_waitcnt vmcnt(4)
L_fr73:
    s_waitcnt vmcnt(5)
L_fq73:
    s_waitcnt vmcnt(7)
    buffer_load_dwordx4 v[116:119], v4, s[8:11], s78 offen offset:0 nt
    s_cmp_eq_u32 s35, 1
    s_cbranch_scc1 L_fq74
    s_cbranch_vccnz L_fr74
    s_waitcnt vmcnt(4)
L_fr74:
    s_waitcnt vmcnt(5)
L_fq74:
    s_waitcnt vmcnt(7)
    buffer_load_dwordx4 v[120:123], v4, s[8:11], s78 offen offset:1024 nt
    v_dot2_f32_bf16 v52, v84, v40, 0
    v_dot2_f32_bf16 v53, v88, v40, 0
    v_dot2_f32_bf16 v52, v85, v41, v52
    v_dot2_f32_bf16 v53, v89, v41, v53
    v_dot2_f32_bf16 v52, v86, v42, v52
    v_dot2_f32_bf16 v53, v90, v42, v53
    v_dot2_f32_bf16 v52, v87, v43, v52
    v_dot2_f32_bf16 v53, v91, v43, v53
    s_cmp_eq_u32 s35, 1
    s_cbranch_scc1 L_fq75
    s_cbranch_vccnz L_fr75
    s_waitcnt vmcnt(4)
L_fr75:
    s_waitcnt vmcnt(5)
L_fq75:
    s_waitcnt vmcnt(7)
    buffer_load_dwordx4 v[124:127], v4, s[8:11], s78 offen offset:2048 nt
    s_cmp_eq_u32 s35, 1
    s_cbranch_scc1 L_fq76
    s_cbranch_vccnz L_fr76
    s_waitcnt vmcnt(4)
L_fr76:
    s_waitcnt vmcnt(5)
L_fq76:
    s_waitcnt vmcnt(7)
    buffer_load_dwordx4 v[128:131], v4, s[8:11], s78 offen offset:3072 nt
    v_dot2_f32_bf16 v54, v92, v40, 0
    v_dot2_f32_bf16 v55, v96, v40, 0
    v_dot2_f32_bf16 v54, v93, v41, v54
    v_dot2_f32_bf16 v55, v97, v41, v55
    v_dot2_f32_bf16 v54, v94, v42, v54
    v_dot2_f32_bf16 v55, v98, v42, v55
    v_dot2_f32_bf16 v54, v95, v43, v54
    v_dot2_f32_bf16 v55, v99, v43, v55
    s_memrealtime s[96:97]
    s_waitcnt lgkmcnt(0)
    s_sub_u32 s96, s96, s34
    s_cmp_gt_i32 s96, 1712
    s_cselect_b64 vcc, -1, 0
    s_cmp_gt_i32 s96, 1752
    s_cselect_b32 s35, 1, 0
    s_add_u32 s76, s76, 131072
    s_and_b32 s76, s76, 0x3fffff
    s_bfe_u32 s6, s76, 0x10011
    s_lshl_b32 s6, s6, 21
    s_xor_b32 s6, s6, s79
    s_and_b32 s5, s76, 0x1ffff
    s_xor_b32 s6, s6, s5
    s_lshr_b32 s5, s76, 18
    s_lshl_b32 s5, s5, 17
    s_xor_b32 s78, s6, s5
    s_cmp_eq_u32 s35, 1
    s_cbranch_scc1 L_fq77
    s_cbranch_vccnz L_fr77
    s_waitcnt vmcnt(4)
L_fr77:
    s_waitcnt vmcnt(5)
L_fq77:
    s_waitcnt vmcnt(7)
    buffer_load_dwordx4 v[132:135], v4, s[8:11], s78 offen offset:0 nt
    s_cmp_eq_u32 s35, 1
    s_cbranch_scc1 L_fq78
    s_cbranch_vccnz L_fr78
    s_waitcnt vmcnt(4)
L_fr78:
    s_waitcnt vmcnt(5)
L_fq78:
    s_waitcnt vmcnt(7)
    buffer_load_dwordx4 v[136:139], v4, s[8:11], s78 offen offset:1024 nt
    v_dot2_f32_bf16 v56, v100, v40, 0
    v_dot2_f32_bf16 v57, v104, v40, 0
    v_dot2_f32_bf16 v56, v101, v41, v56
    v_dot2_f32_bf16 v57, v105, v41, v57
    v_dot2_f32_bf16 v56, v102, v42, v56
    v_dot2_f32_bf16 v57, v106, v42, v57
    v_dot2_f32_bf16 v56, v103, v43, v56
    v_dot2_f32_bf16 v57, v107, v43, v57
    s_cmp_eq_u32 s35, 1
    s_cbranch_scc1 L_fq79
    s_cbranch_vccnz L_fr79
    s_waitcnt vmcnt(4)
L_fr79:
    s_waitcnt vmcnt(5)
L_fq79:
    s_waitcnt vmcnt(7)
    buffer_load_dwordx4 v[140:143], v4, s[8:11], s78 offen offset:2048 nt
    s_cmp_eq_u32 s35, 1
    s_cbranch_scc1 L_fq80
    s_cbranch_vccnz L_fr80
    s_waitcnt vmcnt(4)
L_fr80:
    s_waitcnt vmcnt(5)
L_fq80:
    s_waitcnt vmcnt(7)
    buffer_load_dwordx4 v[144:147], v4, s[8:11], s78 offen offset:3072 nt
    v_dot2_f32_bf16 v58, v108, v40, 0
    v_dot2_f32_bf16 v59, v112, v40, 0
    v_dot2_f32_bf16 v58, v109, v41, v58
    v_dot2_f32_bf16 v59, v113, v41, v59
    v_dot2_f32_bf16 v58, v110, v42, v58
    v_dot2_f32_bf16 v59, v114, v42, v59
    v_dot2_f32_bf16 v58, v111, v43, v58
    v_dot2_f32_bf16 v59, v115, v43, v59
    s_memrealtime s[96:97]
    s_waitcnt lgkmcnt(0)
    s_sub_u32 s96, s96, s34
    s_cmp_gt_i32 s96, 1768
    s_cselect_b64 vcc, -1, 0
    s_cmp_gt_i32 s96, 1808
    s_cselect_b32 s35, 1, 0
    s_add_u32 s76, s76, 131072
    s_and_b32 s76, s76, 0x3fffff
    s_bfe_u32 s6, s76, 0x10011
    s_lshl_b32 s6, s6, 21
    s_xor_b32 s6, s6, s79
    s_and_b32 s5, s76, 0x1ffff
    s_xor_b32 s6, s6, s5
    s_lshr_b32 s5, s76, 18
    s_lshl_b32 s5, s5, 17
    s_xor_b32 s78, s6, s5
    s_cmp_eq_u32 s35, 1
    s_cbranch_scc1 L_fq81
    s_cbranch_vccnz L_fr81
    s_waitcnt vmcnt(4)
L_fr81:
    s_waitcnt vmcnt(5)
L_fq81:
    s_waitcnt vmcnt(7)
    buffer_load_dwordx4 v[148:151], v4, s[8:11], s78 offen offset:0 nt
    s_cmp_eq_u32 s35, 1
    s_cbranch_scc1 L_fq82
    s_cbranch_vccnz L_fr82
    s_waitcnt vmcnt(4)
L_fr82:
    s_waitcnt vmcnt(5)
L_fq82:
    s_waitcnt vmcnt(7)
    buffer_load_dwordx4 v[152:155], v4, s[8:11], s78 offen offset:1024 nt
    v_dot2_f32_bf16 v60, v116, v40, 0
    v_dot2_f32_bf16 v61, v120, v40, 0
    v_dot2_f32_bf16 v60, v117, v41, v60
    v_dot2_f32_bf16 v61, v121, v41, v61
    v_dot2_f32_bf16 v60, v118, v42, v60
    v_dot2_f32_bf16 v61, v122, v42, v61
    v_dot2_f32_bf16 v60, v119, v43, v60
    v_dot2_f32_bf16 v61, v123, v43, v61
    s_cmp_eq_u32 s35, 1
    s_cbranch_scc1 L_fq83
    s_cbranch_vccnz L_fr83
    s_waitcnt vmcnt(4)
L_fr83:
    s_waitcnt vmcnt(5)
L_fq83:
    s_waitcnt vmcnt(7)
    buffer_load_dwordx4 v[156:159], v4, s[8:11], s78 offen offset:2048 nt
    s_cmp_eq_u32 s35, 1
    s_cbranch_scc1 L_fq84
    s_cbranch_vccnz L_fr84
    s_waitcnt vmcnt(4)
L_fr84:
    s_waitcnt vmcnt(5)
L_fq84:
    s_waitcnt vmcnt(7)
    buffer_load_dwordx4 v[160:163], v4, s[8:11], s78 offen offset:3072 nt
    v_dot2_f32_bf16 v62, v124, v40, 0
    v_dot2_f32_bf16 v63, v128, v40, 0
    v_dot2_f32_bf16 v62, v125, v41, v62
    v_dot2_f32_bf16 v63, v129, v41, v63
    v_dot2_f32_bf16 v62, v126, v42, v62
    v_dot2_f32_bf16 v63, v130, v42, v63
    v_dot2_f32_bf16 v62, v127, v43, v62
    v_dot2_f32_bf16 v63, v131, v43, v63
    s_memrealtime s[96:97]
    s_waitcnt lgkmcnt(0)
    s_sub_u32 s96, s96, s34
    s_cmp_gt_i32 s96, 1824
    s_cselect_b64 vcc, -1, 0
    s_cmp_gt_i32 s96, 1864
    s_cselect_b32 s35, 1, 0
    s_add_u32 s76, s76, 131072
    s_and_b32 s76, s76, 0x3fffff
    s_bfe_u32 s6, s76, 0x10011
    s_lshl_b32 s6, s6, 21
    s_xor_b32 s6, s6, s79
    s_and_b32 s5, s76, 0x1ffff
    s_xor_b32 s6, s6, s5
    s_lshr_b32 s5, s76, 18
    s_lshl_b32 s5, s5, 17
    s_xor_b32 s78, s6, s5
    s_cmp_eq_u32 s35, 1
    s_cbranch_scc1 L_fq85
    s_cbranch_vccnz L_fr85
    s_waitcnt vmcnt(4)
L_fr85:
    s_waitcnt vmcnt(5)
L_fq85:
    s_waitcnt vmcnt(7)
    buffer_load_dwordx4 v[164:167], v4, s[8:11], s78 offen offset:0 nt
    s_cmp_eq_u32 s35, 1
    s_cbranch_scc1 L_fq86
    s_cbranch_vccnz L_fr86
    s_waitcnt vmcnt(4)
L_fr86:
    s_waitcnt vmcnt(5)
L_fq86:
    s_waitcnt vmcnt(7)
    buffer_load_dwordx4 v[168:171], v4, s[8:11], s78 offen offset:1024 nt
    v_dot2_f32_bf16 v64, v132, v40, 0
    v_dot2_f32_bf16 v65, v136, v40, 0
    v_dot2_f32_bf16 v64, v133, v41, v64
    v_dot2_f32_bf16 v65, v137, v41, v65
    v_dot2_f32_bf16 v64, v134, v42, v64
    v_dot2_f32_bf16 v65, v138, v42, v65
    v_dot2_f32_bf16 v64, v135, v43, v64
    v_dot2_f32_bf16 v65, v139, v43, v65
    s_cmp_eq_u32 s35, 1
    s_cbranch_scc1 L_fq87
    s_cbranch_vccnz L_fr87
    s_waitcnt vmcnt(4)
L_fr87:
    s_waitcnt vmcnt(5)
L_fq87:
    s_waitcnt vmcnt(7)
    buffer_load_dwordx4 v[172:175], v4, s[8:11], s78 offen offset:2048 nt
    s_cmp_eq_u32 s35, 1
    s_cbranch_scc1 L_fq88
    s_cbranch_vccnz L_fr88
    s_waitcnt vmcnt(4)
L_fr88:
    s_waitcnt vmcnt(5)
L_fq88:
    s_waitcnt vmcnt(7)
    buffer_load_dwordx4 v[176:179], v4, s[8:11], s78 offen offset:3072 nt
    v_dot2_f32_bf16 v66, v140, v40, 0
    v_dot2_f32_bf16 v67, v144, v40, 0
    v_dot2_f32_bf16 v66, v141, v41, v66
    v_dot2_f32_bf16 v67, v145, v41, v67
    v_dot2_f32_bf16 v66, v142, v42, v66
    v_dot2_f32_bf16 v67, v146, v42, v67
    v_dot2_f32_bf16 v66, v143, v43, v66
    v_dot2_f32_bf16 v67, v147, v43, v67
    v_add_f32_dpp v52, v52, v52 row_ror:8 row_mask:0xf bank_mask:0x3
    v_add_f32_dpp v53, v53, v53 row_ror:8 row_mask:0xf bank_mask:0x3
    v_add_f32_dpp v54, v54, v54 row_ror:8 row_mask:0xf bank_mask:0x3
    v_add_f32_dpp v55, v55, v55 row_ror:8 row_mask:0xf bank_mask:0x3
    v_add_f32_dpp v56, v56, v56 row_ror:8 row_mask:0xf bank_mask:0x3
    v_add_f32_dpp v57, v57, v57 row_ror:8 row_mask:0xf bank_mask:0x3
    v_add_f32_dpp v58, v58, v58 row_ror:8 row_mask:0xf bank_mask:0x3
    v_add_f32_dpp v59, v59, v59 row_ror:8 row_mask:0xf bank_mask:0x3
    v_add_f32_dpp v52, v60, v60 row_ror:8 row_mask:0xf bank_mask:0xc
    v_add_f32_dpp v53, v61, v61 row_ror:8 row_mask:0xf bank_mask:0xc
    v_add_f32_dpp v54, v62, v62 row_ror:8 row_mask:0xf bank_mask:0xc
    v_add_f32_dpp v55, v63, v63 row_ror:8 row_mask:0xf bank_mask:0xc
    v_add_f32_dpp v56, v64, v64 row_ror:8 row_mask:0xf bank_mask:0xc
    v_add_f32_dpp v57, v65, v65 row_ror:8 row_mask:0xf bank_mask:0xc
    v_add_f32_dpp v58, v66, v66 row_ror:8 row_mask:0xf bank_mask:0xc
    v_add_f32_dpp v59, v67, v67 row_ror:8 row_mask:0xf bank_mask:0xc
    v_add_f32_dpp v60, v52, v52 row_shl:4 row_mask:0xf bank_mask:0x5
    v_add_f32_dpp v61, v53, v53 row_shl:4 row_mask:0xf bank_mask:0x5
    v_add_f32_dpp v62, v54, v54 row_shl:4 row_mask:0xf bank_mask:0x5
    v_add_f32_dpp v63, v55, v55 row_shl:4 row_mask:0xf bank_mask:0x5
    v_add_f32_dpp v60, v56, v56 row_shr:4 row_mask:0xf bank_mask:0xa
    v_add_f32_dpp v61, v57, v57 row_shr:4 row_mask:0xf bank_mask:0xa
    v_add_f32_dpp v62, v58, v58 row_shr:4 row_mask:0xf bank_mask:0xa
    v_add_f32_dpp v63, v59, v59 row_shr:4 row_mask:0xf bank_mask:0xa
    v_add_f32_dpp v60, v60, v60 quad_perm:[2,3,0,1] row_mask:0xf bank_mask:0xf
    v_add_f32_dpp v61, v61, v61 quad_perm:[2,3,0,1] row_mask:0xf bank_mask:0xf
    v_add_f32_dpp v62, v62, v62 quad_perm:[2,3,0,1] row_mask:0xf bank_mask:0xf
    v_add_f32_dpp v63, v63, v63 quad_perm:[2,3,0,1] row_mask:0xf bank_mask:0xf
    v_cndmask_b32 v60, v60, v62, s[16:17]
    v_cndmask_b32 v61, v61, v63, s[16:17]
    s_nop 0
    v_add_f32_dpp v60, v60, v60 quad_perm:[1,0,3,2] row_mask:0xf bank_mask:0xf
    v_add_f32_dpp v61, v61, v61 quad_perm:[1,0,3,2] row_mask:0xf bank_mask:0xf
    v_cndmask_b32 v50, v60, v61, s[18:19]
    v_cvt_pk_bf16_f32 v50, v50, v50
    v_lshlrev_b32 v50, 16, v50
    v_mul_f32 v50, 0x3db504f3, v50
    v_cvt_pk_bf16_f32 v50, v50, v50
    v_lshlrev_b32 v50, 16, v50
    s_memrealtime s[96:97]
    s_waitcnt lgkmcnt(0)
    s_sub_u32 s96, s96, s34
    s_cmp_gt_i32 s96, 1880
    s_cselect_b64 vcc, -1, 0
    s_cmp_gt_i32 s96, 1920
    s_cselect_b32 s35, 1, 0
    s_add_u32 s76, s76, 131072
    s_and_b32 s76, s76, 0x3fffff
    s_bfe_u32 s6, s76, 0x10011
    s_lshl_b32 s6, s6, 21
    s_xor_b32 s6, s6, s79
    s_and_b32 s5, s76, 0x1ffff
    s_xor_b32 s6, s6, s5
    s_lshr_b32 s5, s76, 18
    s_lshl_b32 s5, s5, 17
    s_xor_b32 s78, s6, s5
    s_cmp_eq_u32 s35, 1
    s_cbranch_scc1 L_fq89
    s_cbranch_vccnz L_fr89
    s_waitcnt vmcnt(4)
L_fr89:
    s_waitcnt vmcnt(5)
L_fq89:
    s_waitcnt vmcnt(7)
    buffer_load_dwordx4 v[180:183], v4, s[8:11], s78 offen offset:0 nt
    s_cmp_eq_u32 s35, 1
    s_cbranch_scc1 L_fq90
    s_cbranch_vccnz L_fr90
    s_waitcnt vmcnt(4)
L_fr90:
    s_waitcnt vmcnt(5)
L_fq90:
    s_waitcnt vmcnt(7)
    buffer_load_dwordx4 v[184:187], v4, s[8:11], s78 offen offset:1024 nt
    v_dot2_f32_bf16 v52, v148, v40, 0
    v_dot2_f32_bf16 v53, v152, v40, 0
    v_dot2_f32_bf16 v52, v149, v41, v52
    v_dot2_f32_bf16 v53, v153, v41, v53
    v_dot2_f32_bf16 v52, v150, v42, v52
    v_dot2_f32_bf16 v53, v154, v42, v53
    v_dot2_f32_bf16 v52, v151, v43, v52
    v_dot2_f32_bf16 v53, v155, v43, v53
    s_cmp_eq_u32 s35, 1
    s_cbranch_scc1 L_fq91
    s_cbranch_vccnz L_fr91
    s_waitcnt vmcnt(4)
L_fr91:
    s_waitcnt vmcnt(5)
L_fq91:
    s_waitcnt vmcnt(7)
    buffer_load_dwordx4 v[188:191], v4, s[8:11], s78 offen offset:2048 nt
    s_cmp_eq_u32 s35, 1
    s_cbranch_scc1 L_fq92
    s_cbranch_vccnz L_fr92
    s_waitcnt vmcnt(4)
L_fr92:
    s_waitcnt vmcnt(5)
L_fq92:
    s_waitcnt vmcnt(7)
    buffer_load_dwordx4 v[192:195], v4, s[8:11], s78 offen offset:3072 nt
    v_dot2_f32_bf16 v54, v156, v40, 0
    v_dot2_f32_bf16 v55, v160, v40, 0
    v_dot2_f32_bf16 v54, v157, v41, v54
    v_dot2_f32_bf16 v55, v161, v41, v55
    v_dot2_f32_bf16 v54, v158, v42, v54
    v_dot2_f32_bf16 v55, v162, v42, v55
    v_dot2_f32_bf16 v54, v159, v43, v54
    v_dot2_f32_bf16 v55, v163, v43, v55
    s_memrealtime s[96:97]
    s_waitcnt lgkmcnt(0)
    s_sub_u32 s96, s96, s34
    s_cmp_gt_i32 s96, 1936
    s_cselect_b64 vcc, -1, 0
    s_cmp_gt_i32 s96, 1976
    s_cselect_b32 s35, 1, 0
    s_add_u32 s76, s76, 131072
    s_and_b32 s76, s76, 0x3fffff
    s_bfe_u32 s6, s76, 0x10011
    s_lshl_b32 s6, s6, 21
    s_xor_b32 s6, s6, s79
    s_and_b32 s5, s76, 0x1ffff
    s_xor_b32 s6, s6, s5
    s_lshr_b32 s5, s76, 18
    s_lshl_b32 s5, s5, 17
    s_xor_b32 s78, s6, s5
    s_cmp_eq_u32 s35, 1
    s_cbranch_scc1 L_fq93
    s_cbranch_vccnz L_fr93
    s_waitcnt vmcnt(4)
L_fr93:
    s_waitcnt vmcnt(5)
L_fq93:
    s_waitcnt vmcnt(7)
    buffer_load_dwordx4 v[196:199], v4, s[8:11], s78 offen offset:0 nt
    s_cmp_eq_u32 s35, 1
    s_cbranch_scc1 L_fq94
    s_cbranch_vccnz L_fr94
    s_waitcnt vmcnt(4)
L_fr94:
    s_waitcnt vmcnt(5)
L_fq94:
    s_waitcnt vmcnt(7)
    buffer_load_dwordx4 v[200:203], v4, s[8:11], s78 offen offset:1024 nt
    v_dot2_f32_bf16 v56, v164, v40, 0
    v_dot2_f32_bf16 v57, v168, v40, 0
    v_dot2_f32_bf16 v56, v165, v41, v56
    v_dot2_f32_bf16 v57, v169, v41, v57
    v_dot2_f32_bf16 v56, v166, v42, v56
    v_dot2_f32_bf16 v57, v170, v42, v57
    v_dot2_f32_bf16 v56, v167, v43, v56
    v_dot2_f32_bf16 v57, v171, v43, v57
    s_cmp_eq_u32 s35, 1
    s_cbranch_scc1 L_fq95
    s_cbranch_vccnz L_fr95
    s_waitcnt vmcnt(4)
L_fr95:
    s_waitcnt vmcnt(5)
L_fq95:
    s_waitcnt vmcnt(7)
    buffer_load_dwordx4 v[204:207], v4, s[8:11], s78 offen offset:2048 nt
    s_cmp_eq_u32 s35, 1
    s_cbranch_scc1 L_fq96
    s_cbranch_vccnz L_fr96
    s_waitcnt vmcnt(4)
L_fr96:
    s_waitcnt vmcnt(5)
L_fq96:
    s_waitcnt vmcnt(7)
    buffer_load_dwordx4 v[208:211], v4, s[8:11], s78 offen offset:3072 nt
    v_dot2_f32_bf16 v58, v172, v40, 0
    v_dot2_f32_bf16 v59, v176, v40, 0
    v_dot2_f32_bf16 v58, v173, v41, v58
    v_dot2_f32_bf16 v59, v177, v41, v59
    v_dot2_f32_bf16 v58, v174, v42, v58
    v_dot2_f32_bf16 v59, v178, v42, v59
    v_dot2_f32_bf16 v58, v175, v43, v58
    v_dot2_f32_bf16 v59, v179, v43, v59
    s_memrealtime s[96:97]
    s_waitcnt lgkmcnt(0)
    s_sub_u32 s96, s96, s34
    s_cmp_gt_i32 s96, 1992
    s_cselect_b64 vcc, -1, 0
    s_cmp_gt_i32 s96, 2032
    s_cselect_b32 s35, 1, 0
    s_mov_b32 s76, s77
    s_bfe_u32 s6, s76, 0x10011
    s_lshl_b32 s6, s6, 21
    s_xor_b32 s6, s6, s79
    s_and_b32 s5, s76, 0x1ffff
    s_xor_b32 s6, s6, s5
    s_lshr_b32 s5, s76, 18
    s_lshl_b32 s5, s5, 17
    s_xor_b32 s78, s6, s5
    s_cmp_eq_u32 s35, 1
    s_cbranch_scc1 L_fq97
    s_cbranch_vccnz L_fr97
    s_waitcnt vmcnt(4)
L_fr97:
    s_waitcnt vmcnt(5)
L_fq97:
    s_waitcnt vmcnt(7)
    buffer_load_dwordx4 v[84:87], v4, s[12:15], s78 offen offset:0 nt
    s_cmp_eq_u32 s35, 1
    s_cbranch_scc1 L_fq98
    s_cbranch_vccnz L_fr98
    s_waitcnt vmcnt(4)
L_fr98:
    s_waitcnt vmcnt(5)
L_fq98:
    s_waitcnt vmcnt(7)
    buffer_load_dwordx4 v[88:91], v4, s[12:15], s78 offen offset:1024 nt
    v_dot2_f32_bf16 v60, v180, v40, 0
    v_dot2_f32_bf16 v61, v184, v40, 0
    v_dot2_f32_bf16 v60, v181, v41, v60
    v_dot2_f32_bf16 v61, v185, v41, v61
    v_dot2_f32_bf16 v60, v182, v42, v60
    v_dot2_f32_bf16 v61, v186, v42, v61
    v_dot2_f32_bf16 v60, v183, v43, v60
    v_dot2_f32_bf16 v61, v187, v43, v61
    s_cmp_eq_u32 s35, 1
    s_cbranch_scc1 L_fq99
    s_cbranch_vccnz L_fr99
    s_waitcnt vmcnt(4)
L_fr99:
    s_waitcnt vmcnt(5)
L_fq99:
    s_waitcnt vmcnt(7)
    buffer_load_dwordx4 v[92:95], v4, s[12:15], s78 offen offset:2048 nt
    s_cmp_eq_u32 s35, 1
    s_cbranch_scc1 L_fq100
    s_cbranch_vccnz L_fr100
    s_waitcnt vmcnt(4)
L_fr100:
    s_waitcnt vmcnt(5)
L_fq100:
    s_waitcnt vmcnt(7)
    buffer_load_dwordx4 v[96:99], v4, s[12:15], s78 offen offset:3072 nt
    v_dot2_f32_bf16 v62, v188, v40, 0
    v_dot2_f32_bf16 v63, v192, v40, 0
    v_dot2_f32_bf16 v62, v189, v41, v62
    v_dot2_f32_bf16 v63, v193, v41, v63
    v_dot2_f32_bf16 v62, v190, v42, v62
    v_dot2_f32_bf16 v63, v194, v42, v63
    v_dot2_f32_bf16 v62, v191, v43, v62
    v_dot2_f32_bf16 v63, v195, v43, v63
    s_memrealtime s[96:97]
    s_waitcnt lgkmcnt(0)
    s_sub_u32 s96, s96, s34
    s_cmp_gt_i32 s96, 2048
    s_cselect_b64 vcc, -1, 0
    s_cmp_gt_i32 s96, 2088
    s_cselect_b32 s35, 1, 0
    s_add_u32 s76, s76, 131072
    s_and_b32 s76, s76, 0x3fffff
    s_bfe_u32 s6, s76, 0x10011
    s_lshl_b32 s6, s6, 21
    s_xor_b32 s6, s6, s79
    s_and_b32 s5, s76, 0x1ffff
    s_xor_b32 s6, s6, s5
    s_lshr_b32 s5, s76, 18
    s_lshl_b32 s5, s5, 17
    s_xor_b32 s78, s6, s5
    s_cmp_eq_u32 s35, 1
    s_cbranch_scc1 L_fq101
    s_cbranch_vccnz L_fr101
    s_waitcnt vmcnt(4)
L_fr101:
    s_waitcnt vmcnt(5)
L_fq101:
    s_waitcnt vmcnt(7)
    buffer_load_dwordx4 v[100:103], v4, s[12:15], s78 offen offset:0 nt
    s_cmp_eq_u32 s35, 1
    s_cbranch_scc1 L_fq102
    s_cbranch_vccnz L_fr102
    s_waitcnt vmcnt(4)
L_fr102:
    s_waitcnt vmcnt(5)
L_fq102:
    s_waitcnt vmcnt(7)
    buffer_load_dwordx4 v[104:107], v4, s[12:15], s78 offen offset:1024 nt
    v_dot2_f32_bf16 v64, v196, v40, 0
    v_dot2_f32_bf16 v65, v200, v40, 0
    v_dot2_f32_bf16 v64, v197, v41, v64
    v_dot2_f32_bf16 v65, v201, v41, v65
    v_dot2_f32_bf16 v64, v198, v42, v64
    v_dot2_f32_bf16 v65, v202, v42, v65
    v_dot2_f32_bf16 v64, v199, v43, v64
    v_dot2_f32_bf16 v65, v203, v43, v65
    s_cmp_eq_u32 s35, 1
    s_cbranch_scc1 L_fq103
    s_cbranch_vccnz L_fr103
    s_waitcnt vmcnt(4)
L_fr103:
    s_waitcnt vmcnt(5)
L_fq103:
    s_waitcnt vmcnt(7)
    buffer_load_dwordx4 v[108:111], v4, s[12:15], s78 offen offset:2048 nt
    s_cmp_eq_u32 s35, 1
    s_cbranch_scc1 L_fq104
    s_cbranch_vccnz L_fr104
    s_waitcnt vmcnt(4)
L_fr104:
    s_waitcnt vmcnt(5)
L_fq104:
    s_waitcnt vmcnt(7)
    buffer_load_dwordx4 v[112:115], v4, s[12:15], s78 offen offset:3072 nt
    v_dot2_f32_bf16 v66, v204, v40, 0
    v_dot2_f32_bf16 v67, v208, v40, 0
    v_dot2_f32_bf16 v66, v205, v41, v66
    v_dot2_f32_bf16 v67, v209, v41, v67
    v_dot2_f32_bf16 v66, v206, v42, v66
    v_dot2_f32_bf16 v67, v210, v42, v67
    v_dot2_f32_bf16 v66, v207, v43, v66
    v_dot2_f32_bf16 v67, v211, v43, v67
    v_add_f32_dpp v52, v52, v52 row_ror:8 row_mask:0xf bank_mask:0x3
    v_add_f32_dpp v53, v53, v53 row_ror:8 row_mask:0xf bank_mask:0x3
    v_add_f32_dpp v54, v54, v54 row_ror:8 row_mask:0xf bank_mask:0x3
    v_add_f32_dpp v55, v55, v55 row_ror:8 row_mask:0xf bank_mask:0x3
    v_add_f32_dpp v56, v56, v56 row_ror:8 row_mask:0xf bank_mask:0x3
    v_add_f32_dpp v57, v57, v57 row_ror:8 row_mask:0xf bank_mask:0x3
    v_add_f32_dpp v58, v58, v58 row_ror:8 row_mask:0xf bank_mask:0x3
    v_add_f32_dpp v59, v59, v59 row_ror:8 row_mask:0xf bank_mask:0x3
    v_add_f32_dpp v52, v60, v60 row_ror:8 row_mask:0xf bank_mask:0xc
    v_add_f32_dpp v53, v61, v61 row_ror:8 row_mask:0xf bank_mask:0xc
    v_add_f32_dpp v54, v62, v62 row_ror:8 row_mask:0xf bank_mask:0xc
    v_add_f32_dpp v55, v63, v63 row_ror:8 row_mask:0xf bank_mask:0xc
    v_add_f32_dpp v56, v64, v64 row_ror:8 row_mask:0xf bank_mask:0xc
    v_add_f32_dpp v57, v65, v65 row_ror:8 row_mask:0xf bank_mask:0xc
    v_add_f32_dpp v58, v66, v66 row_ror:8 row_mask:0xf bank_mask:0xc
    v_add_f32_dpp v59, v67, v67 row_ror:8 row_mask:0xf bank_mask:0xc
    v_add_f32_dpp v60, v52, v52 row_shl:4 row_mask:0xf bank_mask:0x5
    v_add_f32_dpp v61, v53, v53 row_shl:4 row_mask:0xf bank_mask:0x5
    v_add_f32_dpp v62, v54, v54 row_shl:4 row_mask:0xf bank_mask:0x5
    v_add_f32_dpp v63, v55, v55 row_shl:4 row_mask:0xf bank_mask:0x5
    v_add_f32_dpp v60, v56, v56 row_shr:4 row_mask:0xf bank_mask:0xa
    v_add_f32_dpp v61, v57, v57 row_shr:4 row_mask:0xf bank_mask:0xa
    v_add_f32_dpp v62, v58, v58 row_shr:4 row_mask:0xf bank_mask:0xa
    v_add_f32_dpp v63, v59, v59 row_shr:4 row_mask:0xf bank_mask:0xa
    v_add_f32_dpp v60, v60, v60 quad_perm:[2,3,0,1] row_mask:0xf bank_mask:0xf
    v_add_f32_dpp v61, v61, v61 quad_perm:[2,3,0,1] row_mask:0xf bank_mask:0xf
    v_add_f32_dpp v62, v62, v62 quad_perm:[2,3,0,1] row_mask:0xf bank_mask:0xf
    v_add_f32_dpp v63, v63, v63 quad_perm:[2,3,0,1] row_mask:0xf bank_mask:0xf
    v_cndmask_b32 v60, v60, v62, s[16:17]
    v_cndmask_b32 v61, v61, v63, s[16:17]
    s_nop 0
    v_add_f32_dpp v60, v60, v60 quad_perm:[1,0,3,2] row_mask:0xf bank_mask:0xf
    v_add_f32_dpp v61, v61, v61 quad_perm:[1,0,3,2] row_mask:0xf bank_mask:0xf
    v_cndmask_b32 v51, v60, v61, s[18:19]
    v_cvt_pk_bf16_f32 v51, v51, v51
    v_lshlrev_b32 v51, 16, v51
    v_mul_f32 v51, 0x3db504f3, v51
    v_cvt_pk_bf16_f32 v51, v51, v51
    v_lshlrev_b32 v51, 16, v51
    s_memrealtime s[96:97]
    s_waitcnt lgkmcnt(0)
    s_sub_u32 s96, s96, s34
    s_cmp_gt_i32 s96, 2104
    s_cselect_b64 vcc, -1, 0
    s_cmp_gt_i32 s96, 2144
    s_cselect_b32 s35, 1, 0
    s_add_u32 s76, s76, 131072
    s_and_b32 s76, s76, 0x3fffff
    s_bfe_u32 s6, s76, 0x10011
    s_lshl_b32 s6, s6, 21
    s_xor_b32 s6, s6, s79
    s_and_b32 s5, s76, 0x1ffff
    s_xor_b32 s6, s6, s5
    s_lshr_b32 s5, s76, 18
    s_lshl_b32 s5, s5, 17
    s_xor_b32 s78, s6, s5
    s_cmp_eq_u32 s35, 1
    s_cbranch_scc1 L_fq105
    s_cbranch_vccnz L_fr105
    s_waitcnt vmcnt(4)
L_fr105:
    s_waitcnt vmcnt(5)
L_fq105:
    s_waitcnt vmcnt(7)
    buffer_load_dwordx4 v[116:119], v4, s[12:15], s78 offen offset:0 nt
    v_max_f32 v18, v44, v45
    v_max_f32 v18, v18, v46
    v_max_f32 v18, v18, v47
    v_max_f32 v18, v18, v48
    v_max_f32 v18, v18, v49
    v_max_f32 v18, v18, v50
    v_max_f32 v18, v18, v51
    s_nop 1
    v_max_f32_dpp v18, v18, v18 row_ror:8 row_mask:0xf bank_mask:0xf
    s_nop 1
    v_max_f32_dpp v18, v18, v18 row_ror:4 row_mask:0xf bank_mask:0xf
    s_nop 1
    v_max_f32_dpp v18, v18, v18 row_ror:2 row_mask:0xf bank_mask:0xf
    s_nop 1
    v_max_f32_dpp v18, v18, v18 row_ror:1 row_mask:0xf bank_mask:0xf
    v_mov_b32 v7, v18
    s_nop 1
    v_permlane16_swap_b32 v18, v7
    v_max_f32 v18, v18, v7
    v_mov_b32 v7, v18
    s_nop 1
    v_permlane32_swap_b32 v18, v7
    v_max_f32 v18, v18, v7
    v_sub_f32 v44, v44, v18
    v_sub_f32 v45, v45, v18
    v_sub_f32 v46, v46, v18
    v_sub_f32 v47, v47, v18
    v_sub_f32 v48, v48, v18
    v_sub_f32 v49, v49, v18
    v_sub_f32 v50, v50, v18
    v_sub_f32 v51, v51, v18
    v_mul_f32 v44, s94, v44
    v_mul_f32 v45, s94, v45
    v_mul_f32 v46, s94, v46
    v_mul_f32 v47, s94, v47
    v_mul_f32 v48, s94, v48
    v_mul_f32 v49, s94, v49
    v_mul_f32 v50, s94, v50
    v_mul_f32 v51, s94, v51
    v_exp_f32 v44, v44
    v_exp_f32 v45, v45
    v_exp_f32 v46, v46
    v_exp_f32 v47, v47
    v_exp_f32 v48, v48
    v_exp_f32 v49, v49
    v_exp_f32 v50, v50
    v_exp_f32 v51, v51
    v_cvt_pk_bf16_f32 v44, v44, v44
    v_cvt_pk_bf16_f32 v45, v45, v45
    v_cvt_pk_bf16_f32 v46, v46, v46
    v_cvt_pk_bf16_f32 v47, v47, v47
    v_cvt_pk_bf16_f32 v48, v48, v48
    v_cvt_pk_bf16_f32 v49, v49, v49
    v_cvt_pk_bf16_f32 v50, v50, v50
    v_cvt_pk_bf16_f32 v51, v51, v51
    s_cmp_eq_u32 s35, 1
    s_cbranch_scc1 L_fq106
    s_cbranch_vccnz L_fr106
    s_waitcnt vmcnt(4)
L_fr106:
    s_waitcnt vmcnt(5)
L_fq106:
    s_waitcnt vmcnt(7)
    buffer_load_dwordx4 v[120:123], v4, s[12:15], s78 offen offset:1024 nt
    v_lshlrev_b32 v19, 16, v44
    v_lshlrev_b32 v9, 16, v45
    v_add_f32 v19, v19, v9
    v_lshlrev_b32 v9, 16, v46
    v_add_f32 v19, v19, v9
    v_lshlrev_b32 v9, 16, v47
    v_add_f32 v19, v19, v9
    v_lshlrev_b32 v9, 16, v48
    v_add_f32 v19, v19, v9
    v_lshlrev_b32 v9, 16, v49
    v_add_f32 v19, v19, v9
    v_lshlrev_b32 v9, 16, v50
    v_add_f32 v19, v19, v9
    v_lshlrev_b32 v9, 16, v51
    v_add_f32 v19, v19, v9
    s_nop 1
    v_add_f32_dpp v19, v19, v19 row_ror:8 row_mask:0xf bank_mask:0xf
    s_nop 1
    v_add_f32_dpp v19, v19, v19 row_ror:4 row_mask:0xf bank_mask:0xf
    s_nop 1
    v_add_f32_dpp v19, v19, v19 row_ror:2 row_mask:0xf bank_mask:0xf
    s_nop 1
    v_add_f32_dpp v19, v19, v19 row_ror:1 row_mask:0xf bank_mask:0xf
    v_mov_b32 v7, v19
    s_nop 1
    v_permlane16_swap_b32 v19, v7
    v_add_f32 v19, v19, v7
    v_mov_b32 v7, v19
    s_nop 1
    v_permlane32_swap_b32 v19, v7
    v_add_f32 v19, v19, v7
    s_and_b32 s80, s3, 3
    s_lshl_b32 s80, s80, 2
    v_mov_b32 v9, s80
    ds_write_b32 v9, v18 offset:320
    ds_write_b32 v9, v19 offset:352
    v_mov_b32 v12, 1
    s_mov_b64 exec, 1
    ds_add_rtn_u32 v12, v20, v12 offset:264
    s_mov_b64 exec, -1
    v_and_b32 v11, 3, v1
    v_lshlrev_b32 v11, 2, v11
    s_mov_b32 s81, 0x40000000
    s_waitcnt lgkmcnt(0)
    v_readfirstlane_b32 s80, v12
    s_cmp_lg_u32 s80, 3
    s_cbranch_scc1 L_ml0
    ds_read_b32 v10, v11 offset:320
    ds_read_b32 v69, v11 offset:352
    s_getreg_b32 s81, hwreg(HW_REG_XCC_ID)
    s_lshl_b32 s81, s81, 8
    v_or_b32 v70, s81, v16
    v_mov_b32 v71, v16
    s_add_u32 s81, s31, 512
    s_waitcnt lgkmcnt(0)
    v_max_f32_dpp v68, v10, v10 quad_perm:[1,0,3,2] row_mask:0xf bank_mask:0xf
    s_nop 1
    v_max_f32_dpp v68, v68, v68 quad_perm:[2,3,0,1] row_mask:0xf bank_mask:0xf
    v_sub_f32 v10, v10, v68
    v_mul_f32 v10, s94, v10
    v_exp_f32 v10, v10
    s_nop 0
    v_mul_f32 v69, v69, v10
    ds_write_b32 v11, v10 offset:384
    s_nop 0
    v_add_f32_dpp v69, v69, v69 quad_perm:[1,0,3,2] row_mask:0xf bank_mask:0xf
    s_nop 1
    v_add_f32_dpp v69, v69, v69 quad_perm:[2,3,0,1] row_mask:0xf bank_mask:0xf
    v_and_or_b32 v68, v68, s90, v16
    v_and_or_b32 v69, v69, s90, v16
    v_lshlrev_b32 v12, 13, v1
    s_mov_b64 exec, 3
    buffer_store_dwordx4 v[68:71], v12, s[44:47], s81 offen sc1
    s_mov_b64 exec, -1
L_ml0:
    s_nop 1
    v_and_b32_dpp v28, v44, v24 row_newbcast:0 row_mask:0xf bank_mask:0xf
    v_and_b32_dpp v29, v44, v25 row_newbcast:0 row_mask:0xf bank_mask:0xf
    v_and_b32_dpp v30, v44, v26 row_newbcast:0 row_mask:0xf bank_mask:0xf
    v_and_b32_dpp v31, v44, v27 row_newbcast:0 row_mask:0xf bank_mask:0xf
    s_cmp_eq_u32 s35, 1
    s_cbranch_scc1 L_fq107
    s_cbranch_vccnz L_fr107
    s_waitcnt vmcnt(4)
L_fr107:
    s_waitcnt vmcnt(5)
L_fq107:
    s_waitcnt vmcnt(7)
    buffer_load_dwordx4 v[124:127], v4, s[12:15], s78 offen offset:2048 nt
    v_and_b32_dpp v32, v44, v24 row_newbcast:1 row_mask:0xf bank_mask:0xf
    v_and_b32_dpp v33, v44, v25 row_newbcast:1 row_mask:0xf bank_mask:0xf
    v_and_b32_dpp v34, v44, v26 row_newbcast:1 row_mask:0xf bank_mask:0xf
    v_and_b32_dpp v35, v44, v27 row_newbcast:1 row_mask:0xf bank_mask:0xf
    v_mfma_f32_16x16x32_bf16 v[36:39], v[28:31], v[84:87], 0
    v_and_b32_dpp v28, v44, v24 row_newbcast:2 row_mask:0xf bank_mask:0xf
    v_and_b32_dpp v29, v44, v25 row_newbcast:2 row_mask:0xf bank_mask:0xf
    v_and_b32_dpp v30, v44, v26 row_newbcast:2 row_mask:0xf bank_mask:0xf
    v_and_b32_dpp v31, v44, v27 row_newbcast:2 row_mask:0xf bank_mask:0xf
    v_mfma_f32_16x16x32_bf16 v[36:39], v[32:35], v[88:91], v[36:39]
    v_and_b32_dpp v32, v44, v24 row_newbcast:3 row_mask:0xf bank_mask:0xf
    v_and_b32_dpp v33, v44, v25 row_newbcast:3 row_mask:0xf bank_mask:0xf
    v_and_b32_dpp v34, v44, v26 row_newbcast:3 row_mask:0xf bank_mask:0xf
    v_and_b32_dpp v35, v44, v27 row_newbcast:3 row_mask:0xf bank_mask:0xf
    v_mfma_f32_16x16x32_bf16 v[36:39], v[28:31], v[92:95], v[36:39]
    s_cmp_eq_u32 s35, 1
    s_cbranch_scc1 L_fq108
    s_cbranch_vccnz L_fr108
    s_waitcnt vmcnt(4)
L_fr108:
    s_waitcnt vmcnt(5)
L_fq108:
    s_waitcnt vmcnt(7)
    buffer_load_dwordx4 v[128:131], v4, s[12:15], s78 offen offset:3072 nt
    v_and_b32_dpp v28, v44, v24 row_newbcast:4 row_mask:0xf bank_mask:0xf
    v_and_b32_dpp v29, v44, v25 row_newbcast:4 row_mask:0xf bank_mask:0xf
    v_and_b32_dpp v30, v44, v26 row_newbcast:4 row_mask:0xf bank_mask:0xf
    v_and_b32_dpp v31, v44, v27 row_newbcast:4 row_mask:0xf bank_mask:0xf
    v_mfma_f32_16x16x32_bf16 v[36:39], v[32:35], v[96:99], v[36:39]
    s_memrealtime s[96:97]
    s_waitcnt lgkmcnt(0)
    s_sub_u32 s96, s96, s34
    s_cmp_gt_i32 s96, 2160
    s_cselect_b64 vcc, -1, 0
    s_cmp_gt_i32 s96, 2200
    s_cselect_b32 s35, 1, 0
    s_add_u32 s76, s76, 131072
    s_and_b32 s76, s76, 0x3fffff
    s_bfe_u32 s6, s76, 0x10011
    s_lshl_b32 s6, s6, 21
    s_xor_b32 s6, s6, s79
    s_and_b32 s5, s76, 0x1ffff
    s_xor_b32 s6, s6, s5
    s_lshr_b32 s5, s76, 18
    s_lshl_b32 s5, s5, 17
    s_xor_b32 s78, s6, s5
    s_cmp_eq_u32 s35, 1
    s_cbranch_scc1 L_fq109
    s_cbranch_vccnz L_fr109
    s_waitcnt vmcnt(4)
L_fr109:
    s_waitcnt vmcnt(5)
L_fq109:
    s_waitcnt vmcnt(7)
    buffer_load_dwordx4 v[132:135], v4, s[12:15], s78 offen offset:0 nt
    v_and_b32_dpp v32, v44, v24 row_newbcast:5 row_mask:0xf bank_mask:0xf
    v_and_b32_dpp v33, v44, v25 row_newbcast:5 row_mask:0xf bank_mask:0xf
    v_and_b32_dpp v34, v44, v26 row_newbcast:5 row_mask:0xf bank_mask:0xf
    v_and_b32_dpp v35, v44, v27 row_newbcast:5 row_mask:0xf bank_mask:0xf
    v_mfma_f32_16x16x32_bf16 v[36:39], v[28:31], v[100:103], v[36:39]
    s_cmp_eq_u32 s35, 1
    s_cbranch_scc1 L_fq110
    s_cbranch_vccnz L_fr110
    s_waitcnt vmcnt(4)
L_fr110:
    s_waitcnt vmcnt(5)
L_fq110:
    s_waitcnt vmcnt(7)
    buffer_load_dwordx4 v[136:139], v4, s[12:15], s78 offen offset:1024 nt
    v_and_b32_dpp v28, v44, v24 row_newbcast:6 row_mask:0xf bank_mask:0xf
    v_and_b32_dpp v29, v44, v25 row_newbcast:6 row_mask:0xf bank_mask:0xf
    v_and_b32_dpp v30, v44, v26 row_newbcast:6 row_mask:0xf bank_mask:0xf
    v_and_b32_dpp v31, v44, v27 row_newbcast:6 row_mask:0xf bank_mask:0xf
    v_mfma_f32_16x16x32_bf16 v[36:39], v[32:35], v[104:107], v[36:39]
    s_cmp_eq_u32 s35, 1
    s_cbranch_scc1 L_fq111
    s_cbranch_vccnz L_fr111
    s_waitcnt vmcnt(4)
L_fr111:
    s_waitcnt vmcnt(5)
L_fq111:
    s_waitcnt vmcnt(7)
    buffer_load_dwordx4 v[140:143], v4, s[12:15], s78 offen offset:2048 nt
    v_and_b32_dpp v32, v44, v24 row_newbcast:7 row_mask:0xf bank_mask:0xf
    v_and_b32_dpp v33, v44, v25 row_newbcast:7 row_mask:0xf bank_mask:0xf
    v_and_b32_dpp v34, v44, v26 row_newbcast:7 row_mask:0xf bank_mask:0xf
    v_and_b32_dpp v35, v44, v27 row_newbcast:7 row_mask:0xf bank_mask:0xf
    v_mfma_f32_16x16x32_bf16 v[36:39], v[28:31], v[108:111], v[36:39]
    s_cmp_eq_u32 s35, 1
    s_cbranch_scc1 L_fq112
    s_cbranch_vccnz L_fr112
    s_waitcnt vmcnt(4)
L_fr112:
    s_waitcnt vmcnt(5)
L_fq112:
    s_waitcnt vmcnt(7)
    buffer_load_dwordx4 v[144:147], v4, s[12:15], s78 offen offset:3072 nt
    v_and_b32_dpp v28, v44, v24 row_newbcast:8 row_mask:0xf bank_mask:0xf
    v_and_b32_dpp v29, v44, v25 row_newbcast:8 row_mask:0xf bank_mask:0xf
    v_and_b32_dpp v30, v44, v26 row_newbcast:8 row_mask:0xf bank_mask:0xf
    v_and_b32_dpp v31, v44, v27 row_newbcast:8 row_mask:0xf bank_mask:0xf
    v_mfma_f32_16x16x32_bf16 v[36:39], v[32:35], v[112:115], v[36:39]
    s_memrealtime s[96:97]
    s_waitcnt lgkmcnt(0)
    s_sub_u32 s96, s96, s34
    s_cmp_gt_i32 s96, 2216
    s_cselect_b64 vcc, -1, 0
    s_cmp_gt_i32 s96, 2256
    s_cselect_b32 s35, 1, 0
    s_add_u32 s76, s76, 131072
    s_and_b32 s76, s76, 0x3fffff
    s_bfe_u32 s6, s76, 0x10011
    s_lshl_b32 s6, s6, 21
    s_xor_b32 s6, s6, s79
    s_and_b32 s5, s76, 0x1ffff
    s_xor_b32 s6, s6, s5
    s_lshr_b32 s5, s76, 18
    s_lshl_b32 s5, s5, 17
    s_xor_b32 s78, s6, s5
    s_cmp_eq_u32 s35, 1
    s_cbranch_scc1 L_fq113
    s_cbranch_vccnz L_fr113
    s_waitcnt vmcnt(4)
L_fr113:
    s_waitcnt vmcnt(5)
L_fq113:
    s_waitcnt vmcnt(7)
    buffer_load_dwordx4 v[148:151], v4, s[12:15], s78 offen offset:0 nt
    v_and_b32_dpp v32, v44, v24 row_newbcast:9 row_mask:0xf bank_mask:0xf
    v_and_b32_dpp v33, v44, v25 row_newbcast:9 row_mask:0xf bank_mask:0xf
    v_and_b32_dpp v34, v44, v26 row_newbcast:9 row_mask:0xf bank_mask:0xf
    v_and_b32_dpp v35, v44, v27 row_newbcast:9 row_mask:0xf bank_mask:0xf
    v_mfma_f32_16x16x32_bf16 v[36:39], v[28:31], v[116:119], v[36:39]
    s_cmp_eq_u32 s35, 1
    s_cbranch_scc1 L_fq114
    s_cbranch_vccnz L_fr114
    s_waitcnt vmcnt(4)
L_fr114:
    s_waitcnt vmcnt(5)
L_fq114:
    s_waitcnt vmcnt(7)
    buffer_load_dwordx4 v[152:155], v4, s[12:15], s78 offen offset:1024 nt
    v_and_b32_dpp v28, v44, v24 row_newbcast:10 row_mask:0xf bank_mask:0xf
    v_and_b32_dpp v29, v44, v25 row_newbcast:10 row_mask:0xf bank_mask:0xf
    v_and_b32_dpp v30, v44, v26 row_newbcast:10 row_mask:0xf bank_mask:0xf
    v_and_b32_dpp v31, v44, v27 row_newbcast:10 row_mask:0xf bank_mask:0xf
    v_mfma_f32_16x16x32_bf16 v[36:39], v[32:35], v[120:123], v[36:39]
    s_cmp_eq_u32 s35, 1
    s_cbranch_scc1 L_fq115
    s_cbranch_vccnz L_fr115
    s_waitcnt vmcnt(4)
L_fr115:
    s_waitcnt vmcnt(5)
L_fq115:
    s_waitcnt vmcnt(7)
    buffer_load_dwordx4 v[156:159], v4, s[12:15], s78 offen offset:2048 nt
    v_and_b32_dpp v32, v44, v24 row_newbcast:11 row_mask:0xf bank_mask:0xf
    v_and_b32_dpp v33, v44, v25 row_newbcast:11 row_mask:0xf bank_mask:0xf
    v_and_b32_dpp v34, v44, v26 row_newbcast:11 row_mask:0xf bank_mask:0xf
    v_and_b32_dpp v35, v44, v27 row_newbcast:11 row_mask:0xf bank_mask:0xf
    v_mfma_f32_16x16x32_bf16 v[36:39], v[28:31], v[124:127], v[36:39]
    s_cmp_eq_u32 s35, 1
    s_cbranch_scc1 L_fq116
    s_cbranch_vccnz L_fr116
    s_waitcnt vmcnt(4)
L_fr116:
    s_waitcnt vmcnt(5)
L_fq116:
    s_waitcnt vmcnt(7)
    buffer_load_dwordx4 v[160:163], v4, s[12:15], s78 offen offset:3072 nt
    v_and_b32_dpp v28, v44, v24 row_newbcast:12 row_mask:0xf bank_mask:0xf
    v_and_b32_dpp v29, v44, v25 row_newbcast:12 row_mask:0xf bank_mask:0xf
    v_and_b32_dpp v30, v44, v26 row_newbcast:12 row_mask:0xf bank_mask:0xf
    v_and_b32_dpp v31, v44, v27 row_newbcast:12 row_mask:0xf bank_mask:0xf
    v_mfma_f32_16x16x32_bf16 v[36:39], v[32:35], v[128:131], v[36:39]
    s_memrealtime s[96:97]
    s_waitcnt lgkmcnt(0)
    s_sub_u32 s96, s96, s34
    s_cmp_gt_i32 s96, 2272
    s_cselect_b64 vcc, -1, 0
    s_cmp_gt_i32 s96, 2312
    s_cselect_b32 s35, 1, 0
    s_add_u32 s76, s76, 131072
    s_and_b32 s76, s76, 0x3fffff
    s_bfe_u32 s6, s76, 0x10011
    s_lshl_b32 s6, s6, 21
    s_xor_b32 s6, s6, s79
    s_and_b32 s5, s76, 0x1ffff
    s_xor_b32 s6, s6, s5
    s_lshr_b32 s5, s76, 18
    s_lshl_b32 s5, s5, 17
    s_xor_b32 s78, s6, s5
    s_cmp_eq_u32 s35, 1
    s_cbranch_scc1 L_fq117
    s_cbranch_vccnz L_fr117
    s_waitcnt vmcnt(4)
L_fr117:
    s_waitcnt vmcnt(5)
L_fq117:
    s_waitcnt vmcnt(7)
    buffer_load_dwordx4 v[164:167], v4, s[12:15], s78 offen offset:0 nt
    v_and_b32_dpp v32, v44, v24 row_newbcast:13 row_mask:0xf bank_mask:0xf
    v_and_b32_dpp v33, v44, v25 row_newbcast:13 row_mask:0xf bank_mask:0xf
    v_and_b32_dpp v34, v44, v26 row_newbcast:13 row_mask:0xf bank_mask:0xf
    v_and_b32_dpp v35, v44, v27 row_newbcast:13 row_mask:0xf bank_mask:0xf
    v_mfma_f32_16x16x32_bf16 v[36:39], v[28:31], v[132:135], v[36:39]
    s_cmp_eq_u32 s35, 1
    s_cbranch_scc1 L_fq118
    s_cbranch_vccnz L_fr118
    s_waitcnt vmcnt(4)
L_fr118:
    s_waitcnt vmcnt(5)
L_fq118:
    s_waitcnt vmcnt(7)
    buffer_load_dwordx4 v[168:171], v4, s[12:15], s78 offen offset:1024 nt
    v_and_b32_dpp v28, v44, v24 row_newbcast:14 row_mask:0xf bank_mask:0xf
    v_and_b32_dpp v29, v44, v25 row_newbcast:14 row_mask:0xf bank_mask:0xf
    v_and_b32_dpp v30, v44, v26 row_newbcast:14 row_mask:0xf bank_mask:0xf
    v_and_b32_dpp v31, v44, v27 row_newbcast:14 row_mask:0xf bank_mask:0xf
    v_mfma_f32_16x16x32_bf16 v[36:39], v[32:35], v[136:139], v[36:39]
    s_cmp_eq_u32 s35, 1
    s_cbranch_scc1 L_fq119
    s_cbranch_vccnz L_fr119
    s_waitcnt vmcnt(4)
L_fr119:
    s_waitcnt vmcnt(5)
L_fq119:
    s_waitcnt vmcnt(7)
    buffer_load_dwordx4 v[172:175], v4, s[12:15], s78 offen offset:2048 nt
    v_and_b32_dpp v32, v44, v24 row_newbcast:15 row_mask:0xf bank_mask:0xf
    v_and_b32_dpp v33, v44, v25 row_newbcast:15 row_mask:0xf bank_mask:0xf
    v_and_b32_dpp v34, v44, v26 row_newbcast:15 row_mask:0xf bank_mask:0xf
    v_and_b32_dpp v35, v44, v27 row_newbcast:15 row_mask:0xf bank_mask:0xf
    v_mfma_f32_16x16x32_bf16 v[36:39], v[28:31], v[140:143], v[36:39]
    s_cmp_eq_u32 s35, 1
    s_cbranch_scc1 L_fq120
    s_cbranch_vccnz L_fr120
    s_waitcnt vmcnt(4)
L_fr120:
    s_waitcnt vmcnt(5)
L_fq120:
    s_waitcnt vmcnt(7)
    buffer_load_dwordx4 v[176:179], v4, s[12:15], s78 offen offset:3072 nt
    v_and_b32_dpp v28, v45, v24 row_newbcast:0 row_mask:0xf bank_mask:0xf
    v_and_b32_dpp v29, v45, v25 row_newbcast:0 row_mask:0xf bank_mask:0xf
    v_and_b32_dpp v30, v45, v26 row_newbcast:0 row_mask:0xf bank_mask:0xf
    v_and_b32_dpp v31, v45, v27 row_newbcast:0 row_mask:0xf bank_mask:0xf
    v_mfma_f32_16x16x32_bf16 v[36:39], v[32:35], v[144:147], v[36:39]
    s_memrealtime s[96:97]
    s_waitcnt lgkmcnt(0)
    s_sub_u32 s96, s96, s34
    s_cmp_gt_i32 s96, 2328
    s_cselect_b64 vcc, -1, 0
    s_cmp_gt_i32 s96, 2368
    s_cselect_b32 s35, 1, 0
    s_add_u32 s76, s76, 131072
    s_and_b32 s76, s76, 0x3fffff
    s_bfe_u32 s6, s76, 0x10011
    s_lshl_b32 s6, s6, 21
    s_xor_b32 s6, s6, s79
    s_and_b32 s5, s76, 0x1ffff
    s_xor_b32 s6, s6, s5
    s_lshr_b32 s5, s76, 18
    s_lshl_b32 s5, s5, 17
    s_xor_b32 s78, s6, s5
    s_cmp_eq_u32 s35, 1
    s_cbranch_scc1 L_fq121
    s_cbranch_vccnz L_fr121
    s_waitcnt vmcnt(4)
L_fr121:
    s_waitcnt vmcnt(5)
L_fq121:
    s_waitcnt vmcnt(7)
    buffer_load_dwordx4 v[180:183], v4, s[12:15], s78 offen offset:0 nt
    v_and_b32_dpp v32, v45, v24 row_newbcast:1 row_mask:0xf bank_mask:0xf
    v_and_b32_dpp v33, v45, v25 row_newbcast:1 row_mask:0xf bank_mask:0xf
    v_and_b32_dpp v34, v45, v26 row_newbcast:1 row_mask:0xf bank_mask:0xf
    v_and_b32_dpp v35, v45, v27 row_newbcast:1 row_mask:0xf bank_mask:0xf
    v_mfma_f32_16x16x32_bf16 v[36:39], v[28:31], v[148:151], v[36:39]
    s_cmp_eq_u32 s35, 1
    s_cbranch_scc1 L_fq122
    s_cbranch_vccnz L_fr122
    s_waitcnt vmcnt(4)
L_fr122:
    s_waitcnt vmcnt(5)
L_fq122:
    s_waitcnt vmcnt(7)
    buffer_load_dwordx4 v[184:187], v4, s[12:15], s78 offen offset:1024 nt
    v_and_b32_dpp v28, v45, v24 row_newbcast:2 row_mask:0xf bank_mask:0xf
    v_and_b32_dpp v29, v45, v25 row_newbcast:2 row_mask:0xf bank_mask:0xf
    v_and_b32_dpp v30, v45, v26 row_newbcast:2 row_mask:0xf bank_mask:0xf
    v_and_b32_dpp v31, v45, v27 row_newbcast:2 row_mask:0xf bank_mask:0xf
    v_mfma_f32_16x16x32_bf16 v[36:39], v[32:35], v[152:155], v[36:39]
    s_cmp_eq_u32 s35, 1
    s_cbranch_scc1 L_fq123
    s_cbranch_vccnz L_fr123
    s_waitcnt vmcnt(4)
L_fr123:
    s_waitcnt vmcnt(5)
L_fq123:
    s_waitcnt vmcnt(7)
    buffer_load_dwordx4 v[188:191], v4, s[12:15], s78 offen offset:2048 nt
    v_and_b32_dpp v32, v45, v24 row_newbcast:3 row_mask:0xf bank_mask:0xf
    v_and_b32_dpp v33, v45, v25 row_newbcast:3 row_mask:0xf bank_mask:0xf
    v_and_b32_dpp v34, v45, v26 row_newbcast:3 row_mask:0xf bank_mask:0xf
    v_and_b32_dpp v35, v45, v27 row_newbcast:3 row_mask:0xf bank_mask:0xf
    v_mfma_f32_16x16x32_bf16 v[36:39], v[28:31], v[156:159], v[36:39]
    s_cmp_eq_u32 s35, 1
    s_cbranch_scc1 L_fq124
    s_cbranch_vccnz L_fr124
    s_waitcnt vmcnt(4)
L_fr124:
    s_waitcnt vmcnt(5)
L_fq124:
    s_waitcnt vmcnt(7)
    buffer_load_dwordx4 v[192:195], v4, s[12:15], s78 offen offset:3072 nt
    v_and_b32_dpp v28, v45, v24 row_newbcast:4 row_mask:0xf bank_mask:0xf
    v_and_b32_dpp v29, v45, v25 row_newbcast:4 row_mask:0xf bank_mask:0xf
    v_and_b32_dpp v30, v45, v26 row_newbcast:4 row_mask:0xf bank_mask:0xf
    v_and_b32_dpp v31, v45, v27 row_newbcast:4 row_mask:0xf bank_mask:0xf
    v_mfma_f32_16x16x32_bf16 v[36:39], v[32:35], v[160:163], v[36:39]
    s_memrealtime s[96:97]
    s_waitcnt lgkmcnt(0)
    s_sub_u32 s96, s96, s34
    s_cmp_gt_i32 s96, 2384
    s_cselect_b64 vcc, -1, 0
    s_cmp_gt_i32 s96, 2424
    s_cselect_b32 s35, 1, 0
    s_add_u32 s76, s76, 131072
    s_and_b32 s76, s76, 0x3fffff
    s_bfe_u32 s6, s76, 0x10011
    s_lshl_b32 s6, s6, 21
    s_xor_b32 s6, s6, s79
    s_and_b32 s5, s76, 0x1ffff
    s_xor_b32 s6, s6, s5
    s_lshr_b32 s5, s76, 18
    s_lshl_b32 s5, s5, 17
    s_xor_b32 s78, s6, s5
    s_cmp_eq_u32 s35, 1
    s_cbranch_scc1 L_fq125
    s_cbranch_vccnz L_fr125
    s_waitcnt vmcnt(4)
L_fr125:
    s_waitcnt vmcnt(5)
L_fq125:
    s_waitcnt vmcnt(7)
    buffer_load_dwordx4 v[196:199], v4, s[12:15], s78 offen offset:0 nt
    v_and_b32_dpp v32, v45, v24 row_newbcast:5 row_mask:0xf bank_mask:0xf
    v_and_b32_dpp v33, v45, v25 row_newbcast:5 row_mask:0xf bank_mask:0xf
    v_and_b32_dpp v34, v45, v26 row_newbcast:5 row_mask:0xf bank_mask:0xf
    v_and_b32_dpp v35, v45, v27 row_newbcast:5 row_mask:0xf bank_mask:0xf
    v_mfma_f32_16x16x32_bf16 v[36:39], v[28:31], v[164:167], v[36:39]
    s_cmp_eq_u32 s35, 1
    s_cbranch_scc1 L_fq126
    s_cbranch_vccnz L_fr126
    s_waitcnt vmcnt(4)
L_fr126:
    s_waitcnt vmcnt(5)
L_fq126:
    s_waitcnt vmcnt(7)
    buffer_load_dwordx4 v[200:203], v4, s[12:15], s78 offen offset:1024 nt
    v_and_b32_dpp v28, v45, v24 row_newbcast:6 row_mask:0xf bank_mask:0xf
    v_and_b32_dpp v29, v45, v25 row_newbcast:6 row_mask:0xf bank_mask:0xf
    v_and_b32_dpp v30, v45, v26 row_newbcast:6 row_mask:0xf bank_mask:0xf
    v_and_b32_dpp v31, v45, v27 row_newbcast:6 row_mask:0xf bank_mask:0xf
    v_mfma_f32_16x16x32_bf16 v[36:39], v[32:35], v[168:171], v[36:39]
    s_cmp_eq_u32 s35, 1
    s_cbranch_scc1 L_fq127
    s_cbranch_vccnz L_fr127
    s_waitcnt vmcnt(4)
L_fr127:
    s_waitcnt vmcnt(5)
L_fq127:
    s_waitcnt vmcnt(7)
    buffer_load_dwordx4 v[204:207], v4, s[12:15], s78 offen offset:2048 nt
    v_and_b32_dpp v32, v45, v24 row_newbcast:7 row_mask:0xf bank_mask:0xf
    v_and_b32_dpp v33, v45, v25 row_newbcast:7 row_mask:0xf bank_mask:0xf
    v_and_b32_dpp v34, v45, v26 row_newbcast:7 row_mask:0xf bank_mask:0xf
    v_and_b32_dpp v35, v45, v27 row_newbcast:7 row_mask:0xf bank_mask:0xf
    v_mfma_f32_16x16x32_bf16 v[36:39], v[28:31], v[172:175], v[36:39]
    s_cmp_eq_u32 s35, 1
    s_cbranch_scc1 L_fq128
    s_cbranch_vccnz L_fr128
    s_waitcnt vmcnt(4)
L_fr128:
    s_waitcnt vmcnt(5)
L_fq128:
    s_waitcnt vmcnt(7)
    buffer_load_dwordx4 v[208:211], v4, s[12:15], s78 offen offset:3072 nt
    v_and_b32_dpp v28, v45, v24 row_newbcast:8 row_mask:0xf bank_mask:0xf
    v_and_b32_dpp v29, v45, v25 row_newbcast:8 row_mask:0xf bank_mask:0xf
    v_and_b32_dpp v30, v45, v26 row_newbcast:8 row_mask:0xf bank_mask:0xf
    v_and_b32_dpp v31, v45, v27 row_newbcast:8 row_mask:0xf bank_mask:0xf
    v_mfma_f32_16x16x32_bf16 v[36:39], v[32:35], v[176:179], v[36:39]
    s_memrealtime s[96:97]
    s_waitcnt lgkmcnt(0)
    s_sub_u32 s96, s96, s34
    s_cmp_gt_i32 s96, 2440
    s_cselect_b64 vcc, -1, 0
    s_cmp_gt_i32 s96, 2480
    s_cselect_b32 s35, 1, 0
    s_add_u32 s76, s76, 131072
    s_and_b32 s76, s76, 0x3fffff
    s_bfe_u32 s6, s76, 0x10011
    s_lshl_b32 s6, s6, 21
    s_xor_b32 s6, s6, s79
    s_and_b32 s5, s76, 0x1ffff
    s_xor_b32 s6, s6, s5
    s_lshr_b32 s5, s76, 18
    s_lshl_b32 s5, s5, 17
    s_xor_b32 s78, s6, s5
    s_cmp_eq_u32 s35, 1
    s_cbranch_scc1 L_fq129
    s_cbranch_vccnz L_fr129
    s_waitcnt vmcnt(4)
L_fr129:
    s_waitcnt vmcnt(5)
L_fq129:
    s_waitcnt vmcnt(7)
    buffer_load_dwordx4 v[84:87], v4, s[12:15], s78 offen offset:0 nt
    v_and_b32_dpp v32, v45, v24 row_newbcast:9 row_mask:0xf bank_mask:0xf
    v_and_b32_dpp v33, v45, v25 row_newbcast:9 row_mask:0xf bank_mask:0xf
    v_and_b32_dpp v34, v45, v26 row_newbcast:9 row_mask:0xf bank_mask:0xf
    v_and_b32_dpp v35, v45, v27 row_newbcast:9 row_mask:0xf bank_mask:0xf
    v_mfma_f32_16x16x32_bf16 v[36:39], v[28:31], v[180:183], v[36:39]
    s_cmp_eq_u32 s35, 1
    s_cbranch_scc1 L_fq130
    s_cbranch_vccnz L_fr130
    s_waitcnt vmcnt(4)
L_fr130:
    s_waitcnt vmcnt(5)
L_fq130:
    s_waitcnt vmcnt(7)
    buffer_load_dwordx4 v[88:91], v4, s[12:15], s78 offen offset:1024 nt
    v_and_b32_dpp v28, v45, v24 row_newbcast:10 row_mask:0xf bank_mask:0xf
    v_and_b32_dpp v29, v45, v25 row_newbcast:10 row_mask:0xf bank_mask:0xf
    v_and_b32_dpp v30, v45, v26 row_newbcast:10 row_mask:0xf bank_mask:0xf
    v_and_b32_dpp v31, v45, v27 row_newbcast:10 row_mask:0xf bank_mask:0xf
    v_mfma_f32_16x16x32_bf16 v[36:39], v[32:35], v[184:187], v[36:39]
    s_cmp_eq_u32 s35, 1
    s_cbranch_scc1 L_fq131
    s_cbranch_vccnz L_fr131
    s_waitcnt vmcnt(4)
L_fr131:
    s_waitcnt vmcnt(5)
L_fq131:
    s_waitcnt vmcnt(7)
    buffer_load_dwordx4 v[92:95], v4, s[12:15], s78 offen offset:2048 nt
    v_and_b32_dpp v32, v45, v24 row_newbcast:11 row_mask:0xf bank_mask:0xf
    v_and_b32_dpp v33, v45, v25 row_newbcast:11 row_mask:0xf bank_mask:0xf
    v_and_b32_dpp v34, v45, v26 row_newbcast:11 row_mask:0xf bank_mask:0xf
    v_and_b32_dpp v35, v45, v27 row_newbcast:11 row_mask:0xf bank_mask:0xf
    v_mfma_f32_16x16x32_bf16 v[36:39], v[28:31], v[188:191], v[36:39]
    s_cmp_eq_u32 s35, 1
    s_cbranch_scc1 L_fq132
    s_cbranch_vccnz L_fr132
    s_waitcnt vmcnt(4)
L_fr132:
    s_waitcnt vmcnt(5)
L_fq132:
    s_waitcnt vmcnt(7)
    buffer_load_dwordx4 v[96:99], v4, s[12:15], s78 offen offset:3072 nt
    v_and_b32_dpp v28, v45, v24 row_newbcast:12 row_mask:0xf bank_mask:0xf
    v_and_b32_dpp v29, v45, v25 row_newbcast:12 row_mask:0xf bank_mask:0xf
    v_and_b32_dpp v30, v45, v26 row_newbcast:12 row_mask:0xf bank_mask:0xf
    v_and_b32_dpp v31, v45, v27 row_newbcast:12 row_mask:0xf bank_mask:0xf
    v_mfma_f32_16x16x32_bf16 v[36:39], v[32:35], v[192:195], v[36:39]
    s_memrealtime s[96:97]
    s_waitcnt lgkmcnt(0)
    s_sub_u32 s96, s96, s34
    s_cmp_gt_i32 s96, 2496
    s_cselect_b64 vcc, -1, 0
    s_cmp_gt_i32 s96, 2536
    s_cselect_b32 s35, 1, 0
    s_add_u32 s76, s76, 131072
    s_and_b32 s76, s76, 0x3fffff
    s_bfe_u32 s6, s76, 0x10011
    s_lshl_b32 s6, s6, 21
    s_xor_b32 s6, s6, s79
    s_and_b32 s5, s76, 0x1ffff
    s_xor_b32 s6, s6, s5
    s_lshr_b32 s5, s76, 18
    s_lshl_b32 s5, s5, 17
    s_xor_b32 s78, s6, s5
    s_cmp_eq_u32 s35, 1
    s_cbranch_scc1 L_fq133
    s_cbranch_vccnz L_fr133
    s_waitcnt vmcnt(4)
L_fr133:
    s_waitcnt vmcnt(5)
L_fq133:
    s_waitcnt vmcnt(7)
    buffer_load_dwordx4 v[100:103], v4, s[12:15], s78 offen offset:0 nt
    v_and_b32_dpp v32, v45, v24 row_newbcast:13 row_mask:0xf bank_mask:0xf
    v_and_b32_dpp v33, v45, v25 row_newbcast:13 row_mask:0xf bank_mask:0xf
    v_and_b32_dpp v34, v45, v26 row_newbcast:13 row_mask:0xf bank_mask:0xf
    v_and_b32_dpp v35, v45, v27 row_newbcast:13 row_mask:0xf bank_mask:0xf
    v_mfma_f32_16x16x32_bf16 v[36:39], v[28:31], v[196:199], v[36:39]
    s_cmp_eq_u32 s35, 1
    s_cbranch_scc1 L_fq134
    s_cbranch_vccnz L_fr134
    s_waitcnt vmcnt(4)
L_fr134:
    s_waitcnt vmcnt(5)
L_fq134:
    s_waitcnt vmcnt(7)
    buffer_load_dwordx4 v[104:107], v4, s[12:15], s78 offen offset:1024 nt
    v_and_b32_dpp v28, v45, v24 row_newbcast:14 row_mask:0xf bank_mask:0xf
    v_and_b32_dpp v29, v45, v25 row_newbcast:14 row_mask:0xf bank_mask:0xf
    v_and_b32_dpp v30, v45, v26 row_newbcast:14 row_mask:0xf bank_mask:0xf
    v_and_b32_dpp v31, v45, v27 row_newbcast:14 row_mask:0xf bank_mask:0xf
    v_mfma_f32_16x16x32_bf16 v[36:39], v[32:35], v[200:203], v[36:39]
    s_cmp_eq_u32 s35, 1
    s_cbranch_scc1 L_fq135
    s_cbranch_vccnz L_fr135
    s_waitcnt vmcnt(4)
L_fr135:
    s_waitcnt vmcnt(5)
L_fq135:
    s_waitcnt vmcnt(7)
    buffer_load_dwordx4 v[108:111], v4, s[12:15], s78 offen offset:2048 nt
    v_and_b32_dpp v32, v45, v24 row_newbcast:15 row_mask:0xf bank_mask:0xf
    v_and_b32_dpp v33, v45, v25 row_newbcast:15 row_mask:0xf bank_mask:0xf
    v_and_b32_dpp v34, v45, v26 row_newbcast:15 row_mask:0xf bank_mask:0xf
    v_and_b32_dpp v35, v45, v27 row_newbcast:15 row_mask:0xf bank_mask:0xf
    v_mfma_f32_16x16x32_bf16 v[36:39], v[28:31], v[204:207], v[36:39]
    s_cmp_eq_u32 s35, 1
    s_cbranch_scc1 L_fq136
    s_cbranch_vccnz L_fr136
    s_waitcnt vmcnt(4)
L_fr136:
    s_waitcnt vmcnt(5)
L_fq136:
    s_waitcnt vmcnt(7)
    buffer_load_dwordx4 v[112:115], v4, s[12:15], s78 offen offset:3072 nt
    v_and_b32_dpp v28, v46, v24 row_newbcast:0 row_mask:0xf bank_mask:0xf
    v_and_b32_dpp v29, v46, v25 row_newbcast:0 row_mask:0xf bank_mask:0xf
    v_and_b32_dpp v30, v46, v26 row_newbcast:0 row_mask:0xf bank_mask:0xf
    v_and_b32_dpp v31, v46, v27 row_newbcast:0 row_mask:0xf bank_mask:0xf
    v_mfma_f32_16x16x32_bf16 v[36:39], v[32:35], v[208:211], v[36:39]
    s_memrealtime s[96:97]
    s_waitcnt lgkmcnt(0)
    s_sub_u32 s96, s96, s34
    s_cmp_gt_i32 s96, 2552
    s_cselect_b64 vcc, -1, 0
    s_cmp_gt_i32 s96, 2592
    s_cselect_b32 s35, 1, 0
    s_add_u32 s76, s76, 131072
    s_and_b32 s76, s76, 0x3fffff
    s_bfe_u32 s6, s76, 0x10011
    s_lshl_b32 s6, s6, 21
    s_xor_b32 s6, s6, s79
    s_and_b32 s5, s76, 0x1ffff
    s_xor_b32 s6, s6, s5
    s_lshr_b32 s5, s76, 18
    s_lshl_b32 s5, s5, 17
    s_xor_b32 s78, s6, s5
    s_cmp_eq_u32 s35, 1
    s_cbranch_scc1 L_fq137
    s_cbranch_vccnz L_fr137
    s_waitcnt vmcnt(4)
L_fr137:
    s_waitcnt vmcnt(5)
L_fq137:
    s_waitcnt vmcnt(7)
    buffer_load_dwordx4 v[116:119], v4, s[12:15], s78 offen offset:0 nt
    v_and_b32_dpp v32, v46, v24 row_newbcast:1 row_mask:0xf bank_mask:0xf
    v_and_b32_dpp v33, v46, v25 row_newbcast:1 row_mask:0xf bank_mask:0xf
    v_and_b32_dpp v34, v46, v26 row_newbcast:1 row_mask:0xf bank_mask:0xf
    v_and_b32_dpp v35, v46, v27 row_newbcast:1 row_mask:0xf bank_mask:0xf
    v_mfma_f32_16x16x32_bf16 v[36:39], v[28:31], v[84:87], v[36:39]
    s_cmp_eq_u32 s35, 1
    s_cbranch_scc1 L_fq138
    s_cbranch_vccnz L_fr138
    s_waitcnt vmcnt(4)
L_fr138:
    s_waitcnt vmcnt(5)
L_fq138:
    s_waitcnt vmcnt(7)
    buffer_load_dwordx4 v[120:123], v4, s[12:15], s78 offen offset:1024 nt
    v_and_b32_dpp v28, v46, v24 row_newbcast:2 row_mask:0xf bank_mask:0xf
    v_and_b32_dpp v29, v46, v25 row_newbcast:2 row_mask:0xf bank_mask:0xf
    v_and_b32_dpp v30, v46, v26 row_newbcast:2 row_mask:0xf bank_mask:0xf
    v_and_b32_dpp v31, v46, v27 row_newbcast:2 row_mask:0xf bank_mask:0xf
    v_mfma_f32_16x16x32_bf16 v[36:39], v[32:35], v[88:91], v[36:39]
    s_cmp_eq_u32 s35, 1
    s_cbranch_scc1 L_fq139
    s_cbranch_vccnz L_fr139
    s_waitcnt vmcnt(4)
L_fr139:
    s_waitcnt vmcnt(5)
L_fq139:
    s_waitcnt vmcnt(7)
    buffer_load_dwordx4 v[124:127], v4, s[12:15], s78 offen offset:2048 nt
    v_and_b32_dpp v32, v46, v24 row_newbcast:3 row_mask:0xf bank_mask:0xf
    v_and_b32_dpp v33, v46, v25 row_newbcast:3 row_mask:0xf bank_mask:0xf
    v_and_b32_dpp v34, v46, v26 row_newbcast:3 row_mask:0xf bank_mask:0xf
    v_and_b32_dpp v35, v46, v27 row_newbcast:3 row_mask:0xf bank_mask:0xf
    v_mfma_f32_16x16x32_bf16 v[36:39], v[28:31], v[92:95], v[36:39]
    s_cmp_eq_u32 s35, 1
    s_cbranch_scc1 L_fq140
    s_cbranch_vccnz L_fr140
    s_waitcnt vmcnt(4)
L_fr140:
    s_waitcnt vmcnt(5)
L_fq140:
    s_waitcnt vmcnt(7)
    buffer_load_dwordx4 v[128:131], v4, s[12:15], s78 offen offset:3072 nt
    v_and_b32_dpp v28, v46, v24 row_newbcast:4 row_mask:0xf bank_mask:0xf
    v_and_b32_dpp v29, v46, v25 row_newbcast:4 row_mask:0xf bank_mask:0xf
    v_and_b32_dpp v30, v46, v26 row_newbcast:4 row_mask:0xf bank_mask:0xf
    v_and_b32_dpp v31, v46, v27 row_newbcast:4 row_mask:0xf bank_mask:0xf
    v_mfma_f32_16x16x32_bf16 v[36:39], v[32:35], v[96:99], v[36:39]
    s_memrealtime s[96:97]
    s_waitcnt lgkmcnt(0)
    s_sub_u32 s96, s96, s34
    s_cmp_gt_i32 s96, 2608
    s_cselect_b64 vcc, -1, 0
    s_cmp_gt_i32 s96, 2648
    s_cselect_b32 s35, 1, 0
    s_add_u32 s76, s76, 131072
    s_and_b32 s76, s76, 0x3fffff
    s_bfe_u32 s6, s76, 0x10011
    s_lshl_b32 s6, s6, 21
    s_xor_b32 s6, s6, s79
    s_and_b32 s5, s76, 0x1ffff
    s_xor_b32 s6, s6, s5
    s_lshr_b32 s5, s76, 18
    s_lshl_b32 s5, s5, 17
    s_xor_b32 s78, s6, s5
    s_cmp_eq_u32 s35, 1
    s_cbranch_scc1 L_fq141
    s_cbranch_vccnz L_fr141
    s_waitcnt vmcnt(4)
L_fr141:
    s_waitcnt vmcnt(5)
L_fq141:
    s_waitcnt vmcnt(7)
    buffer_load_dwordx4 v[132:135], v4, s[12:15], s78 offen offset:0 nt
    v_and_b32_dpp v32, v46, v24 row_newbcast:5 row_mask:0xf bank_mask:0xf
    v_and_b32_dpp v33, v46, v25 row_newbcast:5 row_mask:0xf bank_mask:0xf
    v_and_b32_dpp v34, v46, v26 row_newbcast:5 row_mask:0xf bank_mask:0xf
    v_and_b32_dpp v35, v46, v27 row_newbcast:5 row_mask:0xf bank_mask:0xf
    v_mfma_f32_16x16x32_bf16 v[36:39], v[28:31], v[100:103], v[36:39]
    s_cmp_eq_u32 s35, 1
    s_cbranch_scc1 L_fq142
    s_cbranch_vccnz L_fr142
    s_waitcnt vmcnt(4)
L_fr142:
    s_waitcnt vmcnt(5)
L_fq142:
    s_waitcnt vmcnt(7)
    buffer_load_dwordx4 v[136:139], v4, s[12:15], s78 offen offset:1024 nt
    v_and_b32_dpp v28, v46, v24 row_newbcast:6 row_mask:0xf bank_mask:0xf
    v_and_b32_dpp v29, v46, v25 row_newbcast:6 row_mask:0xf bank_mask:0xf
    v_and_b32_dpp v30, v46, v26 row_newbcast:6 row_mask:0xf bank_mask:0xf
    v_and_b32_dpp v31, v46, v27 row_newbcast:6 row_mask:0xf bank_mask:0xf
    v_mfma_f32_16x16x32_bf16 v[36:39], v[32:35], v[104:107], v[36:39]
    s_cmp_eq_u32 s35, 1
    s_cbranch_scc1 L_fq143
    s_cbranch_vccnz L_fr143
    s_waitcnt vmcnt(4)
L_fr143:
    s_waitcnt vmcnt(5)
L_fq143:
    s_waitcnt vmcnt(7)
    buffer_load_dwordx4 v[140:143], v4, s[12:15], s78 offen offset:2048 nt
    v_and_b32_dpp v32, v46, v24 row_newbcast:7 row_mask:0xf bank_mask:0xf
    v_and_b32_dpp v33, v46, v25 row_newbcast:7 row_mask:0xf bank_mask:0xf
    v_and_b32_dpp v34, v46, v26 row_newbcast:7 row_mask:0xf bank_mask:0xf
    v_and_b32_dpp v35, v46, v27 row_newbcast:7 row_mask:0xf bank_mask:0xf
    v_mfma_f32_16x16x32_bf16 v[36:39], v[28:31], v[108:111], v[36:39]
    s_cmp_eq_u32 s35, 1
    s_cbranch_scc1 L_fq144
    s_cbranch_vccnz L_fr144
    s_waitcnt vmcnt(4)
L_fr144:
    s_waitcnt vmcnt(5)
L_fq144:
    s_waitcnt vmcnt(7)
    buffer_load_dwordx4 v[144:147], v4, s[12:15], s78 offen offset:3072 nt
    v_and_b32_dpp v28, v46, v24 row_newbcast:8 row_mask:0xf bank_mask:0xf
    v_and_b32_dpp v29, v46, v25 row_newbcast:8 row_mask:0xf bank_mask:0xf
    v_and_b32_dpp v30, v46, v26 row_newbcast:8 row_mask:0xf bank_mask:0xf
    v_and_b32_dpp v31, v46, v27 row_newbcast:8 row_mask:0xf bank_mask:0xf
    v_mfma_f32_16x16x32_bf16 v[36:39], v[32:35], v[112:115], v[36:39]
    s_memrealtime s[96:97]
    s_waitcnt lgkmcnt(0)
    s_sub_u32 s96, s96, s34
    s_cmp_gt_i32 s96, 2664
    s_cselect_b64 vcc, -1, 0
    s_cmp_gt_i32 s96, 2704
    s_cselect_b32 s35, 1, 0
    s_add_u32 s76, s76, 131072
    s_and_b32 s76, s76, 0x3fffff
    s_bfe_u32 s6, s76, 0x10011
    s_lshl_b32 s6, s6, 21
    s_xor_b32 s6, s6, s79
    s_and_b32 s5, s76, 0x1ffff
    s_xor_b32 s6, s6, s5
    s_lshr_b32 s5, s76, 18
    s_lshl_b32 s5, s5, 17
    s_xor_b32 s78, s6, s5
    s_cmp_eq_u32 s35, 1
    s_cbranch_scc1 L_fq145
    s_cbranch_vccnz L_fr145
    s_waitcnt vmcnt(4)
L_fr145:
    s_waitcnt vmcnt(5)
L_fq145:
    s_waitcnt vmcnt(7)
    buffer_load_dwordx4 v[148:151], v4, s[12:15], s78 offen offset:0 nt
    v_and_b32_dpp v32, v46, v24 row_newbcast:9 row_mask:0xf bank_mask:0xf
    v_and_b32_dpp v33, v46, v25 row_newbcast:9 row_mask:0xf bank_mask:0xf
    v_and_b32_dpp v34, v46, v26 row_newbcast:9 row_mask:0xf bank_mask:0xf
    v_and_b32_dpp v35, v46, v27 row_newbcast:9 row_mask:0xf bank_mask:0xf
    v_mfma_f32_16x16x32_bf16 v[36:39], v[28:31], v[116:119], v[36:39]
    s_cmp_eq_u32 s35, 1
    s_cbranch_scc1 L_fq146
    s_cbranch_vccnz L_fr146
    s_waitcnt vmcnt(4)
L_fr146:
    s_waitcnt vmcnt(5)
L_fq146:
    s_waitcnt vmcnt(7)
    buffer_load_dwordx4 v[152:155], v4, s[12:15], s78 offen offset:1024 nt
    v_and_b32_dpp v28, v46, v24 row_newbcast:10 row_mask:0xf bank_mask:0xf
    v_and_b32_dpp v29, v46, v25 row_newbcast:10 row_mask:0xf bank_mask:0xf
    v_and_b32_dpp v30, v46, v26 row_newbcast:10 row_mask:0xf bank_mask:0xf
    v_and_b32_dpp v31, v46, v27 row_newbcast:10 row_mask:0xf bank_mask:0xf
    v_mfma_f32_16x16x32_bf16 v[36:39], v[32:35], v[120:123], v[36:39]
    s_cmp_eq_u32 s35, 1
    s_cbranch_scc1 L_fq147
    s_cbranch_vccnz L_fr147
    s_waitcnt vmcnt(4)
L_fr147:
    s_waitcnt vmcnt(5)
L_fq147:
    s_waitcnt vmcnt(7)
    buffer_load_dwordx4 v[156:159], v4, s[12:15], s78 offen offset:2048 nt
    v_and_b32_dpp v32, v46, v24 row_newbcast:11 row_mask:0xf bank_mask:0xf
    v_and_b32_dpp v33, v46, v25 row_newbcast:11 row_mask:0xf bank_mask:0xf
    v_and_b32_dpp v34, v46, v26 row_newbcast:11 row_mask:0xf bank_mask:0xf
    v_and_b32_dpp v35, v46, v27 row_newbcast:11 row_mask:0xf bank_mask:0xf
    v_mfma_f32_16x16x32_bf16 v[36:39], v[28:31], v[124:127], v[36:39]
    s_cmp_eq_u32 s35, 1
    s_cbranch_scc1 L_fq148
    s_cbranch_vccnz L_fr148
    s_waitcnt vmcnt(4)
L_fr148:
    s_waitcnt vmcnt(5)
L_fq148:
    s_waitcnt vmcnt(7)
    buffer_load_dwordx4 v[160:163], v4, s[12:15], s78 offen offset:3072 nt
    v_and_b32_dpp v28, v46, v24 row_newbcast:12 row_mask:0xf bank_mask:0xf
    v_and_b32_dpp v29, v46, v25 row_newbcast:12 row_mask:0xf bank_mask:0xf
    v_and_b32_dpp v30, v46, v26 row_newbcast:12 row_mask:0xf bank_mask:0xf
    v_and_b32_dpp v31, v46, v27 row_newbcast:12 row_mask:0xf bank_mask:0xf
    v_mfma_f32_16x16x32_bf16 v[36:39], v[32:35], v[128:131], v[36:39]
    s_memrealtime s[96:97]
    s_waitcnt lgkmcnt(0)
    s_sub_u32 s96, s96, s34
    s_cmp_gt_i32 s96, 2720
    s_cselect_b64 vcc, -1, 0
    s_cmp_gt_i32 s96, 2760
    s_cselect_b32 s35, 1, 0
    s_add_u32 s76, s76, 131072
    s_and_b32 s76, s76, 0x3fffff
    s_bfe_u32 s6, s76, 0x10011
    s_lshl_b32 s6, s6, 21
    s_xor_b32 s6, s6, s79
    s_and_b32 s5, s76, 0x1ffff
    s_xor_b32 s6, s6, s5
    s_lshr_b32 s5, s76, 18
    s_lshl_b32 s5, s5, 17
    s_xor_b32 s78, s6, s5
    s_cmp_eq_u32 s35, 1
    s_cbranch_scc1 L_fq149
    s_cbranch_vccnz L_fr149
    s_waitcnt vmcnt(4)
L_fr149:
    s_waitcnt vmcnt(5)
L_fq149:
    s_waitcnt vmcnt(7)
    buffer_load_dwordx4 v[164:167], v4, s[12:15], s78 offen offset:0 nt
    v_and_b32_dpp v32, v46, v24 row_newbcast:13 row_mask:0xf bank_mask:0xf
    v_and_b32_dpp v33, v46, v25 row_newbcast:13 row_mask:0xf bank_mask:0xf
    v_and_b32_dpp v34, v46, v26 row_newbcast:13 row_mask:0xf bank_mask:0xf
    v_and_b32_dpp v35, v46, v27 row_newbcast:13 row_mask:0xf bank_mask:0xf
    v_mfma_f32_16x16x32_bf16 v[36:39], v[28:31], v[132:135], v[36:39]
    s_cmp_eq_u32 s35, 1
    s_cbranch_scc1 L_fq150
    s_cbranch_vccnz L_fr150
    s_waitcnt vmcnt(4)
L_fr150:
    s_waitcnt vmcnt(5)
L_fq150:
    s_waitcnt vmcnt(7)
    buffer_load_dwordx4 v[168:171], v4, s[12:15], s78 offen offset:1024 nt
    v_and_b32_dpp v28, v46, v24 row_newbcast:14 row_mask:0xf bank_mask:0xf
    v_and_b32_dpp v29, v46, v25 row_newbcast:14 row_mask:0xf bank_mask:0xf
    v_and_b32_dpp v30, v46, v26 row_newbcast:14 row_mask:0xf bank_mask:0xf
    v_and_b32_dpp v31, v46, v27 row_newbcast:14 row_mask:0xf bank_mask:0xf
    v_mfma_f32_16x16x32_bf16 v[36:39], v[32:35], v[136:139], v[36:39]
    s_cmp_eq_u32 s35, 1
    s_cbranch_scc1 L_fq151
    s_cbranch_vccnz L_fr151
    s_waitcnt vmcnt(4)
L_fr151:
    s_waitcnt vmcnt(5)
L_fq151:
    s_waitcnt vmcnt(7)
    buffer_load_dwordx4 v[172:175], v4, s[12:15], s78 offen offset:2048 nt
    v_and_b32_dpp v32, v46, v24 row_newbcast:15 row_mask:0xf bank_mask:0xf
    v_and_b32_dpp v33, v46, v25 row_newbcast:15 row_mask:0xf bank_mask:0xf
    v_and_b32_dpp v34, v46, v26 row_newbcast:15 row_mask:0xf bank_mask:0xf
    v_and_b32_dpp v35, v46, v27 row_newbcast:15 row_mask:0xf bank_mask:0xf
    v_mfma_f32_16x16x32_bf16 v[36:39], v[28:31], v[140:143], v[36:39]
    s_cmp_eq_u32 s35, 1
    s_cbranch_scc1 L_fq152
    s_cbranch_vccnz L_fr152
    s_waitcnt vmcnt(4)
L_fr152:
    s_waitcnt vmcnt(5)
L_fq152:
    s_waitcnt vmcnt(7)
    buffer_load_dwordx4 v[176:179], v4, s[12:15], s78 offen offset:3072 nt
    v_and_b32_dpp v28, v47, v24 row_newbcast:0 row_mask:0xf bank_mask:0xf
    v_and_b32_dpp v29, v47, v25 row_newbcast:0 row_mask:0xf bank_mask:0xf
    v_and_b32_dpp v30, v47, v26 row_newbcast:0 row_mask:0xf bank_mask:0xf
    v_and_b32_dpp v31, v47, v27 row_newbcast:0 row_mask:0xf bank_mask:0xf
    v_mfma_f32_16x16x32_bf16 v[36:39], v[32:35], v[144:147], v[36:39]
    s_memrealtime s[96:97]
    s_waitcnt lgkmcnt(0)
    s_sub_u32 s96, s96, s34
    s_cmp_gt_i32 s96, 2776
    s_cselect_b64 vcc, -1, 0
    s_cmp_gt_i32 s96, 2816
    s_cselect_b32 s35, 1, 0
    s_add_u32 s76, s76, 131072
    s_and_b32 s76, s76, 0x3fffff
    s_bfe_u32 s6, s76, 0x10011
    s_lshl_b32 s6, s6, 21
    s_xor_b32 s6, s6, s79
    s_and_b32 s5, s76, 0x1ffff
    s_xor_b32 s6, s6, s5
    s_lshr_b32 s5, s76, 18
    s_lshl_b32 s5, s5, 17
    s_xor_b32 s78, s6, s5
    s_cmp_eq_u32 s35, 1
    s_cbranch_scc1 L_fq153
    s_cbranch_vccnz L_fr153
    s_waitcnt vmcnt(4)
L_fr153:
    s_waitcnt vmcnt(5)
L_fq153:
    s_waitcnt vmcnt(7)
    buffer_load_dwordx4 v[180:183], v4, s[12:15], s78 offen offset:0 nt
    v_and_b32_dpp v32, v47, v24 row_newbcast:1 row_mask:0xf bank_mask:0xf
    v_and_b32_dpp v33, v47, v25 row_newbcast:1 row_mask:0xf bank_mask:0xf
    v_and_b32_dpp v34, v47, v26 row_newbcast:1 row_mask:0xf bank_mask:0xf
    v_and_b32_dpp v35, v47, v27 row_newbcast:1 row_mask:0xf bank_mask:0xf
    v_mfma_f32_16x16x32_bf16 v[36:39], v[28:31], v[148:151], v[36:39]
    s_cmp_eq_u32 s35, 1
    s_cbranch_scc1 L_fq154
    s_cbranch_vccnz L_fr154
    s_waitcnt vmcnt(4)
L_fr154:
    s_waitcnt vmcnt(5)
L_fq154:
    s_waitcnt vmcnt(7)
    buffer_load_dwordx4 v[184:187], v4, s[12:15], s78 offen offset:1024 nt
    v_and_b32_dpp v28, v47, v24 row_newbcast:2 row_mask:0xf bank_mask:0xf
    v_and_b32_dpp v29, v47, v25 row_newbcast:2 row_mask:0xf bank_mask:0xf
    v_and_b32_dpp v30, v47, v26 row_newbcast:2 row_mask:0xf bank_mask:0xf
    v_and_b32_dpp v31, v47, v27 row_newbcast:2 row_mask:0xf bank_mask:0xf
    v_mfma_f32_16x16x32_bf16 v[36:39], v[32:35], v[152:155], v[36:39]
    s_cmp_eq_u32 s35, 1
    s_cbranch_scc1 L_fq155
    s_cbranch_vccnz L_fr155
    s_waitcnt vmcnt(4)
L_fr155:
    s_waitcnt vmcnt(5)
L_fq155:
    s_waitcnt vmcnt(7)
    buffer_load_dwordx4 v[188:191], v4, s[12:15], s78 offen offset:2048 nt
    v_and_b32_dpp v32, v47, v24 row_newbcast:3 row_mask:0xf bank_mask:0xf
    v_and_b32_dpp v33, v47, v25 row_newbcast:3 row_mask:0xf bank_mask:0xf
    v_and_b32_dpp v34, v47, v26 row_newbcast:3 row_mask:0xf bank_mask:0xf
    v_and_b32_dpp v35, v47, v27 row_newbcast:3 row_mask:0xf bank_mask:0xf
    v_mfma_f32_16x16x32_bf16 v[36:39], v[28:31], v[156:159], v[36:39]
    s_cmp_eq_u32 s35, 1
    s_cbranch_scc1 L_fq156
    s_cbranch_vccnz L_fr156
    s_waitcnt vmcnt(4)
L_fr156:
    s_waitcnt vmcnt(5)
L_fq156:
    s_waitcnt vmcnt(7)
    buffer_load_dwordx4 v[192:195], v4, s[12:15], s78 offen offset:3072 nt
    v_and_b32_dpp v28, v47, v24 row_newbcast:4 row_mask:0xf bank_mask:0xf
    v_and_b32_dpp v29, v47, v25 row_newbcast:4 row_mask:0xf bank_mask:0xf
    v_and_b32_dpp v30, v47, v26 row_newbcast:4 row_mask:0xf bank_mask:0xf
    v_and_b32_dpp v31, v47, v27 row_newbcast:4 row_mask:0xf bank_mask:0xf
    v_mfma_f32_16x16x32_bf16 v[36:39], v[32:35], v[160:163], v[36:39]
    s_memrealtime s[96:97]
    s_waitcnt lgkmcnt(0)
    s_sub_u32 s96, s96, s34
    s_cmp_gt_i32 s96, 2832
    s_cselect_b64 vcc, -1, 0
    s_cmp_gt_i32 s96, 2872
    s_cselect_b32 s35, 1, 0
    s_add_u32 s76, s76, 131072
    s_and_b32 s76, s76, 0x3fffff
    s_bfe_u32 s6, s76, 0x10011
    s_lshl_b32 s6, s6, 21
    s_xor_b32 s6, s6, s79
    s_and_b32 s5, s76, 0x1ffff
    s_xor_b32 s6, s6, s5
    s_lshr_b32 s5, s76, 18
    s_lshl_b32 s5, s5, 17
    s_xor_b32 s78, s6, s5
    s_cmp_eq_u32 s35, 1
    s_cbranch_scc1 L_fq157
    s_cbranch_vccnz L_fr157
    s_waitcnt vmcnt(4)
L_fr157:
    s_waitcnt vmcnt(5)
L_fq157:
    s_waitcnt vmcnt(7)
    buffer_load_dwordx4 v[196:199], v4, s[12:15], s78 offen offset:0 nt
    v_and_b32_dpp v32, v47, v24 row_newbcast:5 row_mask:0xf bank_mask:0xf
    v_and_b32_dpp v33, v47, v25 row_newbcast:5 row_mask:0xf bank_mask:0xf
    v_and_b32_dpp v34, v47, v26 row_newbcast:5 row_mask:0xf bank_mask:0xf
    v_and_b32_dpp v35, v47, v27 row_newbcast:5 row_mask:0xf bank_mask:0xf
    v_mfma_f32_16x16x32_bf16 v[36:39], v[28:31], v[164:167], v[36:39]
    s_cmp_eq_u32 s35, 1
    s_cbranch_scc1 L_fq158
    s_cbranch_vccnz L_fr158
    s_waitcnt vmcnt(4)
L_fr158:
    s_waitcnt vmcnt(5)
L_fq158:
    s_waitcnt vmcnt(7)
    buffer_load_dwordx4 v[200:203], v4, s[12:15], s78 offen offset:1024 nt
    v_and_b32_dpp v28, v47, v24 row_newbcast:6 row_mask:0xf bank_mask:0xf
    v_and_b32_dpp v29, v47, v25 row_newbcast:6 row_mask:0xf bank_mask:0xf
    v_and_b32_dpp v30, v47, v26 row_newbcast:6 row_mask:0xf bank_mask:0xf
    v_and_b32_dpp v31, v47, v27 row_newbcast:6 row_mask:0xf bank_mask:0xf
    v_mfma_f32_16x16x32_bf16 v[36:39], v[32:35], v[168:171], v[36:39]
    s_cmp_eq_u32 s35, 1
    s_cbranch_scc1 L_fq159
    s_cbranch_vccnz L_fr159
    s_waitcnt vmcnt(4)
L_fr159:
    s_waitcnt vmcnt(5)
L_fq159:
    s_waitcnt vmcnt(7)
    buffer_load_dwordx4 v[204:207], v4, s[12:15], s78 offen offset:2048 nt
    v_and_b32_dpp v32, v47, v24 row_newbcast:7 row_mask:0xf bank_mask:0xf
    v_and_b32_dpp v33, v47, v25 row_newbcast:7 row_mask:0xf bank_mask:0xf
    v_and_b32_dpp v34, v47, v26 row_newbcast:7 row_mask:0xf bank_mask:0xf
    v_and_b32_dpp v35, v47, v27 row_newbcast:7 row_mask:0xf bank_mask:0xf
    v_mfma_f32_16x16x32_bf16 v[36:39], v[28:31], v[172:175], v[36:39]
    s_cmp_eq_u32 s35, 1
    s_cbranch_scc1 L_fq160
    s_cbranch_vccnz L_fr160
    s_waitcnt vmcnt(4)
L_fr160:
    s_waitcnt vmcnt(5)
L_fq160:
    s_waitcnt vmcnt(7)
    buffer_load_dwordx4 v[208:211], v4, s[12:15], s78 offen offset:3072 nt
    v_and_b32_dpp v28, v47, v24 row_newbcast:8 row_mask:0xf bank_mask:0xf
    v_and_b32_dpp v29, v47, v25 row_newbcast:8 row_mask:0xf bank_mask:0xf
    v_and_b32_dpp v30, v47, v26 row_newbcast:8 row_mask:0xf bank_mask:0xf
    v_and_b32_dpp v31, v47, v27 row_newbcast:8 row_mask:0xf bank_mask:0xf
    v_mfma_f32_16x16x32_bf16 v[36:39], v[32:35], v[176:179], v[36:39]
    s_memrealtime s[96:97]
    s_waitcnt lgkmcnt(0)
    s_sub_u32 s96, s96, s34
    s_cmp_gt_i32 s96, 2884
    s_cselect_b64 vcc, -1, 0
    s_cmp_gt_i32 s96, 2924
    s_cselect_b32 s35, 1, 0
    s_add_u32 s76, s76, 131072
    s_and_b32 s76, s76, 0x3fffff
    s_bfe_u32 s6, s76, 0x10011
    s_lshl_b32 s6, s6, 21
    s_xor_b32 s6, s6, s79
    s_and_b32 s5, s76, 0x1ffff
    s_xor_b32 s6, s6, s5
    s_lshr_b32 s5, s76, 18
    s_lshl_b32 s5, s5, 17
    s_xor_b32 s78, s6, s5
    s_cmp_eq_u32 s35, 1
    s_cbranch_scc1 L_fq161
    s_cbranch_vccnz L_fr161
    s_waitcnt vmcnt(4)
L_fr161:
    s_waitcnt vmcnt(5)
L_fq161:
    s_waitcnt vmcnt(7)
    buffer_load_dwordx4 v[84:87], v4, s[12:15], s78 offen offset:0 nt
    v_and_b32_dpp v32, v47, v24 row_newbcast:9 row_mask:0xf bank_mask:0xf
    v_and_b32_dpp v33, v47, v25 row_newbcast:9 row_mask:0xf bank_mask:0xf
    v_and_b32_dpp v34, v47, v26 row_newbcast:9 row_mask:0xf bank_mask:0xf
    v_and_b32_dpp v35, v47, v27 row_newbcast:9 row_mask:0xf bank_mask:0xf
    v_mfma_f32_16x16x32_bf16 v[36:39], v[28:31], v[180:183], v[36:39]
    s_cmp_eq_u32 s35, 1
    s_cbranch_scc1 L_fq162
    s_cbranch_vccnz L_fr162
    s_waitcnt vmcnt(4)
L_fr162:
    s_waitcnt vmcnt(5)
L_fq162:
    s_waitcnt vmcnt(7)
    buffer_load_dwordx4 v[88:91], v4, s[12:15], s78 offen offset:1024 nt
    v_and_b32_dpp v28, v47, v24 row_newbcast:10 row_mask:0xf bank_mask:0xf
    v_and_b32_dpp v29, v47, v25 row_newbcast:10 row_mask:0xf bank_mask:0xf
    v_and_b32_dpp v30, v47, v26 row_newbcast:10 row_mask:0xf bank_mask:0xf
    v_and_b32_dpp v31, v47, v27 row_newbcast:10 row_mask:0xf bank_mask:0xf
    v_mfma_f32_16x16x32_bf16 v[36:39], v[32:35], v[184:187], v[36:39]
    s_cmp_eq_u32 s35, 1
    s_cbranch_scc1 L_fq163
    s_cbranch_vccnz L_fr163
    s_waitcnt vmcnt(4)
L_fr163:
    s_waitcnt vmcnt(5)
L_fq163:
    s_waitcnt vmcnt(7)
    buffer_load_dwordx4 v[92:95], v4, s[12:15], s78 offen offset:2048 nt
    v_and_b32_dpp v32, v47, v24 row_newbcast:11 row_mask:0xf bank_mask:0xf
    v_and_b32_dpp v33, v47, v25 row_newbcast:11 row_mask:0xf bank_mask:0xf
    v_and_b32_dpp v34, v47, v26 row_newbcast:11 row_mask:0xf bank_mask:0xf
    v_and_b32_dpp v35, v47, v27 row_newbcast:11 row_mask:0xf bank_mask:0xf
    v_mfma_f32_16x16x32_bf16 v[36:39], v[28:31], v[188:191], v[36:39]
    s_cmp_eq_u32 s35, 1
    s_cbranch_scc1 L_fq164
    s_cbranch_vccnz L_fr164
    s_waitcnt vmcnt(4)
L_fr164:
    s_waitcnt vmcnt(5)
L_fq164:
    s_waitcnt vmcnt(7)
    buffer_load_dwordx4 v[96:99], v4, s[12:15], s78 offen offset:3072 nt
    v_and_b32_dpp v28, v47, v24 row_newbcast:12 row_mask:0xf bank_mask:0xf
    v_and_b32_dpp v29, v47, v25 row_newbcast:12 row_mask:0xf bank_mask:0xf
    v_and_b32_dpp v30, v47, v26 row_newbcast:12 row_mask:0xf bank_mask:0xf
    v_and_b32_dpp v31, v47, v27 row_newbcast:12 row_mask:0xf bank_mask:0xf
    v_mfma_f32_16x16x32_bf16 v[36:39], v[32:35], v[192:195], v[36:39]
    s_memrealtime s[96:97]
    s_waitcnt lgkmcnt(0)
    s_sub_u32 s96, s96, s34
    s_cmp_gt_i32 s96, 2934
    s_cselect_b64 vcc, -1, 0
    s_cmp_gt_i32 s96, 2974
    s_cselect_b32 s35, 1, 0
    s_add_u32 s76, s76, 131072
    s_and_b32 s76, s76, 0x3fffff
    s_bfe_u32 s6, s76, 0x10011
    s_lshl_b32 s6, s6, 21
    s_xor_b32 s6, s6, s79
    s_and_b32 s5, s76, 0x1ffff
    s_xor_b32 s6, s6, s5
    s_lshr_b32 s5, s76, 18
    s_lshl_b32 s5, s5, 17
    s_xor_b32 s78, s6, s5
    s_cmp_eq_u32 s35, 1
    s_cbranch_scc1 L_fq165
    s_cbranch_vccnz L_fr165
    s_waitcnt vmcnt(4)
L_fr165:
    s_waitcnt vmcnt(5)
L_fq165:
    s_waitcnt vmcnt(7)
    buffer_load_dwordx4 v[100:103], v4, s[12:15], s78 offen offset:0 nt
    v_and_b32_dpp v32, v47, v24 row_newbcast:13 row_mask:0xf bank_mask:0xf
    v_and_b32_dpp v33, v47, v25 row_newbcast:13 row_mask:0xf bank_mask:0xf
    v_and_b32_dpp v34, v47, v26 row_newbcast:13 row_mask:0xf bank_mask:0xf
    v_and_b32_dpp v35, v47, v27 row_newbcast:13 row_mask:0xf bank_mask:0xf
    v_mfma_f32_16x16x32_bf16 v[36:39], v[28:31], v[196:199], v[36:39]
    s_cmp_eq_u32 s35, 1
    s_cbranch_scc1 L_fq166
    s_cbranch_vccnz L_fr166
    s_waitcnt vmcnt(4)
L_fr166:
    s_waitcnt vmcnt(5)
L_fq166:
    s_waitcnt vmcnt(7)
    buffer_load_dwordx4 v[104:107], v4, s[12:15], s78 offen offset:1024 nt
    v_and_b32_dpp v28, v47, v24 row_newbcast:14 row_mask:0xf bank_mask:0xf
    v_and_b32_dpp v29, v47, v25 row_newbcast:14 row_mask:0xf bank_mask:0xf
    v_and_b32_dpp v30, v47, v26 row_newbcast:14 row_mask:0xf bank_mask:0xf
    v_and_b32_dpp v31, v47, v27 row_newbcast:14 row_mask:0xf bank_mask:0xf
    v_mfma_f32_16x16x32_bf16 v[36:39], v[32:35], v[200:203], v[36:39]
    s_cmp_eq_u32 s35, 1
    s_cbranch_scc1 L_fq167
    s_cbranch_vccnz L_fr167
    s_waitcnt vmcnt(4)
L_fr167:
    s_waitcnt vmcnt(5)
L_fq167:
    s_waitcnt vmcnt(7)
    buffer_load_dwordx4 v[108:111], v4, s[12:15], s78 offen offset:2048 nt
    v_and_b32_dpp v32, v47, v24 row_newbcast:15 row_mask:0xf bank_mask:0xf
    v_and_b32_dpp v33, v47, v25 row_newbcast:15 row_mask:0xf bank_mask:0xf
    v_and_b32_dpp v34, v47, v26 row_newbcast:15 row_mask:0xf bank_mask:0xf
    v_and_b32_dpp v35, v47, v27 row_newbcast:15 row_mask:0xf bank_mask:0xf
    v_mfma_f32_16x16x32_bf16 v[36:39], v[28:31], v[204:207], v[36:39]
    s_cmp_eq_u32 s35, 1
    s_cbranch_scc1 L_fq168
    s_cbranch_vccnz L_fr168
    s_waitcnt vmcnt(4)
L_fr168:
    s_waitcnt vmcnt(5)
L_fq168:
    s_waitcnt vmcnt(7)
    buffer_load_dwordx4 v[112:115], v4, s[12:15], s78 offen offset:3072 nt
    v_and_b32_dpp v28, v48, v24 row_newbcast:0 row_mask:0xf bank_mask:0xf
    v_and_b32_dpp v29, v48, v25 row_newbcast:0 row_mask:0xf bank_mask:0xf
    v_and_b32_dpp v30, v48, v26 row_newbcast:0 row_mask:0xf bank_mask:0xf
    v_and_b32_dpp v31, v48, v27 row_newbcast:0 row_mask:0xf bank_mask:0xf
    v_mfma_f32_16x16x32_bf16 v[36:39], v[32:35], v[208:211], v[36:39]
    s_memrealtime s[96:97]
    s_waitcnt lgkmcnt(0)
    s_sub_u32 s96, s96, s34
    s_cmp_gt_i32 s96, 2984
    s_cselect_b64 vcc, -1, 0
    s_cmp_gt_i32 s96, 3024
    s_cselect_b32 s35, 1, 0
    s_add_u32 s76, s76, 131072
    s_and_b32 s76, s76, 0x3fffff
    s_bfe_u32 s6, s76, 0x10011
    s_lshl_b32 s6, s6, 21
    s_xor_b32 s6, s6, s79
    s_and_b32 s5, s76, 0x1ffff
    s_xor_b32 s6, s6, s5
    s_lshr_b32 s5, s76, 18
    s_lshl_b32 s5, s5, 17
    s_xor_b32 s78, s6, s5
    s_cmp_eq_u32 s35, 1
    s_cbranch_scc1 L_fq169
    s_cbranch_vccnz L_fr169
    s_waitcnt vmcnt(4)
L_fr169:
    s_waitcnt vmcnt(5)
L_fq169:
    s_waitcnt vmcnt(7)
    buffer_load_dwordx4 v[116:119], v4, s[12:15], s78 offen offset:0 nt
    v_and_b32_dpp v32, v48, v24 row_newbcast:1 row_mask:0xf bank_mask:0xf
    v_and_b32_dpp v33, v48, v25 row_newbcast:1 row_mask:0xf bank_mask:0xf
    v_and_b32_dpp v34, v48, v26 row_newbcast:1 row_mask:0xf bank_mask:0xf
    v_and_b32_dpp v35, v48, v27 row_newbcast:1 row_mask:0xf bank_mask:0xf
    v_mfma_f32_16x16x32_bf16 v[36:39], v[28:31], v[84:87], v[36:39]
    s_cmp_eq_u32 s35, 1
    s_cbranch_scc1 L_fq170
    s_cbranch_vccnz L_fr170
    s_waitcnt vmcnt(4)
L_fr170:
    s_waitcnt vmcnt(5)
L_fq170:
    s_waitcnt vmcnt(7)
    buffer_load_dwordx4 v[120:123], v4, s[12:15], s78 offen offset:1024 nt
    v_and_b32_dpp v28, v48, v24 row_newbcast:2 row_mask:0xf bank_mask:0xf
    v_and_b32_dpp v29, v48, v25 row_newbcast:2 row_mask:0xf bank_mask:0xf
    v_and_b32_dpp v30, v48, v26 row_newbcast:2 row_mask:0xf bank_mask:0xf
    v_and_b32_dpp v31, v48, v27 row_newbcast:2 row_mask:0xf bank_mask:0xf
    v_mfma_f32_16x16x32_bf16 v[36:39], v[32:35], v[88:91], v[36:39]
    s_cmp_eq_u32 s35, 1
    s_cbranch_scc1 L_fq171
    s_cbranch_vccnz L_fr171
    s_waitcnt vmcnt(4)
L_fr171:
    s_waitcnt vmcnt(5)
L_fq171:
    s_waitcnt vmcnt(7)
    buffer_load_dwordx4 v[124:127], v4, s[12:15], s78 offen offset:2048 nt
    v_and_b32_dpp v32, v48, v24 row_newbcast:3 row_mask:0xf bank_mask:0xf
    v_and_b32_dpp v33, v48, v25 row_newbcast:3 row_mask:0xf bank_mask:0xf
    v_and_b32_dpp v34, v48, v26 row_newbcast:3 row_mask:0xf bank_mask:0xf
    v_and_b32_dpp v35, v48, v27 row_newbcast:3 row_mask:0xf bank_mask:0xf
    v_mfma_f32_16x16x32_bf16 v[36:39], v[28:31], v[92:95], v[36:39]
    s_cmp_eq_u32 s35, 1
    s_cbranch_scc1 L_fq172
    s_cbranch_vccnz L_fr172
    s_waitcnt vmcnt(4)
L_fr172:
    s_waitcnt vmcnt(5)
L_fq172:
    s_waitcnt vmcnt(7)
    buffer_load_dwordx4 v[128:131], v4, s[12:15], s78 offen offset:3072 nt
    v_and_b32_dpp v28, v48, v24 row_newbcast:4 row_mask:0xf bank_mask:0xf
    v_and_b32_dpp v29, v48, v25 row_newbcast:4 row_mask:0xf bank_mask:0xf
    v_and_b32_dpp v30, v48, v26 row_newbcast:4 row_mask:0xf bank_mask:0xf
    v_and_b32_dpp v31, v48, v27 row_newbcast:4 row_mask:0xf bank_mask:0xf
    v_mfma_f32_16x16x32_bf16 v[36:39], v[32:35], v[96:99], v[36:39]
    s_memrealtime s[96:97]
    s_waitcnt lgkmcnt(0)
    s_sub_u32 s96, s96, s34
    s_cmp_gt_i32 s96, 3033
    s_cselect_b64 vcc, -1, 0
    s_cmp_gt_i32 s96, 3073
    s_cselect_b32 s35, 1, 0
    s_add_u32 s76, s76, 131072
    s_and_b32 s76, s76, 0x3fffff
    s_bfe_u32 s6, s76, 0x10011
    s_lshl_b32 s6, s6, 21
    s_xor_b32 s6, s6, s79
    s_and_b32 s5, s76, 0x1ffff
    s_xor_b32 s6, s6, s5
    s_lshr_b32 s5, s76, 18
    s_lshl_b32 s5, s5, 17
    s_xor_b32 s78, s6, s5
    s_cmp_eq_u32 s35, 1
    s_cbranch_scc1 L_fq173
    s_cbranch_vccnz L_fr173
    s_waitcnt vmcnt(4)
L_fr173:
    s_waitcnt vmcnt(5)
L_fq173:
    s_waitcnt vmcnt(7)
    buffer_load_dwordx4 v[132:135], v4, s[12:15], s78 offen offset:0 nt
    v_and_b32_dpp v32, v48, v24 row_newbcast:5 row_mask:0xf bank_mask:0xf
    v_and_b32_dpp v33, v48, v25 row_newbcast:5 row_mask:0xf bank_mask:0xf
    v_and_b32_dpp v34, v48, v26 row_newbcast:5 row_mask:0xf bank_mask:0xf
    v_and_b32_dpp v35, v48, v27 row_newbcast:5 row_mask:0xf bank_mask:0xf
    v_mfma_f32_16x16x32_bf16 v[36:39], v[28:31], v[100:103], v[36:39]
    s_cmp_eq_u32 s35, 1
    s_cbranch_scc1 L_fq174
    s_cbranch_vccnz L_fr174
    s_waitcnt vmcnt(4)
L_fr174:
    s_waitcnt vmcnt(5)
L_fq174:
    s_waitcnt vmcnt(7)
    buffer_load_dwordx4 v[136:139], v4, s[12:15], s78 offen offset:1024 nt
    v_and_b32_dpp v28, v48, v24 row_newbcast:6 row_mask:0xf bank_mask:0xf
    v_and_b32_dpp v29, v48, v25 row_newbcast:6 row_mask:0xf bank_mask:0xf
    v_and_b32_dpp v30, v48, v26 row_newbcast:6 row_mask:0xf bank_mask:0xf
    v_and_b32_dpp v31, v48, v27 row_newbcast:6 row_mask:0xf bank_mask:0xf
    v_mfma_f32_16x16x32_bf16 v[36:39], v[32:35], v[104:107], v[36:39]
    s_cmp_eq_u32 s35, 1
    s_cbranch_scc1 L_fq175
    s_cbranch_vccnz L_fr175
    s_waitcnt vmcnt(4)
L_fr175:
    s_waitcnt vmcnt(5)
L_fq175:
    s_waitcnt vmcnt(7)
    buffer_load_dwordx4 v[140:143], v4, s[12:15], s78 offen offset:2048 nt
    v_and_b32_dpp v32, v48, v24 row_newbcast:7 row_mask:0xf bank_mask:0xf
    v_and_b32_dpp v33, v48, v25 row_newbcast:7 row_mask:0xf bank_mask:0xf
    v_and_b32_dpp v34, v48, v26 row_newbcast:7 row_mask:0xf bank_mask:0xf
    v_and_b32_dpp v35, v48, v27 row_newbcast:7 row_mask:0xf bank_mask:0xf
    v_mfma_f32_16x16x32_bf16 v[36:39], v[28:31], v[108:111], v[36:39]
    s_cmp_eq_u32 s35, 1
    s_cbranch_scc1 L_fq176
    s_cbranch_vccnz L_fr176
    s_waitcnt vmcnt(4)
L_fr176:
    s_waitcnt vmcnt(5)
L_fq176:
    s_waitcnt vmcnt(7)
    buffer_load_dwordx4 v[144:147], v4, s[12:15], s78 offen offset:3072 nt
    v_and_b32_dpp v28, v48, v24 row_newbcast:8 row_mask:0xf bank_mask:0xf
    v_and_b32_dpp v29, v48, v25 row_newbcast:8 row_mask:0xf bank_mask:0xf
    v_and_b32_dpp v30, v48, v26 row_newbcast:8 row_mask:0xf bank_mask:0xf
    v_and_b32_dpp v31, v48, v27 row_newbcast:8 row_mask:0xf bank_mask:0xf
    v_mfma_f32_16x16x32_bf16 v[36:39], v[32:35], v[112:115], v[36:39]
    s_memrealtime s[96:97]
    s_waitcnt lgkmcnt(0)
    s_sub_u32 s96, s96, s34
    s_cmp_gt_i32 s96, 3083
    s_cselect_b64 vcc, -1, 0
    s_cmp_gt_i32 s96, 3123
    s_cselect_b32 s35, 1, 0
    s_add_u32 s76, s76, 131072
    s_and_b32 s76, s76, 0x3fffff
    s_bfe_u32 s6, s76, 0x10011
    s_lshl_b32 s6, s6, 21
    s_xor_b32 s6, s6, s79
    s_and_b32 s5, s76, 0x1ffff
    s_xor_b32 s6, s6, s5
    s_lshr_b32 s5, s76, 18
    s_lshl_b32 s5, s5, 17
    s_xor_b32 s78, s6, s5
    s_cmp_eq_u32 s35, 1
    s_cbranch_scc1 L_fq177
    s_cbranch_vccnz L_fr177
    s_waitcnt vmcnt(4)
L_fr177:
    s_waitcnt vmcnt(5)
L_fq177:
    s_waitcnt vmcnt(7)
    buffer_load_dwordx4 v[148:151], v4, s[12:15], s78 offen offset:0 nt
    v_and_b32_dpp v32, v48, v24 row_newbcast:9 row_mask:0xf bank_mask:0xf
    v_and_b32_dpp v33, v48, v25 row_newbcast:9 row_mask:0xf bank_mask:0xf
    v_and_b32_dpp v34, v48, v26 row_newbcast:9 row_mask:0xf bank_mask:0xf
    v_and_b32_dpp v35, v48, v27 row_newbcast:9 row_mask:0xf bank_mask:0xf
    v_mfma_f32_16x16x32_bf16 v[36:39], v[28:31], v[116:119], v[36:39]
    s_cmp_eq_u32 s35, 1
    s_cbranch_scc1 L_fq178
    s_cbranch_vccnz L_fr178
    s_waitcnt vmcnt(4)
L_fr178:
    s_waitcnt vmcnt(5)
L_fq178:
    s_waitcnt vmcnt(7)
    buffer_load_dwordx4 v[152:155], v4, s[12:15], s78 offen offset:1024 nt
    v_and_b32_dpp v28, v48, v24 row_newbcast:10 row_mask:0xf bank_mask:0xf
    v_and_b32_dpp v29, v48, v25 row_newbcast:10 row_mask:0xf bank_mask:0xf
    v_and_b32_dpp v30, v48, v26 row_newbcast:10 row_mask:0xf bank_mask:0xf
    v_and_b32_dpp v31, v48, v27 row_newbcast:10 row_mask:0xf bank_mask:0xf
    v_mfma_f32_16x16x32_bf16 v[36:39], v[32:35], v[120:123], v[36:39]
    s_cmp_eq_u32 s35, 1
    s_cbranch_scc1 L_fq179
    s_cbranch_vccnz L_fr179
    s_waitcnt vmcnt(4)
L_fr179:
    s_waitcnt vmcnt(5)
L_fq179:
    s_waitcnt vmcnt(7)
    buffer_load_dwordx4 v[156:159], v4, s[12:15], s78 offen offset:2048 nt
    v_and_b32_dpp v32, v48, v24 row_newbcast:11 row_mask:0xf bank_mask:0xf
    v_and_b32_dpp v33, v48, v25 row_newbcast:11 row_mask:0xf bank_mask:0xf
    v_and_b32_dpp v34, v48, v26 row_newbcast:11 row_mask:0xf bank_mask:0xf
    v_and_b32_dpp v35, v48, v27 row_newbcast:11 row_mask:0xf bank_mask:0xf
    v_mfma_f32_16x16x32_bf16 v[36:39], v[28:31], v[124:127], v[36:39]
    s_cmp_eq_u32 s35, 1
    s_cbranch_scc1 L_fq180
    s_cbranch_vccnz L_fr180
    s_waitcnt vmcnt(4)
L_fr180:
    s_waitcnt vmcnt(5)
L_fq180:
    s_waitcnt vmcnt(7)
    buffer_load_dwordx4 v[160:163], v4, s[12:15], s78 offen offset:3072 nt
    v_and_b32_dpp v28, v48, v24 row_newbcast:12 row_mask:0xf bank_mask:0xf
    v_and_b32_dpp v29, v48, v25 row_newbcast:12 row_mask:0xf bank_mask:0xf
    v_and_b32_dpp v30, v48, v26 row_newbcast:12 row_mask:0xf bank_mask:0xf
    v_and_b32_dpp v31, v48, v27 row_newbcast:12 row_mask:0xf bank_mask:0xf
    v_mfma_f32_16x16x32_bf16 v[36:39], v[32:35], v[128:131], v[36:39]
    s_memrealtime s[96:97]
    s_waitcnt lgkmcnt(0)
    s_sub_u32 s96, s96, s34
    s_cmp_gt_i32 s96, 3132
    s_cselect_b64 vcc, -1, 0
    s_cmp_gt_i32 s96, 3172
    s_cselect_b32 s35, 1, 0
    s_add_u32 s76, s76, 131072
    s_and_b32 s76, s76, 0x3fffff
    s_bfe_u32 s6, s76, 0x10011
    s_lshl_b32 s6, s6, 21
    s_xor_b32 s6, s6, s79
    s_and_b32 s5, s76, 0x1ffff
    s_xor_b32 s6, s6, s5
    s_lshr_b32 s5, s76, 18
    s_lshl_b32 s5, s5, 17
    s_xor_b32 s78, s6, s5
    s_cmp_eq_u32 s35, 1
    s_cbranch_scc1 L_fq181
    s_cbranch_vccnz L_fr181
    s_waitcnt vmcnt(4)
L_fr181:
    s_waitcnt vmcnt(5)
L_fq181:
    s_waitcnt vmcnt(7)
    buffer_load_dwordx4 v[164:167], v4, s[12:15], s78 offen offset:0 nt
    v_and_b32_dpp v32, v48, v24 row_newbcast:13 row_mask:0xf bank_mask:0xf
    v_and_b32_dpp v33, v48, v25 row_newbcast:13 row_mask:0xf bank_mask:0xf
    v_and_b32_dpp v34, v48, v26 row_newbcast:13 row_mask:0xf bank_mask:0xf
    v_and_b32_dpp v35, v48, v27 row_newbcast:13 row_mask:0xf bank_mask:0xf
    v_mfma_f32_16x16x32_bf16 v[36:39], v[28:31], v[132:135], v[36:39]
    s_cmp_eq_u32 s35, 1
    s_cbranch_scc1 L_fq182
    s_cbranch_vccnz L_fr182
    s_waitcnt vmcnt(4)
L_fr182:
    s_waitcnt vmcnt(5)
L_fq182:
    s_waitcnt vmcnt(7)
    buffer_load_dwordx4 v[168:171], v4, s[12:15], s78 offen offset:1024 nt
    v_and_b32_dpp v28, v48, v24 row_newbcast:14 row_mask:0xf bank_mask:0xf
    v_and_b32_dpp v29, v48, v25 row_newbcast:14 row_mask:0xf bank_mask:0xf
    v_and_b32_dpp v30, v48, v26 row_newbcast:14 row_mask:0xf bank_mask:0xf
    v_and_b32_dpp v31, v48, v27 row_newbcast:14 row_mask:0xf bank_mask:0xf
    v_mfma_f32_16x16x32_bf16 v[36:39], v[32:35], v[136:139], v[36:39]
    s_cmp_eq_u32 s35, 1
    s_cbranch_scc1 L_fq183
    s_cbranch_vccnz L_fr183
    s_waitcnt vmcnt(4)
L_fr183:
    s_waitcnt vmcnt(5)
L_fq183:
    s_waitcnt vmcnt(7)
    buffer_load_dwordx4 v[172:175], v4, s[12:15], s78 offen offset:2048 nt
    v_and_b32_dpp v32, v48, v24 row_newbcast:15 row_mask:0xf bank_mask:0xf
    v_and_b32_dpp v33, v48, v25 row_newbcast:15 row_mask:0xf bank_mask:0xf
    v_and_b32_dpp v34, v48, v26 row_newbcast:15 row_mask:0xf bank_mask:0xf
    v_and_b32_dpp v35, v48, v27 row_newbcast:15 row_mask:0xf bank_mask:0xf
    v_mfma_f32_16x16x32_bf16 v[36:39], v[28:31], v[140:143], v[36:39]
    s_cmp_eq_u32 s35, 1
    s_cbranch_scc1 L_fq184
    s_cbranch_vccnz L_fr184
    s_waitcnt vmcnt(4)
L_fr184:
    s_waitcnt vmcnt(5)
L_fq184:
    s_waitcnt vmcnt(7)
    buffer_load_dwordx4 v[176:179], v4, s[12:15], s78 offen offset:3072 nt
    v_and_b32_dpp v28, v49, v24 row_newbcast:0 row_mask:0xf bank_mask:0xf
    v_and_b32_dpp v29, v49, v25 row_newbcast:0 row_mask:0xf bank_mask:0xf
    v_and_b32_dpp v30, v49, v26 row_newbcast:0 row_mask:0xf bank_mask:0xf
    v_and_b32_dpp v31, v49, v27 row_newbcast:0 row_mask:0xf bank_mask:0xf
    v_mfma_f32_16x16x32_bf16 v[36:39], v[32:35], v[144:147], v[36:39]
    s_memrealtime s[96:97]
    s_waitcnt lgkmcnt(0)
    s_sub_u32 s96, s96, s34
    s_cmp_gt_i32 s96, 3182
    s_cselect_b64 vcc, -1, 0
    s_cmp_gt_i32 s96, 3222
    s_cselect_b32 s35, 1, 0
    s_add_u32 s76, s76, 131072
    s_and_b32 s76, s76, 0x3fffff
    s_bfe_u32 s6, s76, 0x10011
    s_lshl_b32 s6, s6, 21
    s_xor_b32 s6, s6, s79
    s_and_b32 s5, s76, 0x1ffff
    s_xor_b32 s6, s6, s5
    s_lshr_b32 s5, s76, 18
    s_lshl_b32 s5, s5, 17
    s_xor_b32 s78, s6, s5
    s_cmp_eq_u32 s35, 1
    s_cbranch_scc1 L_fq185
    s_cbranch_vccnz L_fr185
    s_waitcnt vmcnt(4)
L_fr185:
    s_waitcnt vmcnt(5)
L_fq185:
    s_waitcnt vmcnt(7)
    buffer_load_dwordx4 v[180:183], v4, s[12:15], s78 offen offset:0 nt
    ds_read_b32 v13, v20 offset:284
    s_waitcnt lgkmcnt(0)
    v_readfirstlane_b32 s30, v13
    s_cmp_gt_i32 s30, 0
    s_cselect_b32 s30, 0x2000, 0
    v_and_b32_dpp v32, v49, v24 row_newbcast:1 row_mask:0xf bank_mask:0xf
    v_and_b32_dpp v33, v49, v25 row_newbcast:1 row_mask:0xf bank_mask:0xf
    v_and_b32_dpp v34, v49, v26 row_newbcast:1 row_mask:0xf bank_mask:0xf
    v_and_b32_dpp v35, v49, v27 row_newbcast:1 row_mask:0xf bank_mask:0xf
    v_mfma_f32_16x16x32_bf16 v[36:39], v[28:31], v[148:151], v[36:39]
    s_cmp_eq_u32 s35, 1
    s_cbranch_scc1 L_fq186
    s_cbranch_vccnz L_fr186
    s_waitcnt vmcnt(4)
L_fr186:
    s_waitcnt vmcnt(5)
L_fq186:
    s_waitcnt vmcnt(7)
    buffer_load_dwordx4 v[184:187], v4, s[12:15], s78 offen offset:1024 nt
    v_and_b32_dpp v28, v49, v24 row_newbcast:2 row_mask:0xf bank_mask:0xf
    v_and_b32_dpp v29, v49, v25 row_newbcast:2 row_mask:0xf bank_mask:0xf
    v_and_b32_dpp v30, v49, v26 row_newbcast:2 row_mask:0xf bank_mask:0xf
    v_and_b32_dpp v31, v49, v27 row_newbcast:2 row_mask:0xf bank_mask:0xf
    v_mfma_f32_16x16x32_bf16 v[36:39], v[32:35], v[152:155], v[36:39]
    s_cmp_eq_u32 s35, 1
    s_cbranch_scc1 L_fq187
    s_cbranch_vccnz L_fr187
    s_waitcnt vmcnt(4)
L_fr187:
    s_waitcnt vmcnt(5)
L_fq187:
    s_waitcnt vmcnt(7)
    buffer_load_dwordx4 v[188:191], v4, s[12:15], s78 offen offset:2048 nt
    v_and_b32_dpp v32, v49, v24 row_newbcast:3 row_mask:0xf bank_mask:0xf
    v_and_b32_dpp v33, v49, v25 row_newbcast:3 row_mask:0xf bank_mask:0xf
    v_and_b32_dpp v34, v49, v26 row_newbcast:3 row_mask:0xf bank_mask:0xf
    v_and_b32_dpp v35, v49, v27 row_newbcast:3 row_mask:0xf bank_mask:0xf
    v_mfma_f32_16x16x32_bf16 v[36:39], v[28:31], v[156:159], v[36:39]
    s_cmp_eq_u32 s35, 1
    s_cbranch_scc1 L_fq188
    s_cbranch_vccnz L_fr188
    s_waitcnt vmcnt(4)
L_fr188:
    s_waitcnt vmcnt(5)
L_fq188:
    s_waitcnt vmcnt(7)
    buffer_load_dwordx4 v[192:195], v4, s[12:15], s78 offen offset:3072 nt
    v_and_b32_dpp v28, v49, v24 row_newbcast:4 row_mask:0xf bank_mask:0xf
    v_and_b32_dpp v29, v49, v25 row_newbcast:4 row_mask:0xf bank_mask:0xf
    v_and_b32_dpp v30, v49, v26 row_newbcast:4 row_mask:0xf bank_mask:0xf
    v_and_b32_dpp v31, v49, v27 row_newbcast:4 row_mask:0xf bank_mask:0xf
    v_mfma_f32_16x16x32_bf16 v[36:39], v[32:35], v[160:163], v[36:39]
    s_memrealtime s[96:97]
    s_waitcnt lgkmcnt(0)
    s_sub_u32 s96, s96, s34
    s_cmp_gt_i32 s96, 3232
    s_cselect_b64 vcc, -1, 0
    s_cmp_gt_i32 s96, 3272
    s_cselect_b32 s35, 1, 0
    s_add_u32 s76, s76, 131072
    s_and_b32 s76, s76, 0x3fffff
    s_bfe_u32 s6, s76, 0x10011
    s_lshl_b32 s6, s6, 21
    s_xor_b32 s6, s6, s79
    s_and_b32 s5, s76, 0x1ffff
    s_xor_b32 s6, s6, s5
    s_lshr_b32 s5, s76, 18
    s_lshl_b32 s5, s5, 17
    s_xor_b32 s78, s6, s5
    s_cmp_eq_u32 s35, 1
    s_cbranch_scc1 L_fq189
    s_cbranch_vccnz L_fr189
    s_waitcnt vmcnt(4)
L_fr189:
    s_waitcnt vmcnt(5)
L_fq189:
    s_waitcnt vmcnt(7)
    buffer_load_dwordx4 v[196:199], v4, s[12:15], s78 offen offset:0 nt
    v_and_b32_dpp v32, v49, v24 row_newbcast:5 row_mask:0xf bank_mask:0xf
    v_and_b32_dpp v33, v49, v25 row_newbcast:5 row_mask:0xf bank_mask:0xf
    v_and_b32_dpp v34, v49, v26 row_newbcast:5 row_mask:0xf bank_mask:0xf
    v_and_b32_dpp v35, v49, v27 row_newbcast:5 row_mask:0xf bank_mask:0xf
    v_mfma_f32_16x16x32_bf16 v[36:39], v[28:31], v[164:167], v[36:39]
    s_cmp_eq_u32 s35, 1
    s_cbranch_scc1 L_fq190
    s_cbranch_vccnz L_fr190
    s_waitcnt vmcnt(4)
L_fr190:
    s_waitcnt vmcnt(5)
L_fq190:
    s_waitcnt vmcnt(7)
    buffer_load_dwordx4 v[200:203], v4, s[12:15], s78 offen offset:1024 nt
    v_and_b32_dpp v28, v49, v24 row_newbcast:6 row_mask:0xf bank_mask:0xf
    v_and_b32_dpp v29, v49, v25 row_newbcast:6 row_mask:0xf bank_mask:0xf
    v_and_b32_dpp v30, v49, v26 row_newbcast:6 row_mask:0xf bank_mask:0xf
    v_and_b32_dpp v31, v49, v27 row_newbcast:6 row_mask:0xf bank_mask:0xf
    v_mfma_f32_16x16x32_bf16 v[36:39], v[32:35], v[168:171], v[36:39]
    s_cmp_eq_u32 s35, 1
    s_cbranch_scc1 L_fq191
    s_cbranch_vccnz L_fr191
    s_waitcnt vmcnt(4)
L_fr191:
    s_waitcnt vmcnt(5)
L_fq191:
    s_waitcnt vmcnt(7)
    buffer_load_dwordx4 v[204:207], v4, s[12:15], s78 offen offset:2048 nt
    v_and_b32_dpp v32, v49, v24 row_newbcast:7 row_mask:0xf bank_mask:0xf
    v_and_b32_dpp v33, v49, v25 row_newbcast:7 row_mask:0xf bank_mask:0xf
    v_and_b32_dpp v34, v49, v26 row_newbcast:7 row_mask:0xf bank_mask:0xf
    v_and_b32_dpp v35, v49, v27 row_newbcast:7 row_mask:0xf bank_mask:0xf
    v_mfma_f32_16x16x32_bf16 v[36:39], v[28:31], v[172:175], v[36:39]
    s_cmp_eq_u32 s35, 1
    s_cbranch_scc1 L_fq192
    s_cbranch_vccnz L_fr192
    s_waitcnt vmcnt(4)
L_fr192:
    s_waitcnt vmcnt(5)
L_fq192:
    s_waitcnt vmcnt(7)
    buffer_load_dwordx4 v[208:211], v4, s[12:15], s78 offen offset:3072 nt
    v_and_b32_dpp v28, v49, v24 row_newbcast:8 row_mask:0xf bank_mask:0xf
    v_and_b32_dpp v29, v49, v25 row_newbcast:8 row_mask:0xf bank_mask:0xf
    v_and_b32_dpp v30, v49, v26 row_newbcast:8 row_mask:0xf bank_mask:0xf
    v_and_b32_dpp v31, v49, v27 row_newbcast:8 row_mask:0xf bank_mask:0xf
    v_mfma_f32_16x16x32_bf16 v[36:39], v[32:35], v[176:179], v[36:39]
    s_memrealtime s[96:97]
    s_waitcnt lgkmcnt(0)
    s_sub_u32 s96, s96, s34
    s_cmp_gt_i32 s96, 3281
    s_cselect_b64 vcc, -1, 0
    s_cmp_gt_i32 s96, 3321
    s_cselect_b32 s35, 1, 0
    s_add_u32 s76, s76, 131072
    s_and_b32 s76, s76, 0x3fffff
    s_bfe_u32 s6, s76, 0x10011
    s_lshl_b32 s6, s6, 21
    s_xor_b32 s6, s6, s79
    s_and_b32 s5, s76, 0x1ffff
    s_xor_b32 s6, s6, s5
    s_lshr_b32 s5, s76, 18
    s_lshl_b32 s5, s5, 17
    s_xor_b32 s78, s6, s5
    s_cmp_eq_u32 s35, 1
    s_cbranch_scc1 L_fq193
    s_cbranch_vccnz L_fr193
    s_waitcnt vmcnt(4)
L_fr193:
    s_waitcnt vmcnt(5)
L_fq193:
    s_waitcnt vmcnt(7)
    buffer_load_dwordx4 v[84:87], v4, s[12:15], s78 offen offset:0 nt
    v_and_b32_dpp v32, v49, v24 row_newbcast:9 row_mask:0xf bank_mask:0xf
    v_and_b32_dpp v33, v49, v25 row_newbcast:9 row_mask:0xf bank_mask:0xf
    v_and_b32_dpp v34, v49, v26 row_newbcast:9 row_mask:0xf bank_mask:0xf
    v_and_b32_dpp v35, v49, v27 row_newbcast:9 row_mask:0xf bank_mask:0xf
    v_mfma_f32_16x16x32_bf16 v[36:39], v[28:31], v[180:183], v[36:39]
    s_cmp_eq_u32 s35, 1
    s_cbranch_scc1 L_fq194
    s_cbranch_vccnz L_fr194
    s_waitcnt vmcnt(4)
L_fr194:
    s_waitcnt vmcnt(5)
L_fq194:
    s_waitcnt vmcnt(7)
    buffer_load_dwordx4 v[88:91], v4, s[12:15], s78 offen offset:1024 nt
    v_and_b32_dpp v28, v49, v24 row_newbcast:10 row_mask:0xf bank_mask:0xf
    v_and_b32_dpp v29, v49, v25 row_newbcast:10 row_mask:0xf bank_mask:0xf
    v_and_b32_dpp v30, v49, v26 row_newbcast:10 row_mask:0xf bank_mask:0xf
    v_and_b32_dpp v31, v49, v27 row_newbcast:10 row_mask:0xf bank_mask:0xf
    v_mfma_f32_16x16x32_bf16 v[36:39], v[32:35], v[184:187], v[36:39]
    s_cmp_eq_u32 s35, 1
    s_cbranch_scc1 L_fq195
    s_cbranch_vccnz L_fr195
    s_waitcnt vmcnt(4)
L_fr195:
    s_waitcnt vmcnt(5)
L_fq195:
    s_waitcnt vmcnt(7)
    buffer_load_dwordx4 v[92:95], v4, s[12:15], s78 offen offset:2048 nt
    v_and_b32_dpp v32, v49, v24 row_newbcast:11 row_mask:0xf bank_mask:0xf
    v_and_b32_dpp v33, v49, v25 row_newbcast:11 row_mask:0xf bank_mask:0xf
    v_and_b32_dpp v34, v49, v26 row_newbcast:11 row_mask:0xf bank_mask:0xf
    v_and_b32_dpp v35, v49, v27 row_newbcast:11 row_mask:0xf bank_mask:0xf
    v_mfma_f32_16x16x32_bf16 v[36:39], v[28:31], v[188:191], v[36:39]
    s_cmp_eq_u32 s35, 1
    s_cbranch_scc1 L_fq196
    s_cbranch_vccnz L_fr196
    s_waitcnt vmcnt(4)
L_fr196:
    s_waitcnt vmcnt(5)
L_fq196:
    s_waitcnt vmcnt(7)
    buffer_load_dwordx4 v[96:99], v4, s[12:15], s78 offen offset:3072 nt
    v_and_b32_dpp v28, v49, v24 row_newbcast:12 row_mask:0xf bank_mask:0xf
    v_and_b32_dpp v29, v49, v25 row_newbcast:12 row_mask:0xf bank_mask:0xf
    v_and_b32_dpp v30, v49, v26 row_newbcast:12 row_mask:0xf bank_mask:0xf
    v_and_b32_dpp v31, v49, v27 row_newbcast:12 row_mask:0xf bank_mask:0xf
    v_mfma_f32_16x16x32_bf16 v[36:39], v[32:35], v[192:195], v[36:39]
    s_memrealtime s[96:97]
    s_waitcnt lgkmcnt(0)
    s_sub_u32 s96, s96, s34
    s_cmp_gt_i32 s96, 3331
    s_cselect_b64 vcc, -1, 0
    s_cmp_gt_i32 s96, 3371
    s_cselect_b32 s35, 1, 0
    s_add_u32 s76, s76, 131072
    s_and_b32 s76, s76, 0x3fffff
    s_bfe_u32 s6, s76, 0x10011
    s_lshl_b32 s6, s6, 21
    s_xor_b32 s6, s6, s79
    s_and_b32 s5, s76, 0x1ffff
    s_xor_b32 s6, s6, s5
    s_lshr_b32 s5, s76, 18
    s_lshl_b32 s5, s5, 17
    s_xor_b32 s78, s6, s5
    s_cmp_eq_u32 s35, 1
    s_cbranch_scc1 L_fq197
    s_cbranch_vccnz L_fr197
    s_waitcnt vmcnt(4)
L_fr197:
    s_waitcnt vmcnt(5)
L_fq197:
    s_waitcnt vmcnt(7)
    buffer_load_dwordx4 v[100:103], v4, s[12:15], s78 offen offset:0 nt
    v_and_b32_dpp v32, v49, v24 row_newbcast:13 row_mask:0xf bank_mask:0xf
    v_and_b32_dpp v33, v49, v25 row_newbcast:13 row_mask:0xf bank_mask:0xf
    v_and_b32_dpp v34, v49, v26 row_newbcast:13 row_mask:0xf bank_mask:0xf
    v_and_b32_dpp v35, v49, v27 row_newbcast:13 row_mask:0xf bank_mask:0xf
    v_mfma_f32_16x16x32_bf16 v[36:39], v[28:31], v[196:199], v[36:39]
    s_cmp_eq_u32 s35, 1
    s_cbranch_scc1 L_fq198
    s_cbranch_vccnz L_fr198
    s_waitcnt vmcnt(4)
L_fr198:
    s_waitcnt vmcnt(5)
L_fq198:
    s_waitcnt vmcnt(7)
    buffer_load_dwordx4 v[104:107], v4, s[12:15], s78 offen offset:1024 nt
    v_and_b32_dpp v28, v49, v24 row_newbcast:14 row_mask:0xf bank_mask:0xf
    v_and_b32_dpp v29, v49, v25 row_newbcast:14 row_mask:0xf bank_mask:0xf
    v_and_b32_dpp v30, v49, v26 row_newbcast:14 row_mask:0xf bank_mask:0xf
    v_and_b32_dpp v31, v49, v27 row_newbcast:14 row_mask:0xf bank_mask:0xf
    v_mfma_f32_16x16x32_bf16 v[36:39], v[32:35], v[200:203], v[36:39]
    s_cmp_eq_u32 s35, 1
    s_cbranch_scc1 L_fq199
    s_cbranch_vccnz L_fr199
    s_waitcnt vmcnt(4)
L_fr199:
    s_waitcnt vmcnt(5)
L_fq199:
    s_waitcnt vmcnt(7)
    buffer_load_dwordx4 v[108:111], v4, s[12:15], s78 offen offset:2048 nt
    v_and_b32_dpp v32, v49, v24 row_newbcast:15 row_mask:0xf bank_mask:0xf
    v_and_b32_dpp v33, v49, v25 row_newbcast:15 row_mask:0xf bank_mask:0xf
    v_and_b32_dpp v34, v49, v26 row_newbcast:15 row_mask:0xf bank_mask:0xf
    v_and_b32_dpp v35, v49, v27 row_newbcast:15 row_mask:0xf bank_mask:0xf
    v_mfma_f32_16x16x32_bf16 v[36:39], v[28:31], v[204:207], v[36:39]
    s_cmp_eq_u32 s35, 1
    s_cbranch_scc1 L_fq200
    s_cbranch_vccnz L_fr200
    s_waitcnt vmcnt(4)
L_fr200:
    s_waitcnt vmcnt(5)
L_fq200:
    s_waitcnt vmcnt(7)
    buffer_load_dwordx4 v[112:115], v4, s[12:15], s78 offen offset:3072 nt
    v_and_b32_dpp v28, v50, v24 row_newbcast:0 row_mask:0xf bank_mask:0xf
    v_and_b32_dpp v29, v50, v25 row_newbcast:0 row_mask:0xf bank_mask:0xf
    v_and_b32_dpp v30, v50, v26 row_newbcast:0 row_mask:0xf bank_mask:0xf
    v_and_b32_dpp v31, v50, v27 row_newbcast:0 row_mask:0xf bank_mask:0xf
    v_mfma_f32_16x16x32_bf16 v[36:39], v[32:35], v[208:211], v[36:39]
    s_memrealtime s[96:97]
    s_waitcnt lgkmcnt(0)
    s_sub_u32 s96, s96, s34
    s_cmp_gt_i32 s96, 3380
    s_cselect_b64 vcc, -1, 0
    s_cmp_gt_i32 s96, 3420
    s_cselect_b32 s35, 1, 0
    s_add_u32 s76, s76, 131072
    s_and_b32 s76, s76, 0x3fffff
    s_bfe_u32 s6, s76, 0x10011
    s_lshl_b32 s6, s6, 21
    s_xor_b32 s6, s6, s79
    s_and_b32 s5, s76, 0x1ffff
    s_xor_b32 s6, s6, s5
    s_lshr_b32 s5, s76, 18
    s_lshl_b32 s5, s5, 17
    s_xor_b32 s78, s6, s5
    s_cmp_eq_u32 s35, 1
    s_cbranch_scc1 L_fq201
    s_cbranch_vccnz L_fr201
    s_waitcnt vmcnt(4)
L_fr201:
    s_waitcnt vmcnt(5)
L_fq201:
    s_waitcnt vmcnt(7)
    buffer_load_dwordx4 v[116:119], v4, s[12:15], s78 offen offset:0 nt
    v_and_b32_dpp v32, v50, v24 row_newbcast:1 row_mask:0xf bank_mask:0xf
    v_and_b32_dpp v33, v50, v25 row_newbcast:1 row_mask:0xf bank_mask:0xf
    v_and_b32_dpp v34, v50, v26 row_newbcast:1 row_mask:0xf bank_mask:0xf
    v_and_b32_dpp v35, v50, v27 row_newbcast:1 row_mask:0xf bank_mask:0xf
    v_mfma_f32_16x16x32_bf16 v[36:39], v[28:31], v[84:87], v[36:39]
    s_cmp_eq_u32 s35, 1
    s_cbranch_scc1 L_fq202
    s_cbranch_vccnz L_fr202
    s_waitcnt vmcnt(4)
L_fr202:
    s_waitcnt vmcnt(5)
L_fq202:
    s_waitcnt vmcnt(7)
    buffer_load_dwordx4 v[120:123], v4, s[12:15], s78 offen offset:1024 nt
    v_and_b32_dpp v28, v50, v24 row_newbcast:2 row_mask:0xf bank_mask:0xf
    v_and_b32_dpp v29, v50, v25 row_newbcast:2 row_mask:0xf bank_mask:0xf
    v_and_b32_dpp v30, v50, v26 row_newbcast:2 row_mask:0xf bank_mask:0xf
    v_and_b32_dpp v31, v50, v27 row_newbcast:2 row_mask:0xf bank_mask:0xf
    v_mfma_f32_16x16x32_bf16 v[36:39], v[32:35], v[88:91], v[36:39]
    s_cmp_eq_u32 s35, 1
    s_cbranch_scc1 L_fq203
    s_cbranch_vccnz L_fr203
    s_waitcnt vmcnt(4)
L_fr203:
    s_waitcnt vmcnt(5)
L_fq203:
    s_waitcnt vmcnt(7)
    buffer_load_dwordx4 v[124:127], v4, s[12:15], s78 offen offset:2048 nt
    v_and_b32_dpp v32, v50, v24 row_newbcast:3 row_mask:0xf bank_mask:0xf
    v_and_b32_dpp v33, v50, v25 row_newbcast:3 row_mask:0xf bank_mask:0xf
    v_and_b32_dpp v34, v50, v26 row_newbcast:3 row_mask:0xf bank_mask:0xf
    v_and_b32_dpp v35, v50, v27 row_newbcast:3 row_mask:0xf bank_mask:0xf
    v_mfma_f32_16x16x32_bf16 v[36:39], v[28:31], v[92:95], v[36:39]
    s_cmp_eq_u32 s35, 1
    s_cbranch_scc1 L_fq204
    s_cbranch_vccnz L_fr204
    s_waitcnt vmcnt(4)
L_fr204:
    s_waitcnt vmcnt(5)
L_fq204:
    s_waitcnt vmcnt(7)
    buffer_load_dwordx4 v[128:131], v4, s[12:15], s78 offen offset:3072 nt
    v_and_b32_dpp v28, v50, v24 row_newbcast:4 row_mask:0xf bank_mask:0xf
    v_and_b32_dpp v29, v50, v25 row_newbcast:4 row_mask:0xf bank_mask:0xf
    v_and_b32_dpp v30, v50, v26 row_newbcast:4 row_mask:0xf bank_mask:0xf
    v_and_b32_dpp v31, v50, v27 row_newbcast:4 row_mask:0xf bank_mask:0xf
    v_mfma_f32_16x16x32_bf16 v[36:39], v[32:35], v[96:99], v[36:39]
    s_memrealtime s[96:97]
    s_waitcnt lgkmcnt(0)
    s_sub_u32 s96, s96, s34
    s_cmp_gt_i32 s96, 3430
    s_cselect_b64 vcc, -1, 0
    s_cmp_gt_i32 s96, 3470
    s_cselect_b32 s35, 1, 0
    s_add_u32 s76, s76, 131072
    s_and_b32 s76, s76, 0x3fffff
    s_bfe_u32 s6, s76, 0x10011
    s_lshl_b32 s6, s6, 21
    s_xor_b32 s6, s6, s79
    s_and_b32 s5, s76, 0x1ffff
    s_xor_b32 s6, s6, s5
    s_lshr_b32 s5, s76, 18
    s_lshl_b32 s5, s5, 17
    s_xor_b32 s78, s6, s5
    s_cmp_eq_u32 s35, 1
    s_cbranch_scc1 L_fq205
    s_cbranch_vccnz L_fr205
    s_waitcnt vmcnt(4)
L_fr205:
    s_waitcnt vmcnt(5)
L_fq205:
    s_waitcnt vmcnt(7)
    buffer_load_dwordx4 v[132:135], v4, s[12:15], s78 offen offset:0 nt
    v_and_b32_dpp v32, v50, v24 row_newbcast:5 row_mask:0xf bank_mask:0xf
    v_and_b32_dpp v33, v50, v25 row_newbcast:5 row_mask:0xf bank_mask:0xf
    v_and_b32_dpp v34, v50, v26 row_newbcast:5 row_mask:0xf bank_mask:0xf
    v_and_b32_dpp v35, v50, v27 row_newbcast:5 row_mask:0xf bank_mask:0xf
    v_mfma_f32_16x16x32_bf16 v[36:39], v[28:31], v[100:103], v[36:39]
    s_cmp_eq_u32 s35, 1
    s_cbranch_scc1 L_fq206
    s_cbranch_vccnz L_fr206
    s_waitcnt vmcnt(4)
L_fr206:
    s_waitcnt vmcnt(5)
L_fq206:
    s_waitcnt vmcnt(7)
    buffer_load_dwordx4 v[136:139], v4, s[12:15], s78 offen offset:1024 nt
    v_and_b32_dpp v28, v50, v24 row_newbcast:6 row_mask:0xf bank_mask:0xf
    v_and_b32_dpp v29, v50, v25 row_newbcast:6 row_mask:0xf bank_mask:0xf
    v_and_b32_dpp v30, v50, v26 row_newbcast:6 row_mask:0xf bank_mask:0xf
    v_and_b32_dpp v31, v50, v27 row_newbcast:6 row_mask:0xf bank_mask:0xf
    v_mfma_f32_16x16x32_bf16 v[36:39], v[32:35], v[104:107], v[36:39]
    s_cmp_eq_u32 s35, 1
    s_cbranch_scc1 L_fq207
    s_cbranch_vccnz L_fr207
    s_waitcnt vmcnt(4)
L_fr207:
    s_waitcnt vmcnt(5)
L_fq207:
    s_waitcnt vmcnt(7)
    buffer_load_dwordx4 v[140:143], v4, s[12:15], s78 offen offset:2048 nt
    v_and_b32_dpp v32, v50, v24 row_newbcast:7 row_mask:0xf bank_mask:0xf
    v_and_b32_dpp v33, v50, v25 row_newbcast:7 row_mask:0xf bank_mask:0xf
    v_and_b32_dpp v34, v50, v26 row_newbcast:7 row_mask:0xf bank_mask:0xf
    v_and_b32_dpp v35, v50, v27 row_newbcast:7 row_mask:0xf bank_mask:0xf
    v_mfma_f32_16x16x32_bf16 v[36:39], v[28:31], v[108:111], v[36:39]
    s_cmp_eq_u32 s35, 1
    s_cbranch_scc1 L_fq208
    s_cbranch_vccnz L_fr208
    s_waitcnt vmcnt(4)
L_fr208:
    s_waitcnt vmcnt(5)
L_fq208:
    s_waitcnt vmcnt(7)
    buffer_load_dwordx4 v[144:147], v4, s[12:15], s78 offen offset:3072 nt
    v_and_b32_dpp v28, v50, v24 row_newbcast:8 row_mask:0xf bank_mask:0xf
    v_and_b32_dpp v29, v50, v25 row_newbcast:8 row_mask:0xf bank_mask:0xf
    v_and_b32_dpp v30, v50, v26 row_newbcast:8 row_mask:0xf bank_mask:0xf
    v_and_b32_dpp v31, v50, v27 row_newbcast:8 row_mask:0xf bank_mask:0xf
    v_mfma_f32_16x16x32_bf16 v[36:39], v[32:35], v[112:115], v[36:39]
    s_memrealtime s[96:97]
    s_waitcnt lgkmcnt(0)
    s_sub_u32 s96, s96, s34
    s_cmp_gt_i32 s96, 3480
    s_cselect_b64 vcc, -1, 0
    s_cmp_gt_i32 s96, 3520
    s_cselect_b32 s35, 1, 0
    s_add_u32 s76, s76, 131072
    s_and_b32 s76, s76, 0x3fffff
    s_bfe_u32 s6, s76, 0x10011
    s_lshl_b32 s6, s6, 21
    s_xor_b32 s6, s6, s79
    s_and_b32 s5, s76, 0x1ffff
    s_xor_b32 s6, s6, s5
    s_lshr_b32 s5, s76, 18
    s_lshl_b32 s5, s5, 17
    s_xor_b32 s78, s6, s5
    s_cmp_eq_u32 s35, 1
    s_cbranch_scc1 L_fq209
    s_cbranch_vccnz L_fr209
    s_waitcnt vmcnt(4)
L_fr209:
    s_waitcnt vmcnt(5)
L_fq209:
    s_waitcnt vmcnt(7)
    buffer_load_dwordx4 v[148:151], v4, s[12:15], s78 offen offset:0 nt
    v_and_b32_dpp v32, v50, v24 row_newbcast:9 row_mask:0xf bank_mask:0xf
    v_and_b32_dpp v33, v50, v25 row_newbcast:9 row_mask:0xf bank_mask:0xf
    v_and_b32_dpp v34, v50, v26 row_newbcast:9 row_mask:0xf bank_mask:0xf
    v_and_b32_dpp v35, v50, v27 row_newbcast:9 row_mask:0xf bank_mask:0xf
    v_mfma_f32_16x16x32_bf16 v[36:39], v[28:31], v[116:119], v[36:39]
    s_cmp_eq_u32 s35, 1
    s_cbranch_scc1 L_fq210
    s_cbranch_vccnz L_fr210
    s_waitcnt vmcnt(4)
L_fr210:
    s_waitcnt vmcnt(5)
L_fq210:
    s_waitcnt vmcnt(7)
    buffer_load_dwordx4 v[152:155], v4, s[12:15], s78 offen offset:1024 nt
    v_and_b32_dpp v28, v50, v24 row_newbcast:10 row_mask:0xf bank_mask:0xf
    v_and_b32_dpp v29, v50, v25 row_newbcast:10 row_mask:0xf bank_mask:0xf
    v_and_b32_dpp v30, v50, v26 row_newbcast:10 row_mask:0xf bank_mask:0xf
    v_and_b32_dpp v31, v50, v27 row_newbcast:10 row_mask:0xf bank_mask:0xf
    v_mfma_f32_16x16x32_bf16 v[36:39], v[32:35], v[120:123], v[36:39]
    s_cmp_eq_u32 s35, 1
    s_cbranch_scc1 L_fq211
    s_cbranch_vccnz L_fr211
    s_waitcnt vmcnt(4)
L_fr211:
    s_waitcnt vmcnt(5)
L_fq211:
    s_waitcnt vmcnt(7)
    buffer_load_dwordx4 v[156:159], v4, s[12:15], s78 offen offset:2048 nt
    v_and_b32_dpp v32, v50, v24 row_newbcast:11 row_mask:0xf bank_mask:0xf
    v_and_b32_dpp v33, v50, v25 row_newbcast:11 row_mask:0xf bank_mask:0xf
    v_and_b32_dpp v34, v50, v26 row_newbcast:11 row_mask:0xf bank_mask:0xf
    v_and_b32_dpp v35, v50, v27 row_newbcast:11 row_mask:0xf bank_mask:0xf
    v_mfma_f32_16x16x32_bf16 v[36:39], v[28:31], v[124:127], v[36:39]
    s_cmp_eq_u32 s35, 1
    s_cbranch_scc1 L_fq212
    s_cbranch_vccnz L_fr212
    s_waitcnt vmcnt(4)
L_fr212:
    s_waitcnt vmcnt(5)
L_fq212:
    s_waitcnt vmcnt(7)
    buffer_load_dwordx4 v[160:163], v4, s[12:15], s78 offen offset:3072 nt
    v_and_b32_dpp v28, v50, v24 row_newbcast:12 row_mask:0xf bank_mask:0xf
    v_and_b32_dpp v29, v50, v25 row_newbcast:12 row_mask:0xf bank_mask:0xf
    v_and_b32_dpp v30, v50, v26 row_newbcast:12 row_mask:0xf bank_mask:0xf
    v_and_b32_dpp v31, v50, v27 row_newbcast:12 row_mask:0xf bank_mask:0xf
    v_mfma_f32_16x16x32_bf16 v[36:39], v[32:35], v[128:131], v[36:39]
    s_memrealtime s[96:97]
    s_waitcnt lgkmcnt(0)
    s_sub_u32 s96, s96, s34
    s_cmp_gt_i32 s96, 3536
    s_cselect_b64 vcc, -1, 0
    s_cmp_gt_i32 s96, 3576
    s_cselect_b32 s35, 1, 0
    s_add_u32 s76, s76, 131072
    s_and_b32 s76, s76, 0x3fffff
    s_bfe_u32 s6, s76, 0x10011
    s_lshl_b32 s6, s6, 21
    s_xor_b32 s6, s6, s79
    s_and_b32 s5, s76, 0x1ffff
    s_xor_b32 s6, s6, s5
    s_lshr_b32 s5, s76, 18
    s_lshl_b32 s5, s5, 17
    s_xor_b32 s78, s6, s5
    s_cmp_eq_u32 s35, 1
    s_cbranch_scc1 L_fq213
    s_cbranch_vccnz L_fr213
    s_waitcnt vmcnt(4)
L_fr213:
    s_waitcnt vmcnt(5)
L_fq213:
    s_waitcnt vmcnt(7)
    buffer_load_dwordx4 v[164:167], v4, s[12:15], s78 offen offset:0 nt
    v_and_b32_dpp v32, v50, v24 row_newbcast:13 row_mask:0xf bank_mask:0xf
    v_and_b32_dpp v33, v50, v25 row_newbcast:13 row_mask:0xf bank_mask:0xf
    v_and_b32_dpp v34, v50, v26 row_newbcast:13 row_mask:0xf bank_mask:0xf
    v_and_b32_dpp v35, v50, v27 row_newbcast:13 row_mask:0xf bank_mask:0xf
    v_mfma_f32_16x16x32_bf16 v[36:39], v[28:31], v[132:135], v[36:39]
    s_cmp_eq_u32 s35, 1
    s_cbranch_scc1 L_fq214
    s_cbranch_vccnz L_fr214
    s_waitcnt vmcnt(4)
L_fr214:
    s_waitcnt vmcnt(5)
L_fq214:
    s_waitcnt vmcnt(7)
    buffer_load_dwordx4 v[168:171], v4, s[12:15], s78 offen offset:1024 nt
    v_and_b32_dpp v28, v50, v24 row_newbcast:14 row_mask:0xf bank_mask:0xf
    v_and_b32_dpp v29, v50, v25 row_newbcast:14 row_mask:0xf bank_mask:0xf
    v_and_b32_dpp v30, v50, v26 row_newbcast:14 row_mask:0xf bank_mask:0xf
    v_and_b32_dpp v31, v50, v27 row_newbcast:14 row_mask:0xf bank_mask:0xf
    v_mfma_f32_16x16x32_bf16 v[36:39], v[32:35], v[136:139], v[36:39]
    s_cmp_eq_u32 s35, 1
    s_cbranch_scc1 L_fq215
    s_cbranch_vccnz L_fr215
    s_waitcnt vmcnt(4)
L_fr215:
    s_waitcnt vmcnt(5)
L_fq215:
    s_waitcnt vmcnt(7)
    buffer_load_dwordx4 v[172:175], v4, s[12:15], s78 offen offset:2048 nt
    v_and_b32_dpp v32, v50, v24 row_newbcast:15 row_mask:0xf bank_mask:0xf
    v_and_b32_dpp v33, v50, v25 row_newbcast:15 row_mask:0xf bank_mask:0xf
    v_and_b32_dpp v34, v50, v26 row_newbcast:15 row_mask:0xf bank_mask:0xf
    v_and_b32_dpp v35, v50, v27 row_newbcast:15 row_mask:0xf bank_mask:0xf
    v_mfma_f32_16x16x32_bf16 v[36:39], v[28:31], v[140:143], v[36:39]
    s_cmp_eq_u32 s35, 1
    s_cbranch_scc1 L_fq216
    s_cbranch_vccnz L_fr216
    s_waitcnt vmcnt(4)
L_fr216:
    s_waitcnt vmcnt(5)
L_fq216:
    s_waitcnt vmcnt(7)
    buffer_load_dwordx4 v[176:179], v4, s[12:15], s78 offen offset:3072 nt
    v_and_b32_dpp v28, v51, v24 row_newbcast:0 row_mask:0xf bank_mask:0xf
    v_and_b32_dpp v29, v51, v25 row_newbcast:0 row_mask:0xf bank_mask:0xf
    v_and_b32_dpp v30, v51, v26 row_newbcast:0 row_mask:0xf bank_mask:0xf
    v_and_b32_dpp v31, v51, v27 row_newbcast:0 row_mask:0xf bank_mask:0xf
    v_mfma_f32_16x16x32_bf16 v[36:39], v[32:35], v[144:147], v[36:39]
    s_memrealtime s[96:97]
    s_waitcnt lgkmcnt(0)
    s_sub_u32 s96, s96, s34
    s_cmp_gt_i32 s96, 3592
    s_cselect_b64 vcc, -1, 0
    s_cmp_gt_i32 s96, 3632
    s_cselect_b32 s35, 1, 0
    s_add_u32 s76, s76, 131072
    s_and_b32 s76, s76, 0x3fffff
    s_bfe_u32 s6, s76, 0x10011
    s_lshl_b32 s6, s6, 21
    s_xor_b32 s6, s6, s79
    s_and_b32 s5, s76, 0x1ffff
    s_xor_b32 s6, s6, s5
    s_lshr_b32 s5, s76, 18
    s_lshl_b32 s5, s5, 17
    s_xor_b32 s78, s6, s5
    s_cmp_eq_u32 s35, 1
    s_cbranch_scc1 L_fq217
    s_cbranch_vccnz L_fr217
    s_waitcnt vmcnt(4)
L_fr217:
    s_waitcnt vmcnt(5)
L_fq217:
    s_waitcnt vmcnt(7)
    buffer_load_dwordx4 v[180:183], v4, s[12:15], s78 offen offset:0 nt
    v_and_b32_dpp v32, v51, v24 row_newbcast:1 row_mask:0xf bank_mask:0xf
    v_and_b32_dpp v33, v51, v25 row_newbcast:1 row_mask:0xf bank_mask:0xf
    v_and_b32_dpp v34, v51, v26 row_newbcast:1 row_mask:0xf bank_mask:0xf
    v_and_b32_dpp v35, v51, v27 row_newbcast:1 row_mask:0xf bank_mask:0xf
    v_mfma_f32_16x16x32_bf16 v[36:39], v[28:31], v[148:151], v[36:39]
    s_cmp_eq_u32 s35, 1
    s_cbranch_scc1 L_fq218
    s_cbranch_vccnz L_fr218
    s_waitcnt vmcnt(4)
L_fr218:
    s_waitcnt vmcnt(5)
L_fq218:
    s_waitcnt vmcnt(7)
    buffer_load_dwordx4 v[184:187], v4, s[12:15], s78 offen offset:1024 nt
    v_and_b32_dpp v28, v51, v24 row_newbcast:2 row_mask:0xf bank_mask:0xf
    v_and_b32_dpp v29, v51, v25 row_newbcast:2 row_mask:0xf bank_mask:0xf
    v_and_b32_dpp v30, v51, v26 row_newbcast:2 row_mask:0xf bank_mask:0xf
    v_and_b32_dpp v31, v51, v27 row_newbcast:2 row_mask:0xf bank_mask:0xf
    v_mfma_f32_16x16x32_bf16 v[36:39], v[32:35], v[152:155], v[36:39]
    s_cmp_eq_u32 s35, 1
    s_cbranch_scc1 L_fq219
    s_cbranch_vccnz L_fr219
    s_waitcnt vmcnt(4)
L_fr219:
    s_waitcnt vmcnt(5)
L_fq219:
    s_waitcnt vmcnt(7)
    buffer_load_dwordx4 v[188:191], v4, s[12:15], s78 offen offset:2048 nt
    v_and_b32_dpp v32, v51, v24 row_newbcast:3 row_mask:0xf bank_mask:0xf
    v_and_b32_dpp v33, v51, v25 row_newbcast:3 row_mask:0xf bank_mask:0xf
    v_and_b32_dpp v34, v51, v26 row_newbcast:3 row_mask:0xf bank_mask:0xf
    v_and_b32_dpp v35, v51, v27 row_newbcast:3 row_mask:0xf bank_mask:0xf
    v_mfma_f32_16x16x32_bf16 v[36:39], v[28:31], v[156:159], v[36:39]
    s_cmp_eq_u32 s35, 1
    s_cbranch_scc1 L_fq220
    s_cbranch_vccnz L_fr220
    s_waitcnt vmcnt(4)
L_fr220:
    s_waitcnt vmcnt(5)
L_fq220:
    s_waitcnt vmcnt(7)
    buffer_load_dwordx4 v[192:195], v4, s[12:15], s78 offen offset:3072 nt
    s_add_u32 s76, s76, 131072
    s_and_b32 s76, s76, 0x3fffff
    s_bfe_u32 s6, s76, 0x10011
    s_lshl_b32 s6, s6, 21
    s_xor_b32 s6, s6, s79
    s_and_b32 s5, s76, 0x1ffff
    s_xor_b32 s6, s6, s5
    s_lshr_b32 s5, s76, 18
    s_lshl_b32 s5, s5, 17
    s_xor_b32 s78, s6, s5
    buffer_load_dwordx4 v[196:199], v4, s[12:15], s78 offen offset:0 nt
    s_mov_b64 exec, 1
    v_mov_b32 v12, 1
    ds_add_u32 v20, v12 offset:256
    s_mov_b64 exec, -1
    buffer_load_dwordx4 v[200:203], v4, s[12:15], s78 offen offset:1024 nt
    buffer_load_dwordx4 v[204:207], v4, s[12:15], s78 offen offset:2048 nt
    buffer_load_dwordx4 v[208:211], v4, s[12:15], s78 offen offset:3072 nt
    v_and_b32_dpp v28, v51, v24 row_newbcast:4 row_mask:0xf bank_mask:0xf
    v_and_b32_dpp v29, v51, v25 row_newbcast:4 row_mask:0xf bank_mask:0xf
    v_and_b32_dpp v30, v51, v26 row_newbcast:4 row_mask:0xf bank_mask:0xf
    v_and_b32_dpp v31, v51, v27 row_newbcast:4 row_mask:0xf bank_mask:0xf
    v_mfma_f32_16x16x32_bf16 v[36:39], v[32:35], v[160:163], v[36:39]
    v_and_b32_dpp v32, v51, v24 row_newbcast:5 row_mask:0xf bank_mask:0xf
    v_and_b32_dpp v33, v51, v25 row_newbcast:5 row_mask:0xf bank_mask:0xf
    v_and_b32_dpp v34, v51, v26 row_newbcast:5 row_mask:0xf bank_mask:0xf
    v_and_b32_dpp v35, v51, v27 row_newbcast:5 row_mask:0xf bank_mask:0xf
    s_waitcnt vmcnt(11)
    v_mfma_f32_16x16x32_bf16 v[36:39], v[28:31], v[164:167], v[36:39]
    v_and_b32_dpp v28, v51, v24 row_newbcast:6 row_mask:0xf bank_mask:0xf
    v_and_b32_dpp v29, v51, v25 row_newbcast:6 row_mask:0xf bank_mask:0xf
    v_and_b32_dpp v30, v51, v26 row_newbcast:6 row_mask:0xf bank_mask:0xf
    v_and_b32_dpp v31, v51, v27 row_newbcast:6 row_mask:0xf bank_mask:0xf
    s_waitcnt vmcnt(10)
    v_mfma_f32_16x16x32_bf16 v[36:39], v[32:35], v[168:171], v[36:39]
    v_and_b32_dpp v32, v51, v24 row_newbcast:7 row_mask:0xf bank_mask:0xf
    v_and_b32_dpp v33, v51, v25 row_newbcast:7 row_mask:0xf bank_mask:0xf
    v_and_b32_dpp v34, v51, v26 row_newbcast:7 row_mask:0xf bank_mask:0xf
    v_and_b32_dpp v35, v51, v27 row_newbcast:7 row_mask:0xf bank_mask:0xf
    s_waitcnt vmcnt(9)
    v_mfma_f32_16x16x32_bf16 v[36:39], v[28:31], v[172:175], v[36:39]
    v_and_b32_dpp v28, v51, v24 row_newbcast:8 row_mask:0xf bank_mask:0xf
    v_and_b32_dpp v29, v51, v25 row_newbcast:8 row_mask:0xf bank_mask:0xf
    v_and_b32_dpp v30, v51, v26 row_newbcast:8 row_mask:0xf bank_mask:0xf
    v_and_b32_dpp v31, v51, v27 row_newbcast:8 row_mask:0xf bank_mask:0xf
    s_waitcnt vmcnt(8)
    v_mfma_f32_16x16x32_bf16 v[36:39], v[32:35], v[176:179], v[36:39]
    v_and_b32_dpp v32, v51, v24 row_newbcast:9 row_mask:0xf bank_mask:0xf
    v_and_b32_dpp v33, v51, v25 row_newbcast:9 row_mask:0xf bank_mask:0xf
    v_and_b32_dpp v34, v51, v26 row_newbcast:9 row_mask:0xf bank_mask:0xf
    v_and_b32_dpp v35, v51, v27 row_newbcast:9 row_mask:0xf bank_mask:0xf
    s_waitcnt vmcnt(7)
    v_mfma_f32_16x16x32_bf16 v[36:39], v[28:31], v[180:183], v[36:39]
    v_and_b32_dpp v28, v51, v24 row_newbcast:10 row_mask:0xf bank_mask:0xf
    v_and_b32_dpp v29, v51, v25 row_newbcast:10 row_mask:0xf bank_mask:0xf
    v_and_b32_dpp v30, v51, v26 row_newbcast:10 row_mask:0xf bank_mask:0xf
    v_and_b32_dpp v31, v51, v27 row_newbcast:10 row_mask:0xf bank_mask:0xf
    s_waitcnt vmcnt(6)
    v_mfma_f32_16x16x32_bf16 v[36:39], v[32:35], v[184:187], v[36:39]
    v_and_b32_dpp v32, v51, v24 row_newbcast:11 row_mask:0xf bank_mask:0xf
    v_and_b32_dpp v33, v51, v25 row_newbcast:11 row_mask:0xf bank_mask:0xf
    v_and_b32_dpp v34, v51, v26 row_newbcast:11 row_mask:0xf bank_mask:0xf
    v_and_b32_dpp v35, v51, v27 row_newbcast:11 row_mask:0xf bank_mask:0xf
    s_waitcnt vmcnt(5)
    v_mfma_f32_16x16x32_bf16 v[36:39], v[28:31], v[188:191], v[36:39]
    v_and_b32_dpp v28, v51, v24 row_newbcast:12 row_mask:0xf bank_mask:0xf
    v_and_b32_dpp v29, v51, v25 row_newbcast:12 row_mask:0xf bank_mask:0xf
    v_and_b32_dpp v30, v51, v26 row_newbcast:12 row_mask:0xf bank_mask:0xf
    v_and_b32_dpp v31, v51, v27 row_newbcast:12 row_mask:0xf bank_mask:0xf
    s_waitcnt vmcnt(4)
    v_mfma_f32_16x16x32_bf16 v[36:39], v[32:35], v[192:195], v[36:39]
    v_and_b32_dpp v32, v51, v24 row_newbcast:13 row_mask:0xf bank_mask:0xf
    v_and_b32_dpp v33, v51, v25 row_newbcast:13 row_mask:0xf bank_mask:0xf
    v_and_b32_dpp v34, v51, v26 row_newbcast:13 row_mask:0xf bank_mask:0xf
    v_and_b32_dpp v35, v51, v27 row_newbcast:13 row_mask:0xf bank_mask:0xf
    s_waitcnt vmcnt(3)
    v_mfma_f32_16x16x32_bf16 v[36:39], v[28:31], v[196:199], v[36:39]
    v_and_b32_dpp v28, v51, v24 row_newbcast:14 row_mask:0xf bank_mask:0xf
    v_and_b32_dpp v29, v51, v25 row_newbcast:14 row_mask:0xf bank_mask:0xf
    v_and_b32_dpp v30, v51, v26 row_newbcast:14 row_mask:0xf bank_mask:0xf
    v_and_b32_dpp v31, v51, v27 row_newbcast:14 row_mask:0xf bank_mask:0xf
    s_waitcnt vmcnt(2)
    v_mfma_f32_16x16x32_bf16 v[36:39], v[32:35], v[200:203], v[36:39]
    v_and_b32_dpp v32, v51, v24 row_newbcast:15 row_mask:0xf bank_mask:0xf
    v_and_b32_dpp v33, v51, v25 row_newbcast:15 row_mask:0xf bank_mask:0xf
    v_and_b32_dpp v34, v51, v26 row_newbcast:15 row_mask:0xf bank_mask:0xf
    v_and_b32_dpp v35, v51, v27 row_newbcast:15 row_mask:0xf bank_mask:0xf
    s_waitcnt vmcnt(1)
    v_mfma_f32_16x16x32_bf16 v[36:39], v[28:31], v[204:207], v[36:39]
    s_waitcnt vmcnt(0)
    v_mfma_f32_16x16x32_bf16 v[36:39], v[32:35], v[208:211], v[36:39]
L_sdone:
    v_lshrrev_b32 v6, 5, v1
    v_and_b32 v7, 31, v1
    v_lshlrev_b32 v8, 3, v6
    v_lshlrev_b32 v9, 10, v6
    v_lshl_add_u32 v9, v7, 4, v9
    v_mov_b32 v12, 1
    s_mov_b32 exec_hi, 0
    s_nop 0
    ds_write_b128 v14, v[36:39] offset:4096
    s_mov_b64 exec, 1
    ds_add_rtn_u32 v12, v20, v12 offset:260
    s_mov_b64 exec, -1
    ds_read_b64 v[28:29], v8 offset:384
    ds_read_b128 v[68:71], v9 offset:4096
    ds_read_b128 v[72:75], v9 offset:4608
    v_lshlrev_b32 v10, 4, v7
    v_lshl_add_u32 v10, v6, 3, v10
    s_add_u32 s81, s31, 0x2000
    s_lshl_b32 s82, s84, 10
    s_add_u32 s82, s82, 0x1a0000
    s_waitcnt lgkmcnt(3)
    v_readfirstlane_b32 s80, v12
    s_cmp_lg_u32 s80, 3
    s_cbranch_scc1 L_pub_done
    v_mov_b32 v12, 1
    s_waitcnt lgkmcnt(1)
    v_mul_f32 v52, v28, v68
    v_mul_f32 v53, v28, v69
    v_mul_f32 v54, v28, v70
    v_mul_f32 v55, v28, v71
    s_waitcnt lgkmcnt(0)
    v_fmac_f32 v52, v29, v72
    v_fmac_f32 v53, v29, v73
    v_fmac_f32 v54, v29, v74
    v_fmac_f32 v55, v29, v75
    s_nop 0
    v_permlane32_swap_b32 v52, v54
    v_permlane32_swap_b32 v53, v55
    v_add_f32 v52, v52, v54
    v_add_f32 v53, v53, v55
    v_and_or_b32 v52, v52, s90, v16
    v_and_or_b32 v53, v53, s90, v16
    buffer_store_dwordx2 v[52:53], v10, s[44:47], s31 offen sc1
    buffer_store_dwordx2 v[52:53], v10, s[44:47], s81 offen sc1
    s_mov_b64 exec, 1
    ds_add_u32 v20, v12 offset:260
    s_mov_b64 exec, -1
L_pub_done:
    s_waitcnt lgkmcnt(0)
    s_setprio 0
    s_branch L_tail
L_hsel:
    ds_read_b32 v13, v20 offset:284
    s_waitcnt lgkmcnt(0)
    v_readfirstlane_b32 s30, v13
    s_cmp_gt_i32 s30, 0
    s_cselect_b32 s30, 0x2000, 0
L_tail:
    s_cmp_eq_u32 s85, 0
    s_cbranch_scc1 L_fin
    v_bfe_u32 v6, v1, 3, 1
    v_and_b32 v7, 7, v1
    v_and_b32 v8, 1, v2
    v_lshrrev_b32 v9, 1, v2
    s_lshl_b32 s83, s3, 9
    v_lshlrev_b32 v14, 8, v6
    v_lshl_add_u32 v14, v7, 5, v14
    v_lshl_add_u32 v14, v8, 4, v14
    v_add_u32 v14, s83, v14
    v_lshlrev_b32 v18, 10, v2
    v_lshl_add_u32 v18, v3, 4, v18
    s_cmp_eq_u32 s85, 2
    s_cbranch_scc1 L_g
    v_and_b32 v10, 7, v1
    v_lshlrev_b32 v10, 10, v10
    v_and_b32 v11, 3, v1
    v_lshl_add_u32 v11, v6, 2, v11
    v_lshl_add_u32 v11, v2, 3, v11
    v_lshlrev_b32 v11, 3, v11
    v_bfe_u32 v12, v1, 2, 1
    v_lshl_add_u32 v11, v12, 12, v11
    s_lshl_b32 s80, s87, 2
    s_lshr_b32 s81, s3, 1
    s_add_u32 s80, s80, s81
    s_lshl_b32 s80, s80, 14
    s_add_u32 s80, s80, 0x80000
    s_add_u32 s80, s80, s30
    s_and_b32 s81, s3, 1
    s_lshl_b32 s81, s81, 8
    s_add_u32 s81, s81, s80
    s_mul_i32 s82, s87, 17152
    s_lshl_b32 s83, s88, 8
    s_add_u32 s82, s82, s83
    s_add_u32 s82, s82, 0x100000
    v_lshl_add_u32 v6, v3, 2, v2
    v_lshlrev_b32 v6, 2, v6
    s_add_u32 s32, s82, 0x2000
    s_mov_b32 s91, 90000000
L_gate4:
    ds_read_b32 v12, v20 offset:264
    s_waitcnt lgkmcnt(0)
    v_cmp_gt_u32 vcc, 4, v12
    s_cbranch_vccz L_gate4_done
    s_sleep 2
    s_sub_u32 s91, s91, 1
    s_cbranch_scc0 L_gate4
L_gate4_done:
    s_cmp_lt_u32 s3, 4
    s_cbranch_scc1 L_w_h
    buffer_load_dwordx4 v[204:207], v10, s[44:47], s80 offen offset:512 sc1
    buffer_load_dwordx2 v[196:197], v11, s[44:47], s81 offen offset:0 sc1
    buffer_load_dwordx2 v[198:199], v11, s[44:47], s81 offen offset:1024 sc1
    buffer_load_dwordx2 v[200:201], v11, s[44:47], s81 offen offset:2048 sc1
    buffer_load_dwordx2 v[202:203], v11, s[44:47], s81 offen offset:3072 sc1
    s_cmp_lt_u32 s3, 4
    s_cbranch_scc1 L_fetch0
    s_mov_b32 s91, 90000000
L_gate5:
    ds_read_b32 v12, v20 offset:268
    s_waitcnt lgkmcnt(0)
    v_cmp_gt_u32 vcc, 4, v12
    s_cbranch_vccz L_gate5_done
    s_sleep 2
    s_sub_u32 s91, s91, 1
    s_cbranch_scc0 L_gate5
L_gate5_done:
    s_sub_u32 s83, s3, 4
    s_mul_i32 s83, s83, 10240
    v_add_u32 v19, s83, v4
    ds_read_b128 v[84:87], v19 offset:20480
    ds_read_b128 v[88:91], v19 offset:21504
    ds_read_b128 v[92:95], v19 offset:22528
    ds_read_b128 v[96:99], v19 offset:23552
    ds_read_b128 v[100:103], v19 offset:24576
    ds_read_b128 v[104:107], v19 offset:25600
    ds_read_b128 v[108:111], v19 offset:26624
    ds_read_b128 v[112:115], v19 offset:27648
L_fetch0:
    s_mov_b32 s91, 3000000
    s_branch L_pml_w
L_w_h:
    s_mov_b32 s91, 3000000
L_pml:
    buffer_load_dwordx4 v[204:207], v10, s[44:47], s80 offen offset:512 sc1
    buffer_load_dwordx2 v[196:197], v11, s[44:47], s81 offen offset:0 sc1
    buffer_load_dwordx2 v[198:199], v11, s[44:47], s81 offen offset:1024 sc1
    buffer_load_dwordx2 v[200:201], v11, s[44:47], s81 offen offset:2048 sc1
    buffer_load_dwordx2 v[202:203], v11, s[44:47], s81 offen offset:3072 sc1
L_pml_w:
    s_waitcnt vmcnt(4)
    v_xor_b32 v76, v16, v204
    v_xor_b32 v77, v16, v205
    v_xor_b32 v78, v16, v206
    v_xor_b32 v79, v16, v207
    v_or3_b32 v13, v76, v77, v78
    v_or_b32 v13, v13, v79
    v_and_b32 v13, 0xff, v13
    v_cmp_ne_u32 vcc, 0, v13
    s_cbranch_vccz L_pml_done
    s_sub_u32 s91, s91, 1
    s_cbranch_scc0 L_pml
L_pml_done:
    buffer_load_dwordx2 v[180:181], v11, s[44:47], s81 offen offset:0 sc1
    buffer_load_dwordx2 v[182:183], v11, s[44:47], s81 offen offset:1024 sc1
    buffer_load_dwordx2 v[184:185], v11, s[44:47], s81 offen offset:2048 sc1
    buffer_load_dwordx2 v[186:187], v11, s[44:47], s81 offen offset:3072 sc1
    v_max_f32_dpp v8, v76, v76 quad_perm:[1,0,3,2] row_mask:0xf bank_mask:0xf
    s_nop 1
    v_max_f32_dpp v8, v8, v8 quad_perm:[2,3,0,1] row_mask:0xf bank_mask:0xf
    s_nop 1
    v_max_f32_dpp v8, v8, v8 row_half_mirror row_mask:0xf bank_mask:0xf
    v_sub_f32 v76, v76, v8
    v_mul_f32 v76, s94, v76
    v_exp_f32 v76, v76
    s_nop 0
    v_mul_f32 v77, v77, v76
    s_nop 1
    v_add_f32_dpp v77, v77, v77 quad_perm:[1,0,3,2] row_mask:0xf bank_mask:0xf
    s_nop 1
    v_add_f32_dpp v77, v77, v77 quad_perm:[2,3,0,1] row_mask:0xf bank_mask:0xf
    s_nop 1
    v_add_f32_dpp v77, v77, v77 row_half_mirror row_mask:0xf bank_mask:0xf
    v_rcp_f32 v9, v77
    s_nop 0
    v_mul_f32 v76, v76, v9
    s_nop 1
    v_mov_b32_dpp v80, v76 quad_perm:[0,0,0,0] row_mask:0xf bank_mask:0xf
    v_mov_b32_dpp v81, v76 quad_perm:[1,1,1,1] row_mask:0xf bank_mask:0xf
    v_mov_b32_dpp v82, v76 quad_perm:[2,2,2,2] row_mask:0xf bank_mask:0xf
    v_mov_b32_dpp v83, v76 quad_perm:[3,3,3,3] row_mask:0xf bank_mask:0xf
    s_waitcnt vmcnt(4)
    v_xor_b32 v68, v16, v196
    v_xor_b32 v69, v16, v197
    v_xor_b32 v70, v16, v198
    v_xor_b32 v71, v16, v199
    v_xor_b32 v72, v16, v200
    v_xor_b32 v73, v16, v201
    v_xor_b32 v74, v16, v202
    v_xor_b32 v75, v16, v203
    v_or3_b32 v13, v68, v69, v70
    v_or3_b32 v13, v13, v71, v72
    v_or3_b32 v13, v13, v73, v74
    v_or_b32 v13, v13, v75
    v_and_b32 v13, 0xff, v13
    v_cmp_ne_u32 vcc, 0, v13
    s_cbranch_vccz L_po_done
    s_waitcnt vmcnt(0)
    v_xor_b32 v68, v16, v180
    v_xor_b32 v69, v16, v181
    v_xor_b32 v70, v16, v182
    v_xor_b32 v71, v16, v183
    v_xor_b32 v72, v16, v184
    v_xor_b32 v73, v16, v185
    v_xor_b32 v74, v16, v186
    v_xor_b32 v75, v16, v187
    v_or3_b32 v13, v68, v69, v70
    v_or3_b32 v13, v13, v71, v72
    v_or3_b32 v13, v13, v73, v74
    v_or_b32 v13, v13, v75
    v_and_b32 v13, 0xff, v13
    v_cmp_ne_u32 vcc, 0, v13
    s_cbranch_vccz L_po_done
    s_mov_b32 s91, 3000000
L_poll0:
    buffer_load_dwordx2 v[196:197], v11, s[44:47], s81 offen offset:0 sc1
    buffer_load_dwordx2 v[198:199], v11, s[44:47], s81 offen offset:1024 sc1
    buffer_load_dwordx2 v[200:201], v11, s[44:47], s81 offen offset:2048 sc1
    buffer_load_dwordx2 v[202:203], v11, s[44:47], s81 offen offset:3072 sc1
    s_waitcnt vmcnt(0)
    v_xor_b32 v68, v16, v196
    v_xor_b32 v69, v16, v197
    v_xor_b32 v70, v16, v198
    v_xor_b32 v71, v16, v199
    v_xor_b32 v72, v16, v200
    v_xor_b32 v73, v16, v201
    v_xor_b32 v74, v16, v202
    v_xor_b32 v75, v16, v203
    v_or3_b32 v13, v68, v69, v70
    v_or3_b32 v13, v13, v71, v72
    v_or3_b32 v13, v13, v73, v74
    v_or_b32 v13, v13, v75
    v_and_b32 v13, 0xff, v13
    v_cmp_ne_u32 vcc, 0, v13
    s_cbranch_vccz L_poll0_done
    s_sub_u32 s91, s91, 1
    s_cbranch_scc0 L_poll0
L_poll0_done:
L_po_done:
    s_setprio 2
    v_mul_f32 v68, v68, v80
    v_mul_f32 v69, v69, v80
    v_fmac_f32 v68, v70, v81
    v_fmac_f32 v69, v71, v81
    v_fmac_f32 v68, v72, v82
    v_fmac_f32 v69, v73, v82
    v_fmac_f32 v68, v74, v83
    v_fmac_f32 v69, v75, v83
    s_nop 0
    v_add_f32_dpp v70, v68, v68 row_shl:4 row_mask:0xf bank_mask:0x5
    v_add_f32_dpp v71, v69, v69 row_shl:4 row_mask:0xf bank_mask:0x5
    s_nop 0
    v_add_f32_dpp v70, v68, v68 row_shr:4 row_mask:0xf bank_mask:0xa
    v_add_f32_dpp v71, v69, v69 row_shr:4 row_mask:0xf bank_mask:0xa
    v_cvt_pk_bf16_f32 v70, v70, v70
    v_cvt_pk_bf16_f32 v71, v71, v71
    s_waitcnt lgkmcnt(0)
    v_and_b32_dpp v28, v70, v24 quad_perm:[0,0,0,0] row_mask:0xf bank_mask:0xf
    v_and_b32_dpp v29, v70, v25 quad_perm:[0,0,0,0] row_mask:0xf bank_mask:0xf
    v_and_b32_dpp v30, v70, v26 quad_perm:[0,0,0,0] row_mask:0xf bank_mask:0xf
    v_and_b32_dpp v31, v70, v27 quad_perm:[0,0,0,0] row_mask:0xf bank_mask:0xf
    v_and_b32_dpp v32, v70, v24 quad_perm:[1,1,1,1] row_mask:0xf bank_mask:0xf
    v_and_b32_dpp v33, v70, v25 quad_perm:[1,1,1,1] row_mask:0xf bank_mask:0xf
    v_and_b32_dpp v34, v70, v26 quad_perm:[1,1,1,1] row_mask:0xf bank_mask:0xf
    v_and_b32_dpp v35, v70, v27 quad_perm:[1,1,1,1] row_mask:0xf bank_mask:0xf
    v_mfma_f32_16x16x32_bf16 v[36:39], v[28:31], v[84:87], 0
    v_and_b32_dpp v28, v70, v24 quad_perm:[2,2,2,2] row_mask:0xf bank_mask:0xf
    v_and_b32_dpp v29, v70, v25 quad_perm:[2,2,2,2] row_mask:0xf bank_mask:0xf
    v_and_b32_dpp v30, v70, v26 quad_perm:[2,2,2,2] row_mask:0xf bank_mask:0xf
    v_and_b32_dpp v31, v70, v27 quad_perm:[2,2,2,2] row_mask:0xf bank_mask:0xf
    v_mfma_f32_16x16x32_bf16 v[36:39], v[32:35], v[88:91], v[36:39]
    v_and_b32_dpp v32, v70, v24 quad_perm:[3,3,3,3] row_mask:0xf bank_mask:0xf
    v_and_b32_dpp v33, v70, v25 quad_perm:[3,3,3,3] row_mask:0xf bank_mask:0xf
    v_and_b32_dpp v34, v70, v26 quad_perm:[3,3,3,3] row_mask:0xf bank_mask:0xf
    v_and_b32_dpp v35, v70, v27 quad_perm:[3,3,3,3] row_mask:0xf bank_mask:0xf
    v_mfma_f32_16x16x32_bf16 v[36:39], v[28:31], v[92:95], v[36:39]
    v_and_b32_dpp v28, v71, v24 quad_perm:[0,0,0,0] row_mask:0xf bank_mask:0xf
    v_and_b32_dpp v29, v71, v25 quad_perm:[0,0,0,0] row_mask:0xf bank_mask:0xf
    v_and_b32_dpp v30, v71, v26 quad_perm:[0,0,0,0] row_mask:0xf bank_mask:0xf
    v_and_b32_dpp v31, v71, v27 quad_perm:[0,0,0,0] row_mask:0xf bank_mask:0xf
    v_mfma_f32_16x16x32_bf16 v[36:39], v[32:35], v[96:99], v[36:39]
    v_and_b32_dpp v32, v71, v24 quad_perm:[1,1,1,1] row_mask:0xf bank_mask:0xf
    v_and_b32_dpp v33, v71, v25 quad_perm:[1,1,1,1] row_mask:0xf bank_mask:0xf
    v_and_b32_dpp v34, v71, v26 quad_perm:[1,1,1,1] row_mask:0xf bank_mask:0xf
    v_and_b32_dpp v35, v71, v27 quad_perm:[1,1,1,1] row_mask:0xf bank_mask:0xf
    v_mfma_f32_16x16x32_bf16 v[36:39], v[28:31], v[100:103], v[36:39]
    v_and_b32_dpp v28, v71, v24 quad_perm:[2,2,2,2] row_mask:0xf bank_mask:0xf
    v_and_b32_dpp v29, v71, v25 quad_perm:[2,2,2,2] row_mask:0xf bank_mask:0xf
    v_and_b32_dpp v30, v71, v26 quad_perm:[2,2,2,2] row_mask:0xf bank_mask:0xf
    v_and_b32_dpp v31, v71, v27 quad_perm:[2,2,2,2] row_mask:0xf bank_mask:0xf
    v_mfma_f32_16x16x32_bf16 v[36:39], v[32:35], v[104:107], v[36:39]
    v_and_b32_dpp v32, v71, v24 quad_perm:[3,3,3,3] row_mask:0xf bank_mask:0xf
    v_and_b32_dpp v33, v71, v25 quad_perm:[3,3,3,3] row_mask:0xf bank_mask:0xf
    v_and_b32_dpp v34, v71, v26 quad_perm:[3,3,3,3] row_mask:0xf bank_mask:0xf
    v_and_b32_dpp v35, v71, v27 quad_perm:[3,3,3,3] row_mask:0xf bank_mask:0xf
    v_mfma_f32_16x16x32_bf16 v[36:39], v[28:31], v[108:111], v[36:39]
    s_nop 0
    v_mfma_f32_16x16x32_bf16 v[36:39], v[32:35], v[112:115], v[36:39]
    v_mov_b32 v12, 1
    s_mov_b32 exec_lo, 0x00ff00ff
    s_mov_b32 exec_hi, 0xff00ff00
    s_nop 4
    ds_write_b128 v14, v[36:39] offset:8192
    s_mov_b64 exec, 1
    ds_add_rtn_u32 v12, v20, v12 offset:288
    s_mov_b64 exec, -1
    ds_read_b128 v[68:71], v18 offset:8192
    ds_read_b128 v[72:75], v18 offset:8448
    ds_read_b128 v[76:79], v18 offset:8704
    ds_read_b128 v[80:83], v18 offset:8960
    s_waitcnt lgkmcnt(4)
    v_readfirstlane_b32 s80, v12
    s_cmp_lg_u32 s80, 7
    s_cbranch_scc1 L_fin
    s_waitcnt lgkmcnt(2)
    v_add_f32 v68, v68, v72
    v_add_f32 v69, v69, v73
    v_add_f32 v70, v70, v74
    v_add_f32 v71, v71, v75
    s_waitcnt lgkmcnt(0)
    v_add_f32 v76, v76, v80
    v_add_f32 v77, v77, v81
    v_add_f32 v78, v78, v82
    v_add_f32 v79, v79, v83
    v_add_f32 v68, v68, v76
    v_add_f32 v69, v69, v77
    v_add_f32 v70, v70, v78
    v_add_f32 v71, v71, v79
    s_nop 0
    v_permlane32_swap_b32 v68, v70
    v_permlane32_swap_b32 v69, v71
    v_add_f32 v68, v68, v70
    v_add_f32 v69, v69, v71
    s_nop 1
    v_permlane16_swap_b32 v68, v69
    v_add_f32 v68, v68, v69
    v_and_or_b32 v68, v68, s90, v16
    buffer_store_dword v68, v6, s[44:47], s82 offen sc1
    buffer_store_dword v68, v6, s[44:47], s32 offen sc1
    s_branch L_fin
L_g:
    s_cmp_lt_u32 s3, 4
    s_cbranch_scc1 L_gh
    s_mul_i32 s83, s3, 64
    s_add_u32 s83, s83, 128
    v_and_b32 v11, 3, v1
    v_lshrrev_b32 v40, 3, v1
    v_lshl_add_u32 v40, v40, 2, v11
    v_mul_u32_u24 v40, 2, v40
    v_add_u32 v40, s83, v40
    v_lshlrev_b32 v40, 1, v40
    buffer_load_ushort v44, v40, s[48:51], 0 offen offset:0
    buffer_load_ushort v45, v40, s[48:51], 0 offen offset:2
    v_lshlrev_b32 v40, 1, v40
    v_bfe_u32 v41, v1, 2, 1
    v_mul_u32_u24 v41, 68608, v41
    v_add_u32 v41, v41, v40
    s_cmp_lt_u32 s3, 4
    s_cbranch_scc1 L_fetch1
    s_mov_b32 s91, 90000000
L_gate6:
    ds_read_b32 v12, v20 offset:268
    s_waitcnt lgkmcnt(0)
    v_cmp_gt_u32 vcc, 4, v12
    s_cbranch_vccz L_gate6_done
    s_sleep 2
    s_sub_u32 s91, s91, 1
    s_cbranch_scc0 L_gate6
L_gate6_done:
    s_sub_u32 s83, s3, 4
    s_mul_i32 s83, s83, 10240
    v_add_u32 v19, s83, v4
    ds_read_b128 v[84:87], v19 offset:20480
    ds_read_b128 v[88:91], v19 offset:21504
    ds_read_b128 v[92:95], v19 offset:22528
    ds_read_b128 v[96:99], v19 offset:23552
    ds_read_b128 v[100:103], v19 offset:24576
    ds_read_b128 v[104:107], v19 offset:25600
    ds_read_b128 v[108:111], v19 offset:26624
    ds_read_b128 v[112:115], v19 offset:27648
L_fetch1:
    s_waitcnt lgkmcnt(0)
    v_mov_b32 v68, 0x3f803f80
    s_nop 1
    v_and_b32_dpp v28, v68, v24 quad_perm:[0,0,0,0] row_mask:0xf bank_mask:0xf
    v_and_b32_dpp v29, v68, v25 quad_perm:[0,0,0,0] row_mask:0xf bank_mask:0xf
    v_and_b32_dpp v30, v68, v26 quad_perm:[0,0,0,0] row_mask:0xf bank_mask:0xf
    v_and_b32_dpp v31, v68, v27 quad_perm:[0,0,0,0] row_mask:0xf bank_mask:0xf
    s_nop 1
    v_mfma_f32_16x16x32_bf16 v[36:39], v[28:31], v[84:87], 0
    v_mfma_f32_16x16x32_bf16 v[36:39], v[28:31], v[88:91], v[36:39]
    v_mfma_f32_16x16x32_bf16 v[36:39], v[28:31], v[92:95], v[36:39]
    v_mfma_f32_16x16x32_bf16 v[36:39], v[28:31], v[96:99], v[36:39]
    v_mfma_f32_16x16x32_bf16 v[36:39], v[28:31], v[100:103], v[36:39]
    v_mfma_f32_16x16x32_bf16 v[36:39], v[28:31], v[104:107], v[36:39]
    v_mfma_f32_16x16x32_bf16 v[36:39], v[28:31], v[108:111], v[36:39]
    v_mfma_f32_16x16x32_bf16 v[36:39], v[28:31], v[112:115], v[36:39]
    s_mov_b32 exec_lo, 0x00ff00ff
    s_mov_b32 exec_hi, 0xff00ff00
    s_nop 5
    ds_write_b128 v14, v[36:39] offset:8192
    s_mov_b64 exec, -1
    s_waitcnt lgkmcnt(0)
    s_barrier
    s_add_u32 s20, s30, 0x100000
    s_add_u32 s21, s30, 0x104300
    s_add_u32 s22, s30, 0x108600
    s_add_u32 s23, s30, 0x10c900
    s_lshl_b32 s83, s3, 3
    v_mov_b32 v6, s83
    s_waitcnt vmcnt(0)
    v_lshlrev_b32 v44, 16, v44
    v_lshlrev_b32 v45, 16, v45
    s_mov_b32 s91, 3000000
L_gps:
    buffer_load_dwordx2 v[196:197], v41, s[44:47], s20 offen sc1
    buffer_load_dwordx2 v[200:201], v41, s[44:47], s21 offen sc1
    buffer_load_dwordx2 v[204:205], v41, s[44:47], s22 offen sc1
    buffer_load_dwordx2 v[208:209], v41, s[44:47], s23 offen sc1
    s_waitcnt vmcnt(0)
    v_xor_b32 v68, v16, v196
    v_xor_b32 v69, v16, v197
    v_xor_b32 v70, v16, v200
    v_xor_b32 v71, v16, v201
    v_xor_b32 v72, v16, v204
    v_xor_b32 v73, v16, v205
    v_xor_b32 v74, v16, v208
    v_xor_b32 v75, v16, v209
    v_or3_b32 v13, v68, v69, v70
    v_or3_b32 v13, v13, v71, v72
    v_or3_b32 v13, v13, v73, v74
    v_or_b32 v13, v13, v75
    v_and_b32 v13, 0xff, v13
    v_cmp_ne_u32 vcc, 0, v13
    s_cbranch_vccz L_gps_done
    s_sub_u32 s91, s91, 1
    s_cbranch_scc0 L_gps
L_gps_done:
    s_setprio 2
    v_add_f32 v68, v68, v70
    v_add_f32 v69, v69, v71
    v_add_f32 v72, v72, v74
    v_add_f32 v73, v73, v75
    v_add_f32 v68, v68, v72
    v_add_f32 v69, v69, v73
    s_nop 0
    v_add_f32_dpp v80, v68, v68 row_shl:4 row_mask:0xf bank_mask:0x5
    v_add_f32_dpp v81, v69, v69 row_shl:4 row_mask:0xf bank_mask:0x5
    s_nop 0
    v_add_f32_dpp v80, v68, v68 row_shr:4 row_mask:0xf bank_mask:0xa
    v_add_f32_dpp v81, v69, v69 row_shr:4 row_mask:0xf bank_mask:0xa
    v_cvt_pk_bf16_f32 v80, v80, v80
    v_cvt_pk_bf16_f32 v81, v81, v81
    v_lshlrev_b32 v80, 16, v80
    v_lshlrev_b32 v81, 16, v81
    v_add_f32 v80, v80, v44
    v_add_f32 v81, v81, v45
    v_cvt_pk_bf16_f32 v80, v80, v80
    v_cvt_pk_bf16_f32 v81, v81, v81
    s_nop 0
    v_and_b32_dpp v28, v80, v24 quad_perm:[0,0,0,0] row_mask:0xf bank_mask:0xf
    v_and_b32_dpp v29, v80, v25 quad_perm:[0,0,0,0] row_mask:0xf bank_mask:0xf
    v_and_b32_dpp v30, v80, v26 quad_perm:[0,0,0,0] row_mask:0xf bank_mask:0xf
    v_and_b32_dpp v31, v80, v27 quad_perm:[0,0,0,0] row_mask:0xf bank_mask:0xf
    v_and_b32_dpp v32, v80, v24 quad_perm:[1,1,1,1] row_mask:0xf bank_mask:0xf
    v_and_b32_dpp v33, v80, v25 quad_perm:[1,1,1,1] row_mask:0xf bank_mask:0xf
    v_and_b32_dpp v34, v80, v26 quad_perm:[1,1,1,1] row_mask:0xf bank_mask:0xf
    v_and_b32_dpp v35, v80, v27 quad_perm:[1,1,1,1] row_mask:0xf bank_mask:0xf
    v_lshlrev_b32 v68, 16, v80
    v_lshlrev_b32 v69, 16, v81
    v_add_f32 v72, v68, v69
    v_mul_f32 v73, v68, v68
    v_mfma_f32_16x16x32_bf16 v[36:39], v[28:31], v[84:87], 0
    v_and_b32_dpp v28, v80, v24 quad_perm:[2,2,2,2] row_mask:0xf bank_mask:0xf
    v_and_b32_dpp v29, v80, v25 quad_perm:[2,2,2,2] row_mask:0xf bank_mask:0xf
    v_and_b32_dpp v30, v80, v26 quad_perm:[2,2,2,2] row_mask:0xf bank_mask:0xf
    v_and_b32_dpp v31, v80, v27 quad_perm:[2,2,2,2] row_mask:0xf bank_mask:0xf
    v_fmac_f32 v73, v69, v69
    ds_write_b32 v40, v68 offset:16384
    ds_write_b32 v40, v69 offset:16388
    v_mfma_f32_16x16x32_bf16 v[36:39], v[32:35], v[88:91], v[36:39]
    v_and_b32_dpp v32, v80, v24 quad_perm:[3,3,3,3] row_mask:0xf bank_mask:0xf
    v_and_b32_dpp v33, v80, v25 quad_perm:[3,3,3,3] row_mask:0xf bank_mask:0xf
    v_and_b32_dpp v34, v80, v26 quad_perm:[3,3,3,3] row_mask:0xf bank_mask:0xf
    v_and_b32_dpp v35, v80, v27 quad_perm:[3,3,3,3] row_mask:0xf bank_mask:0xf
    v_add_f32_dpp v72, v72, v72 quad_perm:[1,0,3,2] row_mask:0xf bank_mask:0xf
    v_add_f32_dpp v73, v73, v73 quad_perm:[1,0,3,2] row_mask:0xf bank_mask:0xf
    v_mfma_f32_16x16x32_bf16 v[36:39], v[28:31], v[92:95], v[36:39]
    v_and_b32_dpp v28, v81, v24 quad_perm:[0,0,0,0] row_mask:0xf bank_mask:0xf
    v_and_b32_dpp v29, v81, v25 quad_perm:[0,0,0,0] row_mask:0xf bank_mask:0xf
    v_and_b32_dpp v30, v81, v26 quad_perm:[0,0,0,0] row_mask:0xf bank_mask:0xf
    v_and_b32_dpp v31, v81, v27 quad_perm:[0,0,0,0] row_mask:0xf bank_mask:0xf
    v_add_f32_dpp v72, v72, v72 quad_perm:[2,3,0,1] row_mask:0xf bank_mask:0xf
    v_add_f32_dpp v73, v73, v73 quad_perm:[2,3,0,1] row_mask:0xf bank_mask:0xf
    v_mfma_f32_16x16x32_bf16 v[36:39], v[32:35], v[96:99], v[36:39]
    v_and_b32_dpp v32, v81, v24 quad_perm:[1,1,1,1] row_mask:0xf bank_mask:0xf
    v_and_b32_dpp v33, v81, v25 quad_perm:[1,1,1,1] row_mask:0xf bank_mask:0xf
    v_and_b32_dpp v34, v81, v26 quad_perm:[1,1,1,1] row_mask:0xf bank_mask:0xf
    v_and_b32_dpp v35, v81, v27 quad_perm:[1,1,1,1] row_mask:0xf bank_mask:0xf
    v_add_f32_dpp v72, v72, v72 row_ror:8 row_mask:0xf bank_mask:0xf
    v_add_f32_dpp v73, v73, v73 row_ror:8 row_mask:0xf bank_mask:0xf
    v_mfma_f32_16x16x32_bf16 v[36:39], v[28:31], v[100:103], v[36:39]
    v_and_b32_dpp v28, v81, v24 quad_perm:[2,2,2,2] row_mask:0xf bank_mask:0xf
    v_and_b32_dpp v29, v81, v25 quad_perm:[2,2,2,2] row_mask:0xf bank_mask:0xf
    v_and_b32_dpp v30, v81, v26 quad_perm:[2,2,2,2] row_mask:0xf bank_mask:0xf
    v_and_b32_dpp v31, v81, v27 quad_perm:[2,2,2,2] row_mask:0xf bank_mask:0xf
    v_add_f32_dpp v72, v72, v72 row_bcast:15 row_mask:0xa bank_mask:0xf
    v_add_f32_dpp v73, v73, v73 row_bcast:15 row_mask:0xa bank_mask:0xf
    v_mfma_f32_16x16x32_bf16 v[36:39], v[32:35], v[104:107], v[36:39]
    v_and_b32_dpp v32, v81, v24 quad_perm:[3,3,3,3] row_mask:0xf bank_mask:0xf
    v_and_b32_dpp v33, v81, v25 quad_perm:[3,3,3,3] row_mask:0xf bank_mask:0xf
    v_and_b32_dpp v34, v81, v26 quad_perm:[3,3,3,3] row_mask:0xf bank_mask:0xf
    v_and_b32_dpp v35, v81, v27 quad_perm:[3,3,3,3] row_mask:0xf bank_mask:0xf
    v_add_f32_dpp v72, v72, v72 row_bcast:31 row_mask:0xc bank_mask:0xf
    v_add_f32_dpp v73, v73, v73 row_bcast:31 row_mask:0xc bank_mask:0xf
    v_mfma_f32_16x16x32_bf16 v[36:39], v[28:31], v[108:111], v[36:39]
    v_mfma_f32_16x16x32_bf16 v[36:39], v[32:35], v[112:115], v[36:39]
    s_mov_b32 exec_lo, 0
    s_mov_b32 exec_hi, 0x80000000
    ds_write_b64 v6, v[72:73] offset:448
    s_mov_b32 exec_lo, 0x00ff00ff
    s_mov_b32 exec_hi, 0xff00ff00
    s_nop 2
    ds_write_b128 v14, v[36:39] offset:12288
    s_mov_b64 exec, -1
    s_waitcnt lgkmcnt(0)
    s_barrier
    s_branch L_f
L_gh:
    s_mul_i32 s83, s3, 96
    s_add_u32 s83, s83, 0
    v_and_b32 v11, 3, v1
    v_lshrrev_b32 v40, 3, v1
    v_lshl_add_u32 v40, v40, 2, v11
    v_mul_u32_u24 v40, 3, v40
    v_add_u32 v40, s83, v40
    v_lshlrev_b32 v40, 1, v40
    buffer_load_ushort v44, v40, s[48:51], 0 offen offset:0
    buffer_load_ushort v45, v40, s[48:51], 0 offen offset:2
    buffer_load_ushort v46, v40, s[48:51], 0 offen offset:4
    v_lshlrev_b32 v40, 1, v40
    v_bfe_u32 v41, v1, 2, 1
    v_mul_u32_u24 v41, 68608, v41
    v_add_u32 v41, v41, v40
    v_mul_u32_u24 v48, 1280, v2
    v_lshl_add_u32 v48, v3, 4, v48
    v_lshlrev_b32 v49, 13, v9
    v_lshl_add_u32 v49, v3, 5, v49
    v_lshl_add_u32 v49, v8, 4, v49
    s_mul_i32 s80, s89, 40960
    s_add_u32 s81, s80, 1024
    s_cmp_eq_u32 s3, 0
    s_cselect_b32 s81, s81, 0x40000000
    s_lshl_b32 s82, s3, 8
    s_add_u32 s80, s80, s82
    buffer_load_dwordx4 v[132:135], v48, s[64:67], s80 offen nt
    buffer_load_dwordx4 v[136:139], v48, s[64:67], s81 offen nt
    s_add_u32 s80, s80, 5120
    s_add_u32 s81, s81, 5120
    buffer_load_dwordx4 v[140:143], v48, s[64:67], s80 offen nt
    buffer_load_dwordx4 v[144:147], v48, s[64:67], s81 offen nt
    s_add_u32 s80, s80, 5120
    s_add_u32 s81, s81, 5120
    buffer_load_dwordx4 v[148:151], v48, s[64:67], s80 offen nt
    buffer_load_dwordx4 v[152:155], v48, s[64:67], s81 offen nt
    s_add_u32 s80, s80, 5120
    s_add_u32 s81, s81, 5120
    buffer_load_dwordx4 v[156:159], v48, s[64:67], s80 offen nt
    buffer_load_dwordx4 v[160:163], v48, s[64:67], s81 offen nt
    s_add_u32 s80, s80, 5120
    s_add_u32 s81, s81, 5120
    buffer_load_dwordx4 v[164:167], v48, s[64:67], s80 offen nt
    buffer_load_dwordx4 v[168:171], v48, s[64:67], s81 offen nt
    s_add_u32 s80, s80, 5120
    s_add_u32 s81, s81, 5120
    buffer_load_dwordx4 v[172:175], v48, s[64:67], s80 offen nt
    buffer_load_dwordx4 v[176:179], v48, s[64:67], s81 offen nt
    s_add_u32 s80, s80, 5120
    s_add_u32 s81, s81, 5120
    buffer_load_dwordx4 v[180:183], v48, s[64:67], s80 offen nt
    buffer_load_dwordx4 v[184:187], v48, s[64:67], s81 offen nt
    s_add_u32 s80, s80, 5120
    s_add_u32 s81, s81, 5120
    buffer_load_dwordx4 v[188:191], v48, s[64:67], s80 offen nt
    buffer_load_dwordx4 v[192:195], v48, s[64:67], s81 offen nt
    s_waitcnt vmcnt(16)
    v_mov_b32 v68, 0x3f803f80
    s_nop 1
    v_and_b32_dpp v28, v68, v24 quad_perm:[0,0,0,0] row_mask:0xf bank_mask:0xf
    v_and_b32_dpp v29, v68, v25 quad_perm:[0,0,0,0] row_mask:0xf bank_mask:0xf
    v_and_b32_dpp v30, v68, v26 quad_perm:[0,0,0,0] row_mask:0xf bank_mask:0xf
    v_and_b32_dpp v31, v68, v27 quad_perm:[0,0,0,0] row_mask:0xf bank_mask:0xf
    s_nop 1
    v_mfma_f32_16x16x32_bf16 v[36:39], v[28:31], v[84:87], 0
    v_mfma_f32_16x16x32_bf16 v[36:39], v[28:31], v[88:91], v[36:39]
    v_mfma_f32_16x16x32_bf16 v[36:39], v[28:31], v[92:95], v[36:39]
    v_mfma_f32_16x16x32_bf16 v[36:39], v[28:31], v[96:99], v[36:39]
    v_mfma_f32_16x16x32_bf16 v[36:39], v[28:31], v[100:103], v[36:39]
    v_mfma_f32_16x16x32_bf16 v[36:39], v[28:31], v[104:107], v[36:39]
    v_mfma_f32_16x16x32_bf16 v[36:39], v[28:31], v[108:111], v[36:39]
    v_mfma_f32_16x16x32_bf16 v[36:39], v[28:31], v[112:115], v[36:39]
    v_mfma_f32_16x16x32_bf16 v[36:39], v[28:31], v[116:119], v[36:39]
    v_mfma_f32_16x16x32_bf16 v[36:39], v[28:31], v[120:123], v[36:39]
    v_mfma_f32_16x16x32_bf16 v[36:39], v[28:31], v[124:127], v[36:39]
    v_mfma_f32_16x16x32_bf16 v[36:39], v[28:31], v[128:131], v[36:39]
    s_mov_b32 exec_lo, 0x00ff00ff
    s_mov_b32 exec_hi, 0xff00ff00
    s_nop 5
    ds_write_b128 v14, v[36:39] offset:8192
    s_mov_b64 exec, -1
    s_waitcnt lgkmcnt(0)
    s_barrier
    ds_read_b128 v[68:71], v18 offset:8192
    ds_read_b128 v[72:75], v18 offset:8448
    ds_read_b128 v[76:79], v18 offset:8704
    ds_read_b128 v[80:83], v18 offset:8960
    s_waitcnt lgkmcnt(2)
    v_add_f32 v68, v68, v72
    v_add_f32 v69, v69, v73
    v_add_f32 v70, v70, v74
    v_add_f32 v71, v71, v75
    s_waitcnt lgkmcnt(0)
    v_add_f32 v76, v76, v80
    v_add_f32 v77, v77, v81
    v_add_f32 v78, v78, v82
    v_add_f32 v79, v79, v83
    v_add_f32 v68, v68, v76
    v_add_f32 v69, v69, v77
    v_add_f32 v70, v70, v78
    v_add_f32 v71, v71, v79
    s_nop 0
    v_permlane32_swap_b32 v68, v70
    v_permlane32_swap_b32 v69, v71
    v_add_f32 v68, v68, v70
    v_add_f32 v69, v69, v71
    s_nop 1
    v_permlane16_swap_b32 v68, v69
    v_add_f32 v68, v68, v69
    v_mov_b32 v47, v68
    s_lshr_b32 s81, s89, 1
    s_lshl_b32 s82, s81, 14
    s_and_b32 s81, s81, 7
    s_lshl_b32 s81, s81, 7
    s_add_u32 s82, s82, s81
    s_and_b32 s81, s89, 1
    s_lshl_b32 s81, s81, 12
    s_add_u32 s82, s82, s81
    s_lshl_b32 s81, s3, 8
    s_add_u32 s74, s82, s81
    s_add_u32 s74, s74, 0x130800
    s_cmp_lt_u32 s3, 1
    s_cselect_b32 s74, s74, 0x40000000
    s_lshl_b32 s81, s3, 9
    s_add_u32 s82, s82, s81
    s_add_u32 s82, s82, 0x130000
    s_add_u32 s32, s82, 0x2000
    s_add_u32 s86, s74, 0x2000
    s_add_u32 s20, s30, 0x100000
    s_add_u32 s21, s30, 0x104300
    s_add_u32 s22, s30, 0x108600
    s_add_u32 s23, s30, 0x10c900
    s_lshl_b32 s83, s3, 3
    v_mov_b32 v6, s83
    s_waitcnt vmcnt(0)
    v_lshlrev_b32 v44, 16, v44
    v_lshlrev_b32 v45, 16, v45
    v_lshlrev_b32 v46, 16, v46
    s_mov_b32 s91, 3000000
L_gph:
    buffer_load_dwordx3 v[196:198], v41, s[44:47], s20 offen sc1
    buffer_load_dwordx3 v[200:202], v41, s[44:47], s21 offen sc1
    buffer_load_dwordx3 v[204:206], v41, s[44:47], s22 offen sc1
    buffer_load_dwordx3 v[208:210], v41, s[44:47], s23 offen sc1
    s_waitcnt vmcnt(0)
    v_xor_b32 v68, v16, v196
    v_xor_b32 v69, v16, v197
    v_xor_b32 v70, v16, v198
    v_xor_b32 v71, v16, v200
    v_xor_b32 v72, v16, v201
    v_xor_b32 v73, v16, v202
    v_xor_b32 v74, v16, v204
    v_xor_b32 v75, v16, v205
    v_xor_b32 v76, v16, v206
    v_xor_b32 v77, v16, v208
    v_xor_b32 v78, v16, v209
    v_xor_b32 v79, v16, v210
    v_or3_b32 v13, v68, v69, v70
    v_or3_b32 v13, v13, v71, v72
    v_or3_b32 v13, v13, v73, v74
    v_or3_b32 v13, v13, v75, v76
    v_or3_b32 v13, v13, v77, v78
    v_or_b32 v13, v13, v79
    v_and_b32 v13, 0xff, v13
    v_cmp_ne_u32 vcc, 0, v13
    s_cbranch_vccz L_gph_done
    s_sub_u32 s91, s91, 1
    s_cbranch_scc0 L_gph
L_gph_done:
    s_setprio 3
    v_add_f32 v68, v68, v71
    v_add_f32 v69, v69, v72
    v_add_f32 v70, v70, v73
    v_add_f32 v74, v74, v77
    v_add_f32 v75, v75, v78
    v_add_f32 v76, v76, v79
    v_add_f32 v68, v68, v74
    v_add_f32 v69, v69, v75
    v_add_f32 v70, v70, v76
    v_add_f32_dpp v80, v68, v68 row_shl:4 row_mask:0xf bank_mask:0x5
    v_add_f32_dpp v81, v69, v69 row_shl:4 row_mask:0xf bank_mask:0x5
    v_add_f32_dpp v82, v70, v70 row_shl:4 row_mask:0xf bank_mask:0x5
    v_add_f32_dpp v80, v68, v68 row_shr:4 row_mask:0xf bank_mask:0xa
    v_add_f32_dpp v81, v69, v69 row_shr:4 row_mask:0xf bank_mask:0xa
    v_add_f32_dpp v82, v70, v70 row_shr:4 row_mask:0xf bank_mask:0xa
    v_cvt_pk_bf16_f32 v80, v80, v80
    v_cvt_pk_bf16_f32 v81, v81, v81
    v_cvt_pk_bf16_f32 v82, v82, v82
    v_lshlrev_b32 v80, 16, v80
    v_lshlrev_b32 v81, 16, v81
    v_lshlrev_b32 v82, 16, v82
    v_add_f32 v80, v80, v44
    v_add_f32 v81, v81, v45
    v_add_f32 v82, v82, v46
    v_cvt_pk_bf16_f32 v80, v80, v80
    v_cvt_pk_bf16_f32 v81, v81, v81
    v_cvt_pk_bf16_f32 v82, v82, v82
    v_and_b32_dpp v28, v80, v24 quad_perm:[0,0,0,0] row_mask:0xf bank_mask:0xf
    v_and_b32_dpp v29, v80, v25 quad_perm:[0,0,0,0] row_mask:0xf bank_mask:0xf
    v_and_b32_dpp v30, v80, v26 quad_perm:[0,0,0,0] row_mask:0xf bank_mask:0xf
    v_and_b32_dpp v31, v80, v27 quad_perm:[0,0,0,0] row_mask:0xf bank_mask:0xf
    v_and_b32_dpp v32, v80, v24 quad_perm:[1,1,1,1] row_mask:0xf bank_mask:0xf
    v_and_b32_dpp v33, v80, v25 quad_perm:[1,1,1,1] row_mask:0xf bank_mask:0xf
    v_and_b32_dpp v34, v80, v26 quad_perm:[1,1,1,1] row_mask:0xf bank_mask:0xf
    v_and_b32_dpp v35, v80, v27 quad_perm:[1,1,1,1] row_mask:0xf bank_mask:0xf
    v_lshlrev_b32 v68, 16, v80
    v_lshlrev_b32 v69, 16, v81
    v_lshlrev_b32 v70, 16, v82
    v_add_f32 v72, v68, v69
    v_mfma_f32_16x16x32_bf16 v[36:39], v[28:31], v[84:87], 0
    v_and_b32_dpp v28, v80, v24 quad_perm:[2,2,2,2] row_mask:0xf bank_mask:0xf
    v_and_b32_dpp v29, v80, v25 quad_perm:[2,2,2,2] row_mask:0xf bank_mask:0xf
    v_and_b32_dpp v30, v80, v26 quad_perm:[2,2,2,2] row_mask:0xf bank_mask:0xf
    v_and_b32_dpp v31, v80, v27 quad_perm:[2,2,2,2] row_mask:0xf bank_mask:0xf
    v_mul_f32 v73, v68, v68
    v_fmac_f32 v73, v69, v69
    v_add_f32 v72, v72, v70
    v_fmac_f32 v73, v70, v70
    v_mfma_f32_16x16x32_bf16 v[36:39], v[32:35], v[88:91], v[36:39]
    v_and_b32_dpp v32, v80, v24 quad_perm:[3,3,3,3] row_mask:0xf bank_mask:0xf
    v_and_b32_dpp v33, v80, v25 quad_perm:[3,3,3,3] row_mask:0xf bank_mask:0xf
    v_and_b32_dpp v34, v80, v26 quad_perm:[3,3,3,3] row_mask:0xf bank_mask:0xf
    v_and_b32_dpp v35, v80, v27 quad_perm:[3,3,3,3] row_mask:0xf bank_mask:0xf
    ds_write_b32 v40, v68 offset:16384
    ds_write_b32 v40, v69 offset:16388
    ds_write_b32 v40, v70 offset:16392
    v_mfma_f32_16x16x32_bf16 v[36:39], v[28:31], v[92:95], v[36:39]
    v_and_b32_dpp v28, v81, v24 quad_perm:[0,0,0,0] row_mask:0xf bank_mask:0xf
    v_and_b32_dpp v29, v81, v25 quad_perm:[0,0,0,0] row_mask:0xf bank_mask:0xf
    v_and_b32_dpp v30, v81, v26 quad_perm:[0,0,0,0] row_mask:0xf bank_mask:0xf
    v_and_b32_dpp v31, v81, v27 quad_perm:[0,0,0,0] row_mask:0xf bank_mask:0xf
    v_add_f32_dpp v72, v72, v72 quad_perm:[1,0,3,2] row_mask:0xf bank_mask:0xf
    v_add_f32_dpp v73, v73, v73 quad_perm:[1,0,3,2] row_mask:0xf bank_mask:0xf
    v_mfma_f32_16x16x32_bf16 v[36:39], v[32:35], v[96:99], v[36:39]
    v_and_b32_dpp v32, v81, v24 quad_perm:[1,1,1,1] row_mask:0xf bank_mask:0xf
    v_and_b32_dpp v33, v81, v25 quad_perm:[1,1,1,1] row_mask:0xf bank_mask:0xf
    v_and_b32_dpp v34, v81, v26 quad_perm:[1,1,1,1] row_mask:0xf bank_mask:0xf
    v_and_b32_dpp v35, v81, v27 quad_perm:[1,1,1,1] row_mask:0xf bank_mask:0xf
    v_add_f32_dpp v72, v72, v72 quad_perm:[2,3,0,1] row_mask:0xf bank_mask:0xf
    v_add_f32_dpp v73, v73, v73 quad_perm:[2,3,0,1] row_mask:0xf bank_mask:0xf
    v_mfma_f32_16x16x32_bf16 v[36:39], v[28:31], v[100:103], v[36:39]
    v_and_b32_dpp v28, v81, v24 quad_perm:[2,2,2,2] row_mask:0xf bank_mask:0xf
    v_and_b32_dpp v29, v81, v25 quad_perm:[2,2,2,2] row_mask:0xf bank_mask:0xf
    v_and_b32_dpp v30, v81, v26 quad_perm:[2,2,2,2] row_mask:0xf bank_mask:0xf
    v_and_b32_dpp v31, v81, v27 quad_perm:[2,2,2,2] row_mask:0xf bank_mask:0xf
    v_add_f32_dpp v72, v72, v72 row_ror:8 row_mask:0xf bank_mask:0xf
    v_add_f32_dpp v73, v73, v73 row_ror:8 row_mask:0xf bank_mask:0xf
    v_mfma_f32_16x16x32_bf16 v[36:39], v[32:35], v[104:107], v[36:39]
    v_and_b32_dpp v32, v81, v24 quad_perm:[3,3,3,3] row_mask:0xf bank_mask:0xf
    v_and_b32_dpp v33, v81, v25 quad_perm:[3,3,3,3] row_mask:0xf bank_mask:0xf
    v_and_b32_dpp v34, v81, v26 quad_perm:[3,3,3,3] row_mask:0xf bank_mask:0xf
    v_and_b32_dpp v35, v81, v27 quad_perm:[3,3,3,3] row_mask:0xf bank_mask:0xf
    v_add_f32_dpp v72, v72, v72 row_bcast:15 row_mask:0xa bank_mask:0xf
    v_add_f32_dpp v73, v73, v73 row_bcast:15 row_mask:0xa bank_mask:0xf
    v_mfma_f32_16x16x32_bf16 v[36:39], v[28:31], v[108:111], v[36:39]
    v_and_b32_dpp v28, v82, v24 quad_perm:[0,0,0,0] row_mask:0xf bank_mask:0xf
    v_and_b32_dpp v29, v82, v25 quad_perm:[0,0,0,0] row_mask:0xf bank_mask:0xf
    v_and_b32_dpp v30, v82, v26 quad_perm:[0,0,0,0] row_mask:0xf bank_mask:0xf
    v_and_b32_dpp v31, v82, v27 quad_perm:[0,0,0,0] row_mask:0xf bank_mask:0xf
    v_add_f32_dpp v72, v72, v72 row_bcast:31 row_mask:0xc bank_mask:0xf
    v_add_f32_dpp v73, v73, v73 row_bcast:31 row_mask:0xc bank_mask:0xf
    v_mfma_f32_16x16x32_bf16 v[36:39], v[32:35], v[112:115], v[36:39]
    v_and_b32_dpp v32, v82, v24 quad_perm:[1,1,1,1] row_mask:0xf bank_mask:0xf
    v_and_b32_dpp v33, v82, v25 quad_perm:[1,1,1,1] row_mask:0xf bank_mask:0xf
    v_and_b32_dpp v34, v82, v26 quad_perm:[1,1,1,1] row_mask:0xf bank_mask:0xf
    v_and_b32_dpp v35, v82, v27 quad_perm:[1,1,1,1] row_mask:0xf bank_mask:0xf
    v_mfma_f32_16x16x32_bf16 v[36:39], v[28:31], v[116:119], v[36:39]
    v_and_b32_dpp v28, v82, v24 quad_perm:[2,2,2,2] row_mask:0xf bank_mask:0xf
    v_and_b32_dpp v29, v82, v25 quad_perm:[2,2,2,2] row_mask:0xf bank_mask:0xf
    v_and_b32_dpp v30, v82, v26 quad_perm:[2,2,2,2] row_mask:0xf bank_mask:0xf
    v_and_b32_dpp v31, v82, v27 quad_perm:[2,2,2,2] row_mask:0xf bank_mask:0xf
    v_mfma_f32_16x16x32_bf16 v[36:39], v[32:35], v[120:123], v[36:39]
    v_and_b32_dpp v32, v82, v24 quad_perm:[3,3,3,3] row_mask:0xf bank_mask:0xf
    v_and_b32_dpp v33, v82, v25 quad_perm:[3,3,3,3] row_mask:0xf bank_mask:0xf
    v_and_b32_dpp v34, v82, v26 quad_perm:[3,3,3,3] row_mask:0xf bank_mask:0xf
    v_and_b32_dpp v35, v82, v27 quad_perm:[3,3,3,3] row_mask:0xf bank_mask:0xf
    v_mfma_f32_16x16x32_bf16 v[36:39], v[28:31], v[124:127], v[36:39]
    s_nop 0
    v_mfma_f32_16x16x32_bf16 v[36:39], v[32:35], v[128:131], v[36:39]
    s_mov_b32 exec_lo, 0
    s_mov_b32 exec_hi, 0x80000000
    ds_write_b64 v6, v[72:73] offset:448
    s_mov_b32 exec_lo, 0x00ff00ff
    s_mov_b32 exec_hi, 0xff00ff00
    s_nop 2
    ds_write_b128 v14, v[36:39] offset:12288
    s_mov_b64 exec, -1
    s_waitcnt lgkmcnt(0)
    s_barrier
    ds_read_b128 v[52:55], v20 offset:448
    ds_read_b128 v[56:59], v20 offset:464
    ds_read_b128 v[60:63], v20 offset:480
    ds_read_b128 v[64:67], v20 offset:496
    ds_read_b128 v[68:71], v18 offset:12288
    ds_read_b128 v[72:75], v18 offset:12544
    ds_read_b128 v[76:79], v18 offset:12800
    ds_read_b128 v[80:83], v18 offset:13056
    s_waitcnt lgkmcnt(4)
    v_pk_add_f32 v[52:53], v[52:53], v[60:61]
    v_pk_add_f32 v[54:55], v[54:55], v[62:63]
    v_pk_add_f32 v[56:57], v[56:57], v[64:65]
    v_pk_add_f32 v[58:59], v[58:59], v[66:67]
    v_pk_add_f32 v[52:53], v[52:53], v[56:57]
    v_pk_add_f32 v[54:55], v[54:55], v[58:59]
    v_add_f32 v52, v52, v54
    v_add_f32 v60, v53, v55
    s_waitcnt lgkmcnt(2)
    v_mul_f32 v52, 0x3acccccd, v52
    v_add_f32 v68, v68, v72
    v_mul_f32 v60, 0x3acccccd, v60
    v_add_f32 v69, v69, v73
    v_fma_f32 v60, -v52, v52, v60
    v_add_f32 v70, v70, v74
    v_max_f32 v60, 0, v60
    v_add_f32 v71, v71, v75
    v_cvt_pk_bf16_f32 v60, v60, v60
    s_waitcnt lgkmcnt(0)
    v_add_f32 v76, v76, v80
    v_lshlrev_b32 v60, 16, v60
    v_add_f32 v77, v77, v81
    v_add_f32 v60, 0x3727c5ac, v60
    v_add_f32 v78, v78, v82
    v_cvt_pk_bf16_f32 v60, v60, v60
    v_add_f32 v79, v79, v83
    v_lshlrev_b32 v60, 16, v60
    v_add_f32 v68, v68, v76
    v_sqrt_f32 v60, v60
    v_add_f32 v70, v70, v78
    v_add_f32 v69, v69, v77
    v_add_f32 v71, v71, v79
    v_cvt_pk_bf16_f32 v60, v60, v60
    v_permlane32_swap_b32 v68, v70
    v_cvt_pk_bf16_f32 v52, v52, v52
    v_permlane32_swap_b32 v69, v71
    v_lshlrev_b32 v60, 16, v60
    v_add_f32 v68, v68, v70
    v_add_f32 v69, v69, v71
    v_rcp_f32 v61, v60
    v_lshlrev_b32 v52, 16, v52
    v_permlane16_swap_b32 v68, v69
    v_add_f32 v68, v68, v69
    v_fma_f32 v68, -v52, v47, v68
    v_mul_f32 v68, v68, v61
    v_cvt_pk_bf16_f32 v68, v68, v68
    v_lshlrev_b32 v68, 16, v68
    v_mul_f32 v69, s94, v68
    v_exp_f32 v69, -v69
    s_nop 0
    v_add_f32 v69, 1.0, v69
    v_rcp_f32 v70, v69
    s_nop 0
    v_mul_f32 v71, v68, v70
    v_cvt_pk_bf16_f32 v71, v71, v71
    v_lshlrev_b32 v71, 16, v71
    s_nop 1
    v_mul_f32_dpp v71, v68, v71 row_ror:8 row_mask:0xf bank_mask:0xf
    v_cvt_pk_bf16_f32 v71, v71, v71
    s_nop 1
    v_and_b32_dpp v28, v71, v24 row_newbcast:0 row_mask:0xf bank_mask:0xf
    v_and_b32_dpp v29, v71, v25 row_newbcast:0 row_mask:0xf bank_mask:0xf
    v_and_b32_dpp v30, v71, v26 row_newbcast:0 row_mask:0xf bank_mask:0xf
    v_and_b32_dpp v31, v71, v27 row_newbcast:0 row_mask:0xf bank_mask:0xf
    v_and_b32_dpp v32, v71, v24 row_newbcast:1 row_mask:0xf bank_mask:0xf
    v_and_b32_dpp v33, v71, v25 row_newbcast:1 row_mask:0xf bank_mask:0xf
    v_and_b32_dpp v34, v71, v26 row_newbcast:1 row_mask:0xf bank_mask:0xf
    v_and_b32_dpp v35, v71, v27 row_newbcast:1 row_mask:0xf bank_mask:0xf
    s_cmp_eq_u32 s3, 0
    s_cbranch_scc1 L_d2
    v_mfma_f32_16x16x32_bf16 v[36:39], v[28:31], v[132:135], 0
    v_and_b32_dpp v28, v71, v24 row_newbcast:2 row_mask:0xf bank_mask:0xf
    v_and_b32_dpp v29, v71, v25 row_newbcast:2 row_mask:0xf bank_mask:0xf
    v_and_b32_dpp v30, v71, v26 row_newbcast:2 row_mask:0xf bank_mask:0xf
    v_and_b32_dpp v31, v71, v27 row_newbcast:2 row_mask:0xf bank_mask:0xf
    v_mfma_f32_16x16x32_bf16 v[36:39], v[32:35], v[140:143], v[36:39]
    v_and_b32_dpp v32, v71, v24 row_newbcast:3 row_mask:0xf bank_mask:0xf
    v_and_b32_dpp v33, v71, v25 row_newbcast:3 row_mask:0xf bank_mask:0xf
    v_and_b32_dpp v34, v71, v26 row_newbcast:3 row_mask:0xf bank_mask:0xf
    v_and_b32_dpp v35, v71, v27 row_newbcast:3 row_mask:0xf bank_mask:0xf
    v_mfma_f32_16x16x32_bf16 v[36:39], v[28:31], v[148:151], v[36:39]
    v_and_b32_dpp v28, v71, v24 row_newbcast:4 row_mask:0xf bank_mask:0xf
    v_and_b32_dpp v29, v71, v25 row_newbcast:4 row_mask:0xf bank_mask:0xf
    v_and_b32_dpp v30, v71, v26 row_newbcast:4 row_mask:0xf bank_mask:0xf
    v_and_b32_dpp v31, v71, v27 row_newbcast:4 row_mask:0xf bank_mask:0xf
    v_mfma_f32_16x16x32_bf16 v[36:39], v[32:35], v[156:159], v[36:39]
    v_and_b32_dpp v32, v71, v24 row_newbcast:5 row_mask:0xf bank_mask:0xf
    v_and_b32_dpp v33, v71, v25 row_newbcast:5 row_mask:0xf bank_mask:0xf
    v_and_b32_dpp v34, v71, v26 row_newbcast:5 row_mask:0xf bank_mask:0xf
    v_and_b32_dpp v35, v71, v27 row_newbcast:5 row_mask:0xf bank_mask:0xf
    v_mfma_f32_16x16x32_bf16 v[36:39], v[28:31], v[164:167], v[36:39]
    v_and_b32_dpp v28, v71, v24 row_newbcast:6 row_mask:0xf bank_mask:0xf
    v_and_b32_dpp v29, v71, v25 row_newbcast:6 row_mask:0xf bank_mask:0xf
    v_and_b32_dpp v30, v71, v26 row_newbcast:6 row_mask:0xf bank_mask:0xf
    v_and_b32_dpp v31, v71, v27 row_newbcast:6 row_mask:0xf bank_mask:0xf
    v_mfma_f32_16x16x32_bf16 v[36:39], v[32:35], v[172:175], v[36:39]
    v_and_b32_dpp v32, v71, v24 row_newbcast:7 row_mask:0xf bank_mask:0xf
    v_and_b32_dpp v33, v71, v25 row_newbcast:7 row_mask:0xf bank_mask:0xf
    v_and_b32_dpp v34, v71, v26 row_newbcast:7 row_mask:0xf bank_mask:0xf
    v_and_b32_dpp v35, v71, v27 row_newbcast:7 row_mask:0xf bank_mask:0xf
    v_mfma_f32_16x16x32_bf16 v[36:39], v[28:31], v[180:183], v[36:39]
    s_nop 0
    v_mfma_f32_16x16x32_bf16 v[36:39], v[32:35], v[188:191], v[36:39]
    s_nop 7
    v_and_or_b32 v36, v36, s90, v16
    v_and_or_b32 v37, v37, s90, v16
    v_and_or_b32 v38, v38, s90, v16
    v_and_or_b32 v39, v39, s90, v16
    buffer_store_dwordx4 v[36:39], v49, s[44:47], s82 offen sc1
    s_branch L_d3
L_d2:
    v_mfma_f32_16x16x32_bf16 v[36:39], v[28:31], v[132:135], 0
    v_mfma_f32_16x16x32_bf16 v[64:67], v[28:31], v[136:139], 0
    v_and_b32_dpp v28, v71, v24 row_newbcast:2 row_mask:0xf bank_mask:0xf
    v_and_b32_dpp v29, v71, v25 row_newbcast:2 row_mask:0xf bank_mask:0xf
    v_and_b32_dpp v30, v71, v26 row_newbcast:2 row_mask:0xf bank_mask:0xf
    v_and_b32_dpp v31, v71, v27 row_newbcast:2 row_mask:0xf bank_mask:0xf
    v_mfma_f32_16x16x32_bf16 v[36:39], v[32:35], v[140:143], v[36:39]
    v_mfma_f32_16x16x32_bf16 v[64:67], v[32:35], v[144:147], v[64:67]
    v_and_b32_dpp v32, v71, v24 row_newbcast:3 row_mask:0xf bank_mask:0xf
    v_and_b32_dpp v33, v71, v25 row_newbcast:3 row_mask:0xf bank_mask:0xf
    v_and_b32_dpp v34, v71, v26 row_newbcast:3 row_mask:0xf bank_mask:0xf
    v_and_b32_dpp v35, v71, v27 row_newbcast:3 row_mask:0xf bank_mask:0xf
    v_mfma_f32_16x16x32_bf16 v[36:39], v[28:31], v[148:151], v[36:39]
    v_mfma_f32_16x16x32_bf16 v[64:67], v[28:31], v[152:155], v[64:67]
    v_and_b32_dpp v28, v71, v24 row_newbcast:4 row_mask:0xf bank_mask:0xf
    v_and_b32_dpp v29, v71, v25 row_newbcast:4 row_mask:0xf bank_mask:0xf
    v_and_b32_dpp v30, v71, v26 row_newbcast:4 row_mask:0xf bank_mask:0xf
    v_and_b32_dpp v31, v71, v27 row_newbcast:4 row_mask:0xf bank_mask:0xf
    v_mfma_f32_16x16x32_bf16 v[36:39], v[32:35], v[156:159], v[36:39]
    v_mfma_f32_16x16x32_bf16 v[64:67], v[32:35], v[160:163], v[64:67]
    v_and_b32_dpp v32, v71, v24 row_newbcast:5 row_mask:0xf bank_mask:0xf
    v_and_b32_dpp v33, v71, v25 row_newbcast:5 row_mask:0xf bank_mask:0xf
    v_and_b32_dpp v34, v71, v26 row_newbcast:5 row_mask:0xf bank_mask:0xf
    v_and_b32_dpp v35, v71, v27 row_newbcast:5 row_mask:0xf bank_mask:0xf
    v_mfma_f32_16x16x32_bf16 v[36:39], v[28:31], v[164:167], v[36:39]
    v_mfma_f32_16x16x32_bf16 v[64:67], v[28:31], v[168:171], v[64:67]
    v_and_b32_dpp v28, v71, v24 row_newbcast:6 row_mask:0xf bank_mask:0xf
    v_and_b32_dpp v29, v71, v25 row_newbcast:6 row_mask:0xf bank_mask:0xf
    v_and_b32_dpp v30, v71, v26 row_newbcast:6 row_mask:0xf bank_mask:0xf
    v_and_b32_dpp v31, v71, v27 row_newbcast:6 row_mask:0xf bank_mask:0xf
    v_mfma_f32_16x16x32_bf16 v[36:39], v[32:35], v[172:175], v[36:39]
    v_mfma_f32_16x16x32_bf16 v[64:67], v[32:35], v[176:179], v[64:67]
    v_and_b32_dpp v32, v71, v24 row_newbcast:7 row_mask:0xf bank_mask:0xf
    v_and_b32_dpp v33, v71, v25 row_newbcast:7 row_mask:0xf bank_mask:0xf
    v_and_b32_dpp v34, v71, v26 row_newbcast:7 row_mask:0xf bank_mask:0xf
    v_and_b32_dpp v35, v71, v27 row_newbcast:7 row_mask:0xf bank_mask:0xf
    v_mfma_f32_16x16x32_bf16 v[36:39], v[28:31], v[180:183], v[36:39]
    v_mfma_f32_16x16x32_bf16 v[64:67], v[28:31], v[184:187], v[64:67]
    v_mfma_f32_16x16x32_bf16 v[36:39], v[32:35], v[188:191], v[36:39]
    v_mfma_f32_16x16x32_bf16 v[64:67], v[32:35], v[192:195], v[64:67]
    s_nop 6
    v_and_or_b32 v36, v36, s90, v16
    v_and_or_b32 v37, v37, s90, v16
    v_and_or_b32 v38, v38, s90, v16
    v_and_or_b32 v39, v39, s90, v16
    buffer_store_dwordx4 v[36:39], v49, s[44:47], s82 offen sc1
    v_and_or_b32 v64, v64, s90, v16
    v_and_or_b32 v65, v65, s90, v16
    v_and_or_b32 v66, v66, s90, v16
    v_and_or_b32 v67, v67, s90, v16
    buffer_store_dwordx4 v[64:67], v49, s[44:47], s74 offen sc1
L_d3:
    s_branch L_fin
L_f:
    s_cmp_eq_u32 s3, 7
    s_cbranch_scc1 L_f2
    s_cmp_lg_u32 s3, 6
    s_cbranch_scc1 L_fin
    s_cmp_lg_u32 s89, 0
    s_cbranch_scc1 L_fin
    v_mov_b32 v10, s92
    s_mov_b64 exec, 1
    buffer_store_dword v10, v20, s[44:47], 0 offen offset:0 sc1
    s_mov_b64 exec, -1
    s_branch L_fin
L_f2:
    s_setprio 0
    s_cmp_ge_u32 s89, 40
    s_cbranch_scc1 L_fin
    v_lshrrev_b32 v6, 3, v1
    v_mul_u32_u24 v6, 0x4080, v6
    v_bfe_u32 v7, v1, 2, 1
    v_lshl_add_u32 v6, v7, 12, v6
    v_and_b32 v7, 3, v1
    v_lshl_add_u32 v6, v7, 4, v6
    s_lshl_b32 s83, s89, 6
    s_add_u32 s80, s83, 0x130000
    s_add_u32 s80, s80, s30
    s_add_u32 s81, s80, 131072
    s_add_u32 s82, s80, 262144
    s_add_u32 s76, s80, 393216
    v_lshl_add_u32 v7, v7, 2, v2
    v_lshlrev_b32 v7, 2, v7
    v_add_u32 v7, s83, v7
    ds_read_b32 v8, v7 offset:16384
    v_lshrrev_b32 v7, 1, v7
    s_waitcnt vmcnt(0)
    v_cmp_gt_u32 vcc, 24, v1
    v_subrev_u32 v11, 131072, v6
    s_nop 0
    v_cndmask_b32 v11, v11, v6, vcc
    v_add_u32 v11, 131072, v11
    v_cndmask_b32 v9, 0, 1.0, vcc
    s_mov_b32 s91, 3000000
    s_mov_b64 s[28:29], -1
L_pp1:
    s_mov_b64 exec, s[28:29]
    buffer_load_dwordx4 v[196:199], v6, s[44:47], s80 offen sc1
    buffer_load_dwordx4 v[200:203], v6, s[44:47], s81 offen sc1
    buffer_load_dwordx4 v[204:207], v6, s[44:47], s82 offen sc1
    buffer_load_dwordx4 v[208:211], v11, s[44:47], s82 offen sc1
    s_mov_b64 exec, -1
    s_waitcnt vmcnt(0)
    v_xor_b32 v68, v16, v196
    v_xor_b32 v69, v16, v197
    v_xor_b32 v70, v16, v198
    v_xor_b32 v71, v16, v199
    v_xor_b32 v72, v16, v200
    v_xor_b32 v73, v16, v201
    v_xor_b32 v74, v16, v202
    v_xor_b32 v75, v16, v203
    v_xor_b32 v76, v16, v204
    v_xor_b32 v77, v16, v205
    v_xor_b32 v78, v16, v206
    v_xor_b32 v79, v16, v207
    v_xor_b32 v80, v16, v208
    v_xor_b32 v81, v16, v209
    v_xor_b32 v82, v16, v210
    v_xor_b32 v83, v16, v211
    v_or3_b32 v13, v68, v69, v70
    v_or3_b32 v13, v13, v71, v72
    v_or3_b32 v13, v13, v73, v74
    v_or3_b32 v13, v13, v75, v76
    v_or3_b32 v13, v13, v77, v78
    v_or3_b32 v13, v13, v79, v80
    v_or3_b32 v13, v13, v81, v82
    v_or_b32 v13, v13, v83
    v_and_b32 v13, 0xff, v13
    v_cmp_ne_u32 vcc, 0, v13
    s_cbranch_vccz L_pp1_done
L_pp1_e:
    v_or_b32_dpp v13, v13, v13 quad_perm:[1,0,3,2] row_mask:0xf bank_mask:0xf
    s_nop 1
    v_or_b32_dpp v13, v13, v13 quad_perm:[2,3,0,1] row_mask:0xf bank_mask:0xf
    v_cmp_ne_u32 vcc, 0, v13
    s_mov_b64 s[28:29], vcc
    s_sub_u32 s91, s91, 1
    s_cbranch_scc1 L_pp1_done
    s_branch L_pp1
L_pp1_done:
    v_add_f32 v68, v68, v72
    v_add_f32 v69, v69, v73
    v_add_f32 v70, v70, v74
    v_add_f32 v71, v71, v75
    v_fmac_f32 v76, v9, v80
    v_fmac_f32 v77, v9, v81
    v_fmac_f32 v78, v9, v82
    v_fmac_f32 v79, v9, v83
    v_add_f32 v68, v68, v76
    v_add_f32 v69, v69, v77
    v_add_f32 v70, v70, v78
    v_add_f32 v71, v71, v79
    s_nop 0
    v_permlane32_swap_b32 v68, v70
    v_permlane32_swap_b32 v69, v71
    v_add_f32 v68, v68, v70
    v_add_f32 v69, v69, v71
    s_nop 1
    v_permlane16_swap_b32 v68, v69
    v_add_f32 v68, v68, v69
    s_nop 1
    v_add_f32_dpp v68, v68, v68 row_ror:8 row_mask:0xf bank_mask:0xf
    s_nop 1
    v_add_f32_dpp v68, v68, v68 row_ror:4 row_mask:0xf bank_mask:0xf
    v_cvt_pk_bf16_f32 v68, v68, v68
    v_lshlrev_b32 v68, 16, v68
    s_waitcnt lgkmcnt(0)
    v_add_f32 v68, v68, v8
    v_cvt_pk_bf16_f32 v68, v68, v68
    s_mov_b32 exec_lo, 0x000f000f
    s_mov_b32 exec_hi, 0x000f000f
    buffer_store_short v68, v7, s[68:71], 0 offen
    s_mov_b64 exec, -1
L_fin:
L_end:
    s_endpgm
    .p2align 6
    .type L_tab,@object
L_tab:
    .byte 65, 68, 255, 22, 66, 255, 69, 255, 71, 255, 37, 255, 40, 255, 66, 255
    .byte 255, 70, 4, 255, 9, 255, 65, 255, 48, 255, 69, 255, 255, 27, 64, 255
    .byte 255, 255, 52, 72, 71, 255, 255, 66, 255, 2, 64, 255, 69, 255, 12, 255
    .byte 255, 51, 255, 7, 72, 255, 255, 71, 49, 255, 255, 23, 255, 72, 71, 255
    .byte 72, 255, 21, 255, 255, 10, 68, 255, 32, 255, 72, 255, 255, 64, 255, 30
    .byte 255, 50, 255, 73, 8, 255, 255, 70, 255, 66, 5, 255, 255, 66, 255, 47
    .byte 255, 64, 65, 255, 25, 255, 255, 73, 0, 255, 71, 255, 70, 255, 255, 15
    .byte 68, 73, 255, 64, 255, 65, 255, 46, 1, 255, 255, 66, 255, 11, 255, 67
    .byte 16, 255, 70, 255, 68, 255, 45, 255, 255, 255, 53, 65, 255, 71, 255, 69
    .byte 33, 255, 255, 39, 255, 73, 70, 255, 255, 35, 255, 70, 73, 255, 28, 255
    .byte 255, 19, 255, 6, 255, 69, 255, 64, 66, 71, 255, 67, 24, 255, 72, 255
    .byte 255, 3, 73, 255, 65, 255, 255, 31, 73, 255, 20, 255, 255, 67, 255, 14
    .byte 70, 255, 36, 255, 64, 255, 29, 255, 255, 72, 68, 255, 255, 42, 67, 255
    .byte 17, 255, 255, 68, 41, 255, 255, 68, 64, 69, 255, 38, 255, 68, 255, 72
    .byte 67, 65, 66, 255, 255, 43, 73, 255, 69, 67, 255, 69, 67, 255, 44, 255
    .byte 255, 34, 67, 255, 255, 26, 255, 65, 255, 18, 255, 71, 255, 70, 13, 255
    .size L_tab, 256
.section .rodata,"a"
.p2align 6
.amdhsa_kernel sequential_preLN__mha_block_cached__swiglu_ffn__decode_kernel
  .amdhsa_next_free_vgpr 212
  .amdhsa_next_free_sgpr 102
  .amdhsa_accum_offset 212
  .amdhsa_group_segment_fixed_size 0
  .amdhsa_kernarg_size 96
  .amdhsa_user_sgpr_count 2
  .amdhsa_user_sgpr_kernarg_segment_ptr 1
  .amdhsa_system_sgpr_workgroup_id_x 1
  .amdhsa_float_denorm_mode_32 3
  .amdhsa_float_denorm_mode_16_64 3
.end_amdhsa_kernel
```
